```python
import torch

def _softmax(x, axis=-1):
    return torch.softmax(x, dim=axis)
def _gelu(x):
    return torch.nn.functional.gelu(x, approximate="tanh")
def _silu(x):
    return torch.nn.functional.silu(x)
def _sigmoid(x):
    return torch.sigmoid(x)
def _layernorm(x, axis=-1, eps=1e-5):
    m = x.mean(dim=axis, keepdim=True)
    v = x.var(dim=axis, keepdim=True, unbiased=False)
    return (x - m) / torch.sqrt(v + eps)
def _scatter_add(tgt, idx, src, axis=0):
    return tgt.clone().index_add_(axis, idx, src)
def _segment_sum(src, seg, n):
    out = torch.zeros((n,) + src.shape[1:], dtype=src.dtype)
    return out.index_add_(0, seg, src)
def _pad(x, pw):
    flat = tuple(v for pair in reversed(pw) for v in pair)
    return torch.nn.functional.pad(x, flat)

kernel_name = 'recurrent_scan__sliding_block_cached__glu_gated_bilinear__prompt'

def setup_inputs():

    _w = (lambda a: (lambda t: t.to(torch.bfloat16) if t.is_floating_point() else t)(torch.as_tensor(a)))
    def _A_setup():
        B, Sq, D = 1, 2048, 1024
        Hq, Hkv, Sk, Dh = 32, 4, 2048, 128
        assert Hq % Hkv == 0, (Hq, Hkv)
        return {
            "x": _w((lambda *s: torch.randn(*s, dtype=torch.bfloat16) * 0.05)(B, Sq, D)),
            "k_cache": _w((lambda *s: torch.randn(*s, dtype=torch.bfloat16) * 1.6)(B, Hkv, Sk, Dh)),
            "v_cache": _w((lambda *s: torch.randn(*s, dtype=torch.bfloat16) * 1.6)(B, Hkv, Sk, Dh)),
            "wq": _w((lambda *s: torch.randn(*s, dtype=torch.bfloat16) * 1.6)(D, Hq * Dh) * (D ** -0.5)),
            "wo": _w((lambda *s: torch.randn(*s, dtype=torch.bfloat16) * 1.6)(Hq * Dh, D) * ((Hq * Dh) ** -0.5)),
        }
    _A_in = _A_setup()

    def _B_setup():
        B, S, D, F = 1, 2048, 1024, 3584
        return {
            "x": _w((lambda *s: torch.randn(*s, dtype=torch.bfloat16) * 0.05)(B, S, D)),
            "w_gate": _w((lambda *s: torch.randn(*s, dtype=torch.bfloat16) * 0.2)(D, F) * (D ** -0.5)),
            "w_up": _w((lambda *s: torch.randn(*s, dtype=torch.bfloat16) * 0.2)(D, F) * (D ** -0.5)),
            "w_down": _w((lambda *s: torch.randn(*s, dtype=torch.bfloat16) * 0.2)(F, D) * (F ** -0.5)),
        }
    _B_in = _B_setup()

    return {
        "A_x": _A_in["x"],
        "A_k_cache": _A_in["k_cache"],
        "A_v_cache": _A_in["v_cache"],
        "A_wq": _A_in["wq"],
        "A_wo": _A_in["wo"],
        "B_x": _B_in["x"],
        "B_w_gate": _B_in["w_gate"],
        "B_w_up": _B_in["w_up"],
        "B_w_down": _B_in["w_down"],
    }

def reference(A_x, A_k_cache, A_v_cache, A_wq, A_wo, B_x, B_w_gate, B_w_up, B_w_down):
    def _A_ref(x, k_cache, v_cache, wq, wo):
        B, Sq, D = x.shape
        Hq, Dh = 32, 128
        Hkv, Sk = k_cache.shape[1], k_cache.shape[2]
        W = min(4096, max(256, Sk // 4))
        rep = Hq // Hkv
        q = (lambda x, *d: x.permute(*d))((x @ wq).reshape(B, Sq, Hq, Dh), 0, 2, 1, 3)
        k = (lambda x, n, axis: torch.repeat_interleave(x, n, dim=axis))(k_cache[:, :, Sk - W:, :], rep, axis=1)
        v = (lambda x, n, axis: torch.repeat_interleave(x, n, dim=axis))(v_cache[:, :, Sk - W:, :], rep, axis=1)
        scores = torch.einsum("bhqd,bhkd->bhqk", q, k) * (Dh ** -0.5)
        p = _softmax(scores, axis=-1)
        o = torch.einsum("bhqk,bhkd->bhqd", p, v)
        return (lambda x, *d: x.permute(*d))(o, 0, 2, 1, 3).reshape(B, Sq, Hq * Dh) @ wo

    def _B_ref(x, w_gate, w_up, w_down):
        g = torch.einsum("bsd,df->bsf", x, w_gate)
        u = torch.einsum("bsd,df->bsf", x, w_up)
        h = g * u
        return torch.einsum("bsf,fd->bsd", h, w_down)

    x = A_x
    xn = _layernorm(x, axis=-1)
    s = _A_ref(xn, A_k_cache, A_v_cache, A_wq, A_wo)
    g = _silu(_B_ref(xn, B_w_gate, B_w_up, B_w_down))
    return x + s * g
```

```asm
; @launch grid=(256,1,1) block=(256,1,1) lds=163840
.amdgcn_target "amdgcn-amd-amdhsa--gfx950"
.text
.globl recurrent_scan__sliding_block_cached__glu_gated_bilinear__prompt_kernel
.p2align 8
.type recurrent_scan__sliding_block_cached__glu_gated_bilinear__prompt_kernel,@function
recurrent_scan__sliding_block_cached__glu_gated_bilinear__prompt_kernel:
    s_cmp_ge_u32 s2, 256
    s_cbranch_scc1 L_end
    s_nop 0
    s_load_dwordx2 s[56:57], s[0:1], 0
    s_load_dwordx4 s[64:67], s[0:1], 8
    s_load_dwordx4 s[68:71], s[0:1], 24
    s_load_dwordx4 s[72:75], s[0:1], 48
    s_load_dwordx4 s[76:79], s[0:1], 64
    s_load_dwordx2 s[46:47], s[0:1], 88
    s_memrealtime s[4:5]
    s_getpc_b64 s[96:97]
    s_and_b32 s96, s96, 0xffffff00
    s_lshr_b32 s98, s2, 3
    s_mul_i32 s98, s98, 15
    v_min_u32 v31, 14, v0
    v_add_u32_e64 v31, s98, v31
    v_min_u32 v31, 464, v31
    v_lshlrev_b32_e64 v31, 7, v31
    global_load_dword v31, v31, s[96:97]
    v_lshrrev_b32 v32, 6, v0
    v_and_b32 v0, 63, v0
    v_readfirstlane_b32 s38, v32
    s_and_b32 s60, s2, 7
    s_bfe_u32 s61, s2, 0x20003
    s_lshl_b32 s40, s60, 2
    s_add_u32 s40, s40, s61
    s_lshr_b32 s39, s2, 5
    v_lshrrev_b32 v40, 3, v0
    v_and_b32 v41, 7, v0
    v_lshlrev_b32 v42, 11, v40
    v_lshl_add_u32 v42, v41, 4, v42
    s_lshl_b32 s60, s39, 5
    s_add_u32 s60, s60, s40
    s_lshl_b32 s61, s60, 14
    s_lshl_b32 s62, s38, 9
    s_add_u32 s61, s61, s62
    v_lshlrev_b32 v20, 4, v0
    s_waitcnt lgkmcnt(0)
    s_mov_b32 s24, s56
    s_and_b32 s25, s57, 0xffff
    s_mov_b32 s26, 4194304
    s_mov_b32 s27, 0x20000
    buffer_load_dwordx4 v[48:51], v42, s[24:27], s61 offen offset:0
    buffer_load_dwordx4 v[52:55], v42, s[24:27], s61 offen offset:128
    buffer_load_dwordx4 v[56:59], v42, s[24:27], s61 offen offset:256
    buffer_load_dwordx4 v[60:63], v42, s[24:27], s61 offen offset:384
    s_mov_b32 s8, s46
    s_nop 0
    s_and_b32 s9, s47, 0xffff
    s_mov_b32 s10, 268435456
    s_mov_b32 s11, 0x20000
    s_sub_u32 s4, s4, 2000
    s_subb_u32 s5, s5, 0
    s_mov_b32 s50, s78
    s_mov_b32 s51, s79
    s_mov_b32 s12, s68
    s_and_b32 s13, s69, 0xffff
    s_mov_b32 s14, 8388608
    s_mov_b32 s15, 0x20000
    s_cmp_ge_u32 s38, 2
    s_cselect_b32 s72, s74, s72
    s_cselect_b32 s73, s75, s73
    s_mov_b32 s16, s72
    s_and_b32 s17, s73, 0xffff
    s_mov_b32 s18, 7340032
    s_mov_b32 s19, 0x20000
    v_bfe_u32 v32, v0, 2, 2
    v_lshrrev_b32 v33, 4, v0
    v_and_b32 v34, 3, v0
    v_lshlrev_b32_e64 v35, 6, v33
    v_lshl_add_u32 v35, v34, 4, v35
    v_lshl_add_u32 v9, v32, 13, v35
    s_lshl_b32 s61, s40, 8
    s_lshl_b32 s62, s38, 17
    s_add_u32 s61, s61, s62
    v_add_u32 v9, s61, v9
    v_xor_b32_e64 v36, 32, v9
    v_add_u32 v10, 31744, v36
    v_add_u32 v11, 63488, v9
    v_add_u32 v12, 95232, v36
    v_lshl_add_u32 v23, v32, 8, v35
    s_lshl_b32 s63, s38, 11
    v_add_u32 v23, s63, v23
    v_xor_b32 v26, 32, v23
    v_add_u32 v32, 0, v33
    v_and_b32 v34, 15, v0
    v_xor_b32 v34, v34, v32
    v_lshlrev_b32_e64 v34, 4, v34
    v_lshl_add_u32 v21, v33, 8, v34
    v_add_u32 v21, s63, v21
    v_add_u32 v32, 4, v33
    v_and_b32 v34, 15, v0
    v_xor_b32 v34, v34, v32
    v_lshlrev_b32_e64 v34, 4, v34
    v_lshl_add_u32 v22, v33, 8, v34
    v_add_u32 v22, s63, v22
    s_and_b32 s62, s38, 1
    s_mul_i32 s62, s62, 229376
    s_mul_i32 s63, s40, 192
    s_add_u32 s63, s63, s62
    s_lshl_b32 s61, s40, 5
    s_add_u32 s61, s61, s62
    s_add_u32 s61, s61, 5952
    v_mov_b32 v35, s63
    v_mov_b32_e64 v36, s61
    s_mov_b32 s63, 4682
    v_add_u32 v32, 0, v0
    v_mul_u32_u24 v33, s63, v32
    v_lshrrev_b32 v33, 16, v33
    v_mul_u32_u24 v34, 14, v33
    v_sub_u32 v34, v32, v34
    v_cmp_gt_u32 vcc, 12, v34
    v_mul_u32_u24 v33, 7168, v33
    v_lshl_add_u32 v33, v34, 4, v33
    v_cndmask_b32 v32, v36, v35, vcc
    v_add_u32 v33, v32, v33
    v_subrev_u32 v13, 0, v33
    v_add_u32 v32, 64, v0
    v_mul_u32_u24 v33, s63, v32
    v_lshrrev_b32_e64 v33, 16, v33
    v_mul_u32_u24 v34, 14, v33
    v_sub_u32 v34, v32, v34
    v_cmp_gt_u32 vcc, 12, v34
    v_mul_u32_u24 v33, 7168, v33
    v_lshl_add_u32 v33, v34, 4, v33
    v_cndmask_b32 v32, v36, v35, vcc
    v_add_u32 v33, v32, v33
    v_subrev_u32 v14, 1024, v33
    v_add_u32 v32, 128, v0
    v_mul_u32_u24 v33, s63, v32
    v_lshrrev_b32_e64 v33, 16, v33
    v_mul_u32_u24 v34, 14, v33
    v_sub_u32 v34, v32, v34
    v_cmp_gt_u32 vcc, 12, v34
    v_mul_u32_u24 v33, 7168, v33
    v_lshl_add_u32 v33, v34, 4, v33
    v_cndmask_b32 v32, v36, v35, vcc
    v_add_u32 v33, v32, v33
    v_subrev_u32 v15, 2048, v33
    v_add_u32 v32, 192, v0
    v_mul_u32_u24 v33, s63, v32
    v_lshrrev_b32_e64 v33, 16, v33
    v_mul_u32_u24 v34, 14, v33
    v_sub_u32 v34, v32, v34
    v_cmp_gt_u32 vcc, 12, v34
    v_mul_u32_u24 v33, 7168, v33
    v_lshl_add_u32 v33, v34, 4, v33
    v_cndmask_b32 v32, v36, v35, vcc
    v_add_u32 v33, v32, v33
    v_subrev_u32 v16, 3072, v33
    v_add_u32 v32, 256, v0
    v_mul_u32_u24 v33, s63, v32
    v_lshrrev_b32_e64 v33, 16, v33
    v_mul_u32_u24 v34, 14, v33
    v_sub_u32 v34, v32, v34
    v_cmp_gt_u32 vcc, 12, v34
    v_mul_u32_u24 v33, 7168, v33
    v_lshl_add_u32 v33, v34, 4, v33
    v_cndmask_b32 v32, v36, v35, vcc
    v_add_u32_e64 v33, v32, v33
    v_subrev_u32 v17, 0, v33
    v_add_u32 v32, 320, v0
    v_mul_u32_u24 v33, s63, v32
    v_lshrrev_b32_e64 v33, 16, v33
    v_mul_u32_u24 v34, 14, v33
    v_sub_u32 v34, v32, v34
    v_cmp_gt_u32 vcc, 12, v34
    v_mul_u32_u24 v33, 7168, v33
    v_lshl_add_u32 v33, v34, 4, v33
    v_cndmask_b32 v32, v36, v35, vcc
    v_add_u32 v33, v32, v33
    v_subrev_u32 v18, 1024, v33
    v_add_u32 v32, 384, v0
    v_mul_u32_u24 v33, s63, v32
    v_lshrrev_b32_e64 v33, 16, v33
    v_mul_u32_u24 v34, 14, v33
    v_sub_u32 v34, v32, v34
    v_cmp_gt_u32 vcc, 12, v34
    v_mul_u32_u24 v33, 7168, v33
    v_lshl_add_u32 v33, v34, 4, v33
    v_cndmask_b32 v32, v36, v35, vcc
    v_add_u32 v33, v32, v33
    v_subrev_u32 v19, 2048, v33
    s_lshl_b32 s34, s38, 12
    s_nop 0
    s_mul_i32 s35, s38, 7168
    s_add_u32 s35, s35, 16384
    s_add_u32 s36, s35, 4096
    s_mul_i32 s43, s38, 4224
    s_mov_b32 s30, 0
    s_mov_b32 s31, 0
    s_mov_b32 s33, 90112
    s_add_u32 m0, s33, s34
    s_nop 0
    buffer_load_dwordx4 v9, s[12:15], s30 offen offset:0 nt lds
    buffer_load_dwordx4 v10, s[12:15], s30 offen offset:1024 nt lds
    buffer_load_dwordx4 v11, s[12:15], s30 offen offset:2048 nt lds
    buffer_load_dwordx4 v12, s[12:15], s30 offen offset:3072 nt lds
    s_add_u32 s30, s30, 524288
    s_lshr_b32 s61, s2, 3
    s_lshl_b32 s62, s61, 2
    s_add_u32 s62, s62, s38
    s_lshl_b32 s96, s62, 13
    s_and_b32 s63, s2, 7
    s_lshl_b32 s62, s63, 10
    s_add_u32 s96, s96, s62
    s_lshl_b32 s61, s61, 1
    s_and_b32 s62, s38, 1
    s_add_u32 s61, s61, s62
    s_mul_i32 s97, s61, 14336
    v_lshlrev_b32_e64 v32, 7, v0
    v_mov_b32 v33, 0x80000000
    v_cmp_gt_u32 vcc, 8, v0
    s_nop 1
    v_cndmask_b32 v38, v33, v32, vcc
    v_cmp_lt_u32 vcc, 6, v0
    s_nop 1
    v_cndmask_b32 v34, 0, 1, vcc
    v_mul_u32_u24 v35, 7, v34
    v_sub_u32 v35, v0, v35
    s_mul_i32 s61, s63, 768
    s_lshl_b32 s62, s63, 7
    s_add_u32 s62, s62, 5376
    v_mov_b32 v36, s61
    v_mov_b32_e64 v39, s62
    v_cmp_gt_u32 vcc, 6, v35
    s_nop 1
    v_cndmask_b32 v36, v39, v36, vcc
    v_lshl_add_u32 v36, v35, 7, v36
    v_mul_u32_u24 v34, 7168, v34
    v_add_u32 v36, v36, v34
    v_cmp_gt_u32 vcc, 14, v0
    s_nop 1
    v_cndmask_b32 v37, v33, v36, vcc
    buffer_load_dword a255, v38, s[12:15], s96 offen
    s_add_u32 s96, s96, 1048576
    buffer_load_dword a255, v37, s[16:19], s97 offen
    s_add_u32 s97, s97, 917504
    v_accvgpr_write_b32 a254, v37
    v_accvgpr_write_b32 a253, v38
    s_lshr_b32 s61, s38, 1
    s_lshl_b32 s62, s39, 1
    s_add_u32 s61, s61, s62
    s_lshl_b32 s61, s61, 8
    s_lshl_b32 s62, s40, 3
    s_add_u32 s61, s61, s62
    s_and_b32 s62, s38, 1
    s_lshl_b32 s62, s62, 2
    s_add_u32 s61, s61, s62
    s_add_u32 s55, s61, 41943040
    s_bfe_u32 s61, s2, 0x10002
    s_lshl_b32 s61, s61, 2
    s_and_b32 s62, s40, 3
    s_add_u32 s61, s61, s62
    s_lshl_b32 s62, s39, 3
    s_add_u32 s61, s61, s62
    s_lshl_b32 s61, s61, 2
    s_add_u32 s61, s61, s38
    s_lshl_b32 s61, s61, 8
    s_and_b32 s62, s2, 3
    s_lshl_b32 s62, s62, 2
    s_add_u32 s61, s61, s62
    s_add_u32 s61, s61, 42008576
    v_mov_b32 v32, 0
    v_lshlrev_b32 v33, 12, v0
    v_lshlrev_b32 v34, 7, v0
    s_mov_b64 exec, 3
    buffer_store_dword v32, v33, s[8:11], s55 offen sc1
    buffer_store_dword v32, v34, s[8:11], s61 offen sc1
    s_mov_b64 exec, -1
    v_lshlrev_b32 v43, 5, v40
    s_lshl_b32 s61, s38, 3
    v_add_u32 v44, s61, v43
    v_add_u32 v43, 143360, v43
    v_add_u32 v44, 143360, v44
    v_lshrrev_b32 v45, 2, v41
    v_lshlrev_b32 v45, 10, v45
    v_and_b32_e64 v46, 1, v41
    v_lshl_add_u32 v45, v46, 9, v45
    v_bfe_u32 v46, v41, 1, 1
    v_lshl_add_u32 v45, v46, 8, v45
    v_lshl_add_u32 v45, v40, 4, v45
    v_cmp_eq_u32 s[98:99], 1, v46
    s_lshr_b32 s61, s60, 1
    s_lshl_b32 s61, s61, 15
    s_lshl_b32 s62, s38, 13
    s_add_u32 s61, s61, s62
    s_and_b32 s62, s40, 1
    s_lshl_b32 s62, s62, 7
    s_add_u32 s61, s61, s62
    s_add_u32 s61, s61, 0
    s_add_u32 s62, s61, 4096
    v_mov_b32 v112, 0x3f803f80
    v_mov_b32 v96, 0
    v_mov_b32 v97, 0
    v_mov_b32 v98, 0
    v_mov_b32 v99, 0
    v_mov_b32 v100, 0
    v_mov_b32 v101, 0
    v_mov_b32 v102, 0
    v_mov_b32_e64 v103, 0
    s_waitcnt vmcnt(8)
    v_dot2_f32_bf16 v96, v48, v112, v96
    v_dot2_f32_bf16 v97, v48, v48, v97
    v_dot2_f32_bf16 v98, v49, v112, v98
    v_dot2_f32_bf16 v99, v49, v49, v99
    v_dot2_f32_bf16 v100, v50, v112, v100
    v_dot2_f32_bf16 v101, v50, v50, v101
    v_dot2_f32_bf16 v102, v51, v112, v102
    v_dot2_f32_bf16 v103, v51, v51, v103
    v_dot2_f32_bf16 v96, v52, v112, v96
    v_dot2_f32_bf16 v97, v52, v52, v97
    v_dot2_f32_bf16 v98, v53, v112, v98
    v_dot2_f32_bf16 v99, v53, v53, v99
    v_dot2_f32_bf16 v100, v54, v112, v100
    v_dot2_f32_bf16 v101, v54, v54, v101
    v_dot2_f32_bf16 v102, v55, v112, v102
    v_dot2_f32_bf16 v103, v55, v55, v103
    v_dot2_f32_bf16 v96, v56, v112, v96
    v_dot2_f32_bf16 v97, v56, v56, v97
    v_dot2_f32_bf16 v98, v57, v112, v98
    v_dot2_f32_bf16 v99, v57, v57, v99
    v_dot2_f32_bf16 v100, v58, v112, v100
    v_dot2_f32_bf16 v101, v58, v58, v101
    v_dot2_f32_bf16 v102, v59, v112, v102
    v_dot2_f32_bf16 v103, v59, v59, v103
    v_dot2_f32_bf16 v96, v60, v112, v96
    v_dot2_f32_bf16 v97, v60, v60, v97
    v_dot2_f32_bf16 v98, v61, v112, v98
    v_dot2_f32_bf16 v99, v61, v61, v99
    v_dot2_f32_bf16 v100, v62, v112, v100
    v_dot2_f32_bf16 v101, v62, v62, v101
    v_dot2_f32_bf16 v102, v63, v112, v102
    v_dot2_f32_bf16 v103, v63, v63, v103
    v_lshlrev_b32_e64 v64, 16, v48
    v_and_b32 v65, 0xffff0000, v48
    v_lshlrev_b32_e64 v66, 16, v49
    v_and_b32 v67, 0xffff0000, v49
    v_lshlrev_b32_e64 v68, 16, v50
    v_and_b32 v69, 0xffff0000, v50
    v_lshlrev_b32_e64 v70, 16, v51
    v_and_b32 v71, 0xffff0000, v51
    v_pk_add_f32 v[96:97], v[96:97], v[98:99]
    v_pk_add_f32 v[100:101], v[100:101], v[102:103]
    v_pk_add_f32 v[96:97], v[96:97], v[100:101]
    s_nop 1
    v_add_f32_dpp v96, v96, v96 quad_perm:[1,0,3,2] row_mask:0xf bank_mask:0xf
    v_add_f32_dpp v97, v97, v97 quad_perm:[1,0,3,2] row_mask:0xf bank_mask:0xf
    s_nop 0
    v_add_f32_dpp v96, v96, v96 quad_perm:[2,3,0,1] row_mask:0xf bank_mask:0xf
    v_add_f32_dpp v97, v97, v97 quad_perm:[2,3,0,1] row_mask:0xf bank_mask:0xf
    s_nop 0
    s_nop 0
    v_add_f32_dpp v96, v96, v96 row_half_mirror row_mask:0xf bank_mask:0xf
    v_add_f32_dpp v97, v97, v97 row_half_mirror row_mask:0xf bank_mask:0xf
    ds_write_b64 v44, v[96:97]
    v_lshlrev_b32_e64 v72, 16, v52
    v_and_b32 v73, 0xffff0000, v52
    v_lshlrev_b32_e64 v74, 16, v53
    v_and_b32 v75, 0xffff0000, v53
    v_lshlrev_b32_e64 v76, 16, v54
    v_and_b32 v77, 0xffff0000, v54
    v_lshlrev_b32_e64 v78, 16, v55
    v_and_b32 v79, 0xffff0000, v55
    v_lshlrev_b32_e64 v80, 16, v56
    v_and_b32 v81, 0xffff0000, v56
    v_lshlrev_b32_e64 v82, 16, v57
    v_and_b32 v83, 0xffff0000, v57
    v_lshlrev_b32_e64 v84, 16, v58
    v_and_b32 v85, 0xffff0000, v58
    v_lshlrev_b32_e64 v86, 16, v59
    v_and_b32 v87, 0xffff0000, v59
    v_lshlrev_b32_e64 v88, 16, v60
    v_and_b32 v89, 0xffff0000, v60
    v_lshlrev_b32_e64 v90, 16, v61
    v_and_b32 v91, 0xffff0000, v61
    v_lshlrev_b32_e64 v92, 16, v62
    v_and_b32 v93, 0xffff0000, v62
    v_lshlrev_b32_e64 v94, 16, v63
    v_and_b32 v95, 0xffff0000, v63
    s_waitcnt lgkmcnt(0)
    s_barrier
    ds_read_b128 v[96:99], v43
    ds_read_b128 v[100:103], v43 offset:16
    s_waitcnt lgkmcnt(0)
    s_nop 0
    v_pk_add_f32 v[96:97], v[96:97], v[98:99]
    v_pk_add_f32 v[100:101], v[100:101], v[102:103]
    v_pk_add_f32 v[96:97], v[96:97], v[100:101]
    v_mul_f32 v112, 0xba800000, v96
    v_mul_f32 v114, 0x3a800000, v97
    v_fma_f32 v114, -v112, v112, v114
    v_max_f32_e64 v114, 0, v114
    v_cvt_pk_bf16_f32 v115, v112, v114
    v_lshlrev_b32_e64 v112, 16, v115
    v_and_b32 v114, 0xffff0000, v115
    v_add_f32 v114, 0x3727c5ac, v114
    v_cvt_pk_bf16_f32 v114, v114, v114
    v_and_b32 v114, 0xffff0000, v114
    v_sqrt_f32 v114, v114
    s_nop 0
    v_cvt_pk_bf16_f32 v114, v114, v114
    v_and_b32 v114, 0xffff0000, v114
    v_rcp_f32 v114, v114
    v_mov_b32 v113, v112
    v_pk_add_f32 v[64:65], v[64:65], v[112:113]
    v_pk_add_f32 v[66:67], v[66:67], v[112:113]
    v_pk_add_f32 v[68:69], v[68:69], v[112:113]
    v_pk_add_f32 v[70:71], v[70:71], v[112:113]
    v_pk_add_f32 v[72:73], v[72:73], v[112:113]
    v_pk_add_f32 v[74:75], v[74:75], v[112:113]
    v_pk_add_f32 v[76:77], v[76:77], v[112:113]
    v_pk_add_f32 v[78:79], v[78:79], v[112:113]
    v_pk_add_f32 v[80:81], v[80:81], v[112:113]
    v_pk_add_f32 v[82:83], v[82:83], v[112:113]
    v_pk_add_f32 v[84:85], v[84:85], v[112:113]
    v_pk_add_f32 v[86:87], v[86:87], v[112:113]
    v_pk_add_f32 v[88:89], v[88:89], v[112:113]
    v_pk_add_f32 v[90:91], v[90:91], v[112:113]
    v_pk_add_f32 v[92:93], v[92:93], v[112:113]
    v_pk_add_f32 v[94:95], v[94:95], v[112:113]
    v_mov_b32_e64 v115, v114
    v_pk_mul_f32 v[64:65], v[64:65], v[114:115]
    v_pk_mul_f32 v[66:67], v[66:67], v[114:115]
    v_pk_mul_f32 v[68:69], v[68:69], v[114:115]
    v_pk_mul_f32 v[70:71], v[70:71], v[114:115]
    v_pk_mul_f32 v[72:73], v[72:73], v[114:115]
    v_pk_mul_f32 v[74:75], v[74:75], v[114:115]
    v_pk_mul_f32 v[76:77], v[76:77], v[114:115]
    v_pk_mul_f32 v[78:79], v[78:79], v[114:115]
    v_pk_mul_f32 v[80:81], v[80:81], v[114:115]
    v_pk_mul_f32 v[82:83], v[82:83], v[114:115]
    v_pk_mul_f32 v[84:85], v[84:85], v[114:115]
    v_pk_mul_f32 v[86:87], v[86:87], v[114:115]
    v_pk_mul_f32 v[88:89], v[88:89], v[114:115]
    v_pk_mul_f32 v[90:91], v[90:91], v[114:115]
    v_pk_mul_f32 v[92:93], v[92:93], v[114:115]
    v_pk_mul_f32 v[94:95], v[94:95], v[114:115]
    v_cvt_pk_bf16_f32 v48, v64, v65
    v_cvt_pk_bf16_f32 v49, v66, v67
    v_cvt_pk_bf16_f32 v50, v68, v69
    v_cvt_pk_bf16_f32 v51, v70, v71
    v_cvt_pk_bf16_f32 v52, v72, v73
    v_cvt_pk_bf16_f32 v53, v74, v75
    v_cvt_pk_bf16_f32 v54, v76, v77
    v_cvt_pk_bf16_f32 v55, v78, v79
    v_cvt_pk_bf16_f32 v56, v80, v81
    v_cvt_pk_bf16_f32 v57, v82, v83
    v_cvt_pk_bf16_f32 v58, v84, v85
    v_cvt_pk_bf16_f32 v59, v86, v87
    v_cvt_pk_bf16_f32 v60, v88, v89
    v_cvt_pk_bf16_f32 v61, v90, v91
    v_cvt_pk_bf16_f32 v62, v92, v93
    v_cvt_pk_bf16_f32 v63, v94, v95
    v_cndmask_b32 v100, v50, v48, s[98:99]
    v_cndmask_b32 v101, v51, v49, s[98:99]
    v_cndmask_b32 v108, v54, v52, s[98:99]
    v_cndmask_b32 v109, v55, v53, s[98:99]
    v_cndmask_b32 v116, v58, v56, s[98:99]
    v_cndmask_b32 v117, v59, v57, s[98:99]
    v_cndmask_b32 v124, v62, v60, s[98:99]
    v_cndmask_b32 v125, v63, v61, s[98:99]
    v_mov_b32_dpp v102, v100 quad_perm:[2,3,0,1] row_mask:0xf bank_mask:0xf
    v_mov_b32_dpp v103, v101 quad_perm:[2,3,0,1] row_mask:0xf bank_mask:0xf
    v_mov_b32_dpp v110, v108 quad_perm:[2,3,0,1] row_mask:0xf bank_mask:0xf
    v_mov_b32_dpp v111, v109 quad_perm:[2,3,0,1] row_mask:0xf bank_mask:0xf
    v_mov_b32_dpp v118, v116 quad_perm:[2,3,0,1] row_mask:0xf bank_mask:0xf
    v_mov_b32_dpp v119, v117 quad_perm:[2,3,0,1] row_mask:0xf bank_mask:0xf
    v_mov_b32_dpp v126, v124 quad_perm:[2,3,0,1] row_mask:0xf bank_mask:0xf
    v_mov_b32_dpp v127, v125 quad_perm:[2,3,0,1] row_mask:0xf bank_mask:0xf
    v_cndmask_b32 v96, v48, v102, s[98:99]
    v_cndmask_b32 v97, v49, v103, s[98:99]
    v_cndmask_b32 v98, v102, v50, s[98:99]
    v_cndmask_b32 v99, v103, v51, s[98:99]
    buffer_store_dwordx4 v[96:99], v45, s[8:11], s61 offen offset:0 sc1
    v_cndmask_b32 v104, v52, v110, s[98:99]
    v_cndmask_b32 v105, v53, v111, s[98:99]
    v_cndmask_b32 v106, v110, v54, s[98:99]
    v_cndmask_b32 v107, v111, v55, s[98:99]
    buffer_store_dwordx4 v[104:107], v45, s[8:11], s61 offen offset:2048 sc1
    v_cndmask_b32 v112, v56, v118, s[98:99]
    v_cndmask_b32 v113, v57, v119, s[98:99]
    v_cndmask_b32 v114, v118, v58, s[98:99]
    v_cndmask_b32 v115, v119, v59, s[98:99]
    buffer_store_dwordx4 v[112:115], v45, s[8:11], s62 offen offset:0 sc1
    v_cndmask_b32 v120, v60, v126, s[98:99]
    v_cndmask_b32 v121, v61, v127, s[98:99]
    v_cndmask_b32 v122, v126, v62, s[98:99]
    v_cndmask_b32 v123, v127, v63, s[98:99]
    buffer_store_dwordx4 v[120:123], v45, s[8:11], s62 offen offset:2048 sc1
    s_lshr_b32 s61, s40, 3
    s_lshl_b32 s61, s61, 19
    s_add_u32 s61, s61, 393216
    s_add_u32 s64, s64, s61
    s_addc_u32 s65, s65, 0
    s_mov_b32 s20, s64
    s_nop 0
    s_and_b32 s21, s65, 0xffff
    s_mov_b32 s22, 131072
    s_mov_b32 s23, 0x20000
    s_sub_u32 s61, s61, 2048
    s_add_u32 s66, s66, s61
    s_addc_u32 s67, s67, 0
    s_mov_b32 s24, s66
    s_nop 0
    s_and_b32 s25, s67, 0xffff
    s_mov_b32 s26, 133120
    s_mov_b32 s27, 0x20000
    s_mov_b32 s41, 0
    s_mov_b32 s42, 0
    s_lshl_b32 s59, s39, 4
    s_lshl_b32 s61, s38, 2
    s_add_u32 s59, s59, s61
    s_lshl_b32 s61, s59, 15
    v_add_u32_e64 v7, s61, v20
    v_add_u32 v8, 0x8000, v7
    s_mov_b32 s28, 0
    s_mov_b32 s29, 65536
    v_mov_b32 v34, 0
    v_and_b32 v31, 31, v0
    v_lshlrev_b32_e64 v31, 3, v31
    s_lshl_b32 s60, s60, 3
    s_add_u32 s60, s60, 41951232
    s_lshl_b32 s63, s39, 8
    s_add_u32 s63, s63, 41951232
    s_waitcnt vmcnt(0)
    s_barrier
    s_cmp_lg_u32 s38, 0
    s_cbranch_scc1 L_nosig
    s_memrealtime s[6:7]
    s_waitcnt lgkmcnt(0)
    v_mov_b32 v32, s6
    v_mov_b32_e64 v33, s7
    s_mov_b64 exec, 1
    buffer_store_dwordx2 v[32:33], v34, s[8:11], s60 offen sc1
    s_mov_b64 exec, -1
L_nosig:
    s_add_u32 m0, s33, s35
    s_nop 0
    s_nop 0
    buffer_load_dwordx4 v13, s[16:19], s31 offen offset:0 nt lds
    buffer_load_dwordx4 v14, s[16:19], s31 offen offset:1024 nt lds
    buffer_load_dwordx4 v15, s[16:19], s31 offen offset:2048 nt lds
    buffer_load_dwordx4 v16, s[16:19], s31 offen offset:3072 nt lds
    s_add_u32 m0, s33, s36
    s_nop 0
    buffer_load_dwordx4 v17, s[16:19], s31 offen offset:0 nt lds
    buffer_load_dwordx4 v18, s[16:19], s31 offen offset:1024 nt lds
    buffer_load_dwordx4 v19, s[16:19], s31 offen offset:2048 nt lds
    s_add_u32 s31, s31, 458752
    s_mov_b32 s33, 0
    s_add_u32 m0, s33, s34
    s_nop 0
    s_nop 0
    buffer_load_dwordx4 v9, s[12:15], s30 offen offset:0 nt lds
    buffer_load_dwordx4 v10, s[12:15], s30 offen offset:1024 nt lds
    buffer_load_dwordx4 v11, s[12:15], s30 offen offset:2048 nt lds
    buffer_load_dwordx4 v12, s[12:15], s30 offen offset:3072 nt lds
    s_add_u32 s30, s30, 524288
    s_add_u32 m0, s33, s35
    s_nop 0
    buffer_load_dwordx4 v13, s[16:19], s31 offen offset:0 nt lds
    buffer_load_dwordx4 v14, s[16:19], s31 offen offset:1024 nt lds
    buffer_load_dwordx4 v15, s[16:19], s31 offen offset:2048 nt lds
    buffer_load_dwordx4 v16, s[16:19], s31 offen offset:3072 nt lds
    s_add_u32 m0, s33, s36
    s_nop 0
    buffer_load_dwordx4 v17, s[16:19], s31 offen offset:0 nt lds
    buffer_load_dwordx4 v18, s[16:19], s31 offen offset:1024 nt lds
    buffer_load_dwordx4 v19, s[16:19], s31 offen offset:2048 nt lds
    s_add_u32 s31, s31, 458752
    buffer_load_dword a255, v38, s[12:15], s96 offen
    s_add_u32 s96, s96, 1048576
    buffer_load_dword a255, v37, s[16:19], s97 offen
    s_add_u32 s97, s97, 917504
    s_mul_i32 s61, s59, 131072
    s_mul_i32 s62, s40, 3072
    s_add_u32 s61, s61, s62
    s_nop 0
    s_add_u32 s44, s61, 20971520
    s_add_u32 s45, s44, 131072
    s_add_u32 s46, s45, 131072
    s_add_u32 s47, s46, 131072
    s_lshr_b32 s61, s40, 1
    s_add_u32 s61, s61, 96
    s_lshl_b32 s61, s61, 10
    s_sub_u32 s61, s61, s62
    s_and_b32 s62, s40, 1
    s_lshl_b32 s62, s62, 3
    s_add_u32 s61, s61, s62
    v_add_u32 v29, s61, v20
    s_lshl_b32 s61, s59, 17
    s_lshl_b32 s62, s40, 12
    s_add_u32 s61, s61, s62
    s_add_u32 s48, s61, 4194304
    s_add_u32 s49, s48, 262144
    v_and_b32_e64 v32, 15, v0
    v_bfe_u32 v33, v0, 4, 1
    v_lshrrev_b32_e64 v35, 5, v0
    v_add_u32 v30, 0x20000, v20
    v_bfe_u32 v34, v0, 2, 2
    v_and_b32 v32, 3, v0
    v_lshrrev_b32 v36, 4, v0
    v_lshlrev_b32_e64 v4, 3, v32
    v_lshl_add_u32 v4, v34, 6, v4
    v_lshl_add_u32 v4, v36, 10, v4
    v_lshl_add_u32 v4, v33, 5, v4
    v_xor_b32_e64 v5, 32, v4
    v_lshl_add_u32 v36, v36, 2, v34
    v_mul_u32_u24 v36, 224, v36
    v_lshl_add_u32 v36, v32, 3, v36
    v_add_u32 v6, 16384, v36
    v_mul_u32_u24 v36, 4224, v35
    v_lshl_add_u32 v36, v33, 10, v36
    v_lshl_add_u32 v36, v34, 6, v36
    v_lshl_add_u32 v36, v32, 3, v36
    v_lshl_add_u32 v36, v33, 5, v36
    v_add_u32 v27, 2048, v36
    v_xor_b32_e64 v28, 32, v27
    v_bfe_u32 v32, v0, 3, 1
    v_mul_u32_u24 v32, 4224, v32
    v_and_b32_e64 v33, 7, v0
    v_lshl_add_u32 v32, v33, 8, v32
    v_lshrrev_b32 v36, 4, v0
    v_add_u32 v34, 0, v36
    v_xor_b32_e64 v34, v34, v33
    v_lshl_add_u32 v24, v34, 4, v32
    v_add_u32 v34, 4, v36
    v_xor_b32 v34, v34, v33
    v_lshl_add_u32 v25, v34, 4, v32
    s_mov_b32 s32, 90112
    v_add_u32 v1, s32, v4
    v_add_u32 v2, s32, v5
    v_add_u32 v3, s32, v6
    v_mov_b64 v[36:37], 0
    v_mov_b64 v[38:39], 0
    v_mov_b64 v[40:41], 0
    v_mov_b64 v[42:43], 0
    v_mov_b64 v[44:45], 0
    v_mov_b64 v[46:47], 0
    v_mov_b64 v[48:49], 0
    v_mov_b64 v[50:51], 0
    v_mov_b64 v[52:53], 0
    v_mov_b64 v[54:55], 0
    v_mov_b64 v[56:57], 0
    v_mov_b64 v[58:59], 0
    v_mov_b64 v[60:61], 0
    v_mov_b64 v[62:63], 0
    v_mov_b64 v[64:65], 0
    v_mov_b64 v[66:67], 0
    v_mov_b64 v[68:69], 0
    v_mov_b64 v[70:71], 0
    v_mov_b64 v[72:73], 0
    v_mov_b64 v[74:75], 0
    v_mov_b64 v[76:77], 0
    v_mov_b64 v[78:79], 0
    v_mov_b64 v[80:81], 0
    v_mov_b64 v[82:83], 0
    v_mov_b64 v[84:85], 0
    v_mov_b64 v[86:87], 0
    v_mov_b64 v[88:89], 0
    v_mov_b64 v[90:91], 0
    v_mov_b64 v[92:93], 0
    v_mov_b64 v[94:95], 0
    v_mov_b64 v[96:97], 0
    v_mov_b64 v[98:99], 0
    v_mov_b64 v[100:101], 0
    v_mov_b64 v[102:103], 0
    v_mov_b64 v[104:105], 0
    v_mov_b64 v[106:107], 0
    v_mov_b64 v[108:109], 0
    v_mov_b64 v[110:111], 0
    v_mov_b64 v[112:113], 0
    v_mov_b64 v[114:115], 0
    v_mov_b64 v[116:117], 0
    v_mov_b64 v[118:119], 0
    v_mov_b64 v[120:121], 0
    v_mov_b64 v[122:123], 0
    v_mov_b64 v[124:125], 0
    v_mov_b64 v[126:127], 0
    v_mov_b64 v[128:129], 0
    v_mov_b64 v[130:131], 0
    v_mov_b64 v[132:133], 0
    v_mov_b64 v[134:135], 0
    v_mov_b64 v[136:137], 0
    v_mov_b64 v[138:139], 0
    v_mov_b64 v[140:141], 0
    v_mov_b64 v[142:143], 0
    v_mov_b64 v[144:145], 0
    v_mov_b64 v[146:147], 0
    v_mov_b64 v[148:149], 0
    v_mov_b64 v[150:151], 0
    v_mov_b64 v[152:153], 0
    v_mov_b64 v[154:155], 0
    v_mov_b64 v[156:157], 0
    v_mov_b64 v[158:159], 0
    v_mov_b64 v[160:161], 0
    v_mov_b64 v[162:163], 0
    v_mov_b64 v[164:165], 0
    v_mov_b64 v[166:167], 0
    v_mov_b64 v[168:169], 0
    v_mov_b64 v[170:171], 0
    v_mov_b64 v[172:173], 0
    v_mov_b64 v[174:175], 0
    v_mov_b64 v[176:177], 0
    v_mov_b64 v[178:179], 0
    v_mov_b64 v[180:181], 0
    v_mov_b64 v[182:183], 0
    v_mov_b64 v[184:185], 0
    v_mov_b64 v[186:187], 0
    v_mov_b64 v[188:189], 0
    v_mov_b64 v[190:191], 0
    v_mov_b64 v[192:193], 0
    v_mov_b64 v[194:195], 0
    v_mov_b64 v[196:197], 0
    v_mov_b64 v[198:199], 0
    v_mov_b64 v[200:201], 0
    v_mov_b64 v[202:203], 0
    v_mov_b64 v[204:205], 0
    v_mov_b64 v[206:207], 0
    v_mov_b64 v[208:209], 0
    v_mov_b64 v[210:211], 0
    v_mov_b64 v[212:213], 0
    v_mov_b64 v[214:215], 0
    v_mov_b64 v[216:217], 0
    v_mov_b64 v[218:219], 0
    v_mov_b64 v[220:221], 0
    v_mov_b64 v[222:223], 0
    v_mov_b64 v[224:225], 0
    v_mov_b64 v[226:227], 0
    v_mov_b64 v[228:229], 0
    v_mov_b64 v[230:231], 0
    v_mov_b64 v[232:233], 0
    v_mov_b64 v[234:235], 0
    v_mov_b64 v[236:237], 0
    v_mov_b64 v[238:239], 0
    v_mov_b64 v[240:241], 0
    v_mov_b64 v[242:243], 0
    v_mov_b64 v[244:245], 0
    v_mov_b64 v[246:247], 0
    v_mov_b64 v[248:249], 0
    v_mov_b64 v[250:251], 0
    v_mov_b64 v[252:253], 0
    v_mov_b64_e64 v[254:255], 0
    v_accvgpr_write_b32 a0, 0
    v_accvgpr_write_b32 a1, 0
    v_accvgpr_write_b32 a2, 0
    v_accvgpr_write_b32 a3, 0
    v_accvgpr_write_b32 a4, 0
    v_accvgpr_write_b32 a5, 0
    v_accvgpr_write_b32 a6, 0
    v_accvgpr_write_b32 a7, 0
    v_accvgpr_write_b32 a8, 0
    v_accvgpr_write_b32 a9, 0
    v_accvgpr_write_b32 a10, 0
    v_accvgpr_write_b32 a11, 0
    v_accvgpr_write_b32 a12, 0
    v_accvgpr_write_b32 a13, 0
    v_accvgpr_write_b32 a14, 0
    v_accvgpr_write_b32 a15, 0
    v_accvgpr_write_b32 a16, 0
    v_accvgpr_write_b32 a17, 0
    v_accvgpr_write_b32 a18, 0
    v_accvgpr_write_b32 a19, 0
    v_accvgpr_write_b32 a20, 0
    v_accvgpr_write_b32 a21, 0
    v_accvgpr_write_b32 a22, 0
    v_accvgpr_write_b32 a23, 0
    v_accvgpr_write_b32 a24, 0
    v_accvgpr_write_b32 a25, 0
    v_accvgpr_write_b32 a26, 0
    v_accvgpr_write_b32 a27, 0
    v_accvgpr_write_b32 a28, 0
    v_accvgpr_write_b32 a29, 0
    v_accvgpr_write_b32 a30, 0
    v_accvgpr_write_b32 a31, 0
    v_accvgpr_write_b32 a32, 0
    v_accvgpr_write_b32 a33, 0
    v_accvgpr_write_b32 a34, 0
    v_accvgpr_write_b32 a35, 0
    v_accvgpr_write_b32 a36, 0
    v_accvgpr_write_b32 a37, 0
    v_accvgpr_write_b32 a38, 0
    v_accvgpr_write_b32 a39, 0
    v_accvgpr_write_b32 a40, 0
    v_accvgpr_write_b32 a41, 0
    v_accvgpr_write_b32 a42, 0
    v_accvgpr_write_b32 a43, 0
    v_accvgpr_write_b32 a44, 0
    v_accvgpr_write_b32 a45, 0
    v_accvgpr_write_b32 a46, 0
    v_accvgpr_write_b32 a47, 0
    v_accvgpr_write_b32 a48, 0
    v_accvgpr_write_b32 a49, 0
    v_accvgpr_write_b32 a50, 0
    v_accvgpr_write_b32 a51, 0
    v_accvgpr_write_b32 a52, 0
    v_accvgpr_write_b32 a53, 0
    v_accvgpr_write_b32 a54, 0
    v_accvgpr_write_b32 a55, 0
    v_accvgpr_write_b32 a56, 0
    v_accvgpr_write_b32 a57, 0
    v_accvgpr_write_b32 a58, 0
    v_accvgpr_write_b32 a59, 0
    v_accvgpr_write_b32 a60, 0
    v_accvgpr_write_b32 a61, 0
    v_accvgpr_write_b32 a62, 0
    v_accvgpr_write_b32 a63, 0
    v_accvgpr_write_b32 a64, 0
    v_accvgpr_write_b32 a65, 0
    v_accvgpr_write_b32 a66, 0
    v_accvgpr_write_b32 a67, 0
    v_accvgpr_write_b32 a68, 0
    v_accvgpr_write_b32 a69, 0
    v_accvgpr_write_b32 a70, 0
    v_accvgpr_write_b32 a71, 0
    v_accvgpr_write_b32 a72, 0
    v_accvgpr_write_b32 a73, 0
    v_accvgpr_write_b32 a74, 0
    v_accvgpr_write_b32 a75, 0
    v_accvgpr_write_b32 a76, 0
    v_accvgpr_write_b32 a77, 0
    v_accvgpr_write_b32 a78, 0
    v_accvgpr_write_b32 a79, 0
    v_accvgpr_write_b32 a80, 0
    v_accvgpr_write_b32 a81, 0
    v_accvgpr_write_b32 a82, 0
    v_accvgpr_write_b32 a83, 0
    v_accvgpr_write_b32 a84, 0
    v_accvgpr_write_b32 a85, 0
    v_accvgpr_write_b32 a86, 0
    v_accvgpr_write_b32 a87, 0
    v_accvgpr_write_b32 a88, 0
    v_accvgpr_write_b32 a89, 0
    v_accvgpr_write_b32 a90, 0
    v_accvgpr_write_b32 a91, 0
    v_accvgpr_write_b32 a92, 0
    v_accvgpr_write_b32 a93, 0
    v_accvgpr_write_b32 a94, 0
    v_accvgpr_write_b32 a95, 0
    v_accvgpr_write_b32 a96, 0
    v_accvgpr_write_b32 a97, 0
    v_accvgpr_write_b32 a98, 0
    v_accvgpr_write_b32 a99, 0
    v_accvgpr_write_b32 a100, 0
    v_accvgpr_write_b32 a101, 0
    v_accvgpr_write_b32 a102, 0
    v_accvgpr_write_b32 a103, 0
    v_accvgpr_write_b32 a104, 0
    v_accvgpr_write_b32 a105, 0
    v_accvgpr_write_b32 a106, 0
    v_accvgpr_write_b32 a107, 0
    v_accvgpr_write_b32 a108, 0
    v_accvgpr_write_b32 a109, 0
    v_accvgpr_write_b32 a110, 0
    v_accvgpr_write_b32 a111, 0
    v_accvgpr_write_b32 a112, 0
    v_accvgpr_write_b32 a113, 0
    v_accvgpr_write_b32 a114, 0
    v_accvgpr_write_b32 a115, 0
    v_accvgpr_write_b32 a116, 0
    v_accvgpr_write_b32 a117, 0
    v_accvgpr_write_b32 a118, 0
    v_accvgpr_write_b32 a119, 0
    v_accvgpr_write_b32 a120, 0
    v_accvgpr_write_b32 a121, 0
    v_accvgpr_write_b32 a122, 0
    v_accvgpr_write_b32 a123, 0
    v_accvgpr_write_b32 a124, 0
    v_accvgpr_write_b32 a125, 0
    v_accvgpr_write_b32 a126, 0
    v_accvgpr_write_b32 a127, 0
    s_mov_b32 s52, 0x3e0293ee
    s_mov_b32 s53, 0x3e0293ee
    s_cmp_lg_u32 s38, 0
    s_cbranch_scc1 L_pollx_done
    s_mov_b32 s60, 1048576
    v_mov_b32_e64 v35, s5
L_pollx:
    buffer_load_dwordx2 v[32:33], v31, s[8:11], s63 offen sc1
    s_sub_u32 s60, s60, 1
    s_cbranch_scc1 L_pollx_done
    s_waitcnt vmcnt(0)
    v_subrev_co_u32 v34, vcc, s4, v32
    s_nop 1
    v_subb_co_u32 v34, vcc, v33, v35, vcc
    v_cmp_ne_u32 vcc, 0, v34
    s_cbranch_vccnz L_pollx
L_pollx_done:
    v_mov_b64 v[32:33], 0
    v_mov_b64 v[34:35], 0
    v_accvgpr_read_b32 v31, a254
    v_accvgpr_read_b32 v0, a253
    s_waitcnt vmcnt(13)
    s_barrier
    buffer_load_dwordx4 a[128:131], v7, s[8:11], s28 offen offset:0 sc1
    buffer_load_dwordx4 a[132:135], v8, s[8:11], s28 offen offset:0 sc1
    buffer_load_dwordx4 a[136:139], v7, s[8:11], s29 offen offset:0 sc1
    buffer_load_dwordx4 a[140:143], v8, s[8:11], s29 offen offset:0 sc1
    buffer_load_dwordx4 a[144:147], v7, s[8:11], s28 offen offset:1024 sc1
    buffer_load_dwordx4 a[148:151], v8, s[8:11], s28 offen offset:1024 sc1
    buffer_load_dwordx4 a[152:155], v7, s[8:11], s29 offen offset:1024 sc1
    buffer_load_dwordx4 a[156:159], v8, s[8:11], s29 offen offset:1024 sc1
    s_mov_b32 s33, 45056
    ds_read_b64_tr_b16 a[192:193], v1 offset:0
    ds_read_b64_tr_b16 a[194:195], v1 offset:4096
    ds_read_b64_tr_b16 a[196:197], v1 offset:8192
    ds_read_b64_tr_b16 a[198:199], v1 offset:12288
    ds_read_b64_tr_b16 a[200:201], v2 offset:0
    ds_read_b64_tr_b16 a[202:203], v2 offset:4096
    ds_read_b64_tr_b16 a[204:205], v2 offset:8192
    ds_read_b64_tr_b16 a[206:207], v2 offset:12288
    s_mov_b32 s37, 7
    s_waitcnt vmcnt(0)
L_g1:
    s_waitcnt vmcnt(16) lgkmcnt(4)
    s_waitcnt vmcnt(12)
    v_mfma_f32_16x16x32_bf16 a[0:3], a[192:195], a[128:131], a[0:3]
    ds_read_b64_tr_b16 a[208:209], v1 offset:256
    v_mfma_f32_16x16x32_bf16 a[0:3], a[196:199], a[144:147], a[0:3]
    ds_read_b64_tr_b16 a[210:211], v1 offset:4352
    v_mfma_f32_16x16x32_bf16 a[4:7], a[196:199], a[148:151], a[4:7]
    buffer_load_dwordx4 a[160:163], v7, s[8:11], s28 offen offset:2048 sc1
    v_mfma_f32_16x16x32_bf16 a[4:7], a[192:195], a[132:135], a[4:7]
    v_mfma_f32_16x16x32_bf16 a[8:11], a[192:195], a[136:139], a[8:11]
    ds_read_b64_tr_b16 a[212:213], v1 offset:8448
    v_mfma_f32_16x16x32_bf16 a[8:11], a[196:199], a[152:155], a[8:11]
    ds_read_b64_tr_b16 a[214:215], v1 offset:12544
    v_mfma_f32_16x16x32_bf16 a[12:15], a[196:199], a[156:159], a[12:15]
    v_mfma_f32_16x16x32_bf16 a[12:15], a[192:195], a[140:143], a[12:15]
    s_waitcnt lgkmcnt(4)
    v_mfma_f32_16x16x32_bf16 a[16:19], a[200:203], a[128:131], a[16:19]
    ds_read_b64_tr_b16 a[216:217], v2 offset:256
    v_mfma_f32_16x16x32_bf16 a[16:19], a[204:207], a[144:147], a[16:19]
    ds_read_b64_tr_b16 a[218:219], v2 offset:4352
    v_mfma_f32_16x16x32_bf16 a[20:23], a[204:207], a[148:151], a[20:23]
    buffer_load_dwordx4 a[164:167], v8, s[8:11], s28 offen offset:2048 sc1
    v_mfma_f32_16x16x32_bf16 a[20:23], a[200:203], a[132:135], a[20:23]
    v_mfma_f32_16x16x32_bf16 a[24:27], a[200:203], a[136:139], a[24:27]
    ds_read_b64_tr_b16 a[220:221], v2 offset:8448
    v_mfma_f32_16x16x32_bf16 a[24:27], a[204:207], a[152:155], a[24:27]
    ds_read_b64_tr_b16 a[222:223], v2 offset:12544
    v_mfma_f32_16x16x32_bf16 a[28:31], a[204:207], a[156:159], a[28:31]
    v_mfma_f32_16x16x32_bf16 a[28:31], a[200:203], a[140:143], a[28:31]
    s_waitcnt lgkmcnt(4)
    v_mfma_f32_16x16x32_bf16 a[32:35], a[208:211], a[128:131], a[32:35]
    ds_read_b64_tr_b16 a[192:193], v1 offset:512
    v_mfma_f32_16x16x32_bf16 a[32:35], a[212:215], a[144:147], a[32:35]
    ds_read_b64_tr_b16 a[194:195], v1 offset:4608
    v_mfma_f32_16x16x32_bf16 a[36:39], a[212:215], a[148:151], a[36:39]
    buffer_load_dwordx4 a[168:171], v7, s[8:11], s29 offen offset:2048 sc1
    v_mfma_f32_16x16x32_bf16 a[36:39], a[208:211], a[132:135], a[36:39]
    v_mfma_f32_16x16x32_bf16 a[40:43], a[208:211], a[136:139], a[40:43]
    ds_read_b64_tr_b16 a[196:197], v1 offset:8704
    v_mfma_f32_16x16x32_bf16 a[40:43], a[212:215], a[152:155], a[40:43]
    ds_read_b64_tr_b16 a[198:199], v1 offset:12800
    v_mfma_f32_16x16x32_bf16 a[44:47], a[212:215], a[156:159], a[44:47]
    v_mfma_f32_16x16x32_bf16 a[44:47], a[208:211], a[140:143], a[44:47]
    s_waitcnt lgkmcnt(4)
    v_mfma_f32_16x16x32_bf16 a[48:51], a[216:219], a[128:131], a[48:51]
    ds_read_b64_tr_b16 a[200:201], v2 offset:512
    v_mfma_f32_16x16x32_bf16 a[48:51], a[220:223], a[144:147], a[48:51]
    ds_read_b64_tr_b16 a[202:203], v2 offset:4608
    v_mfma_f32_16x16x32_bf16 a[52:55], a[220:223], a[148:151], a[52:55]
    buffer_load_dwordx4 a[172:175], v8, s[8:11], s29 offen offset:2048 sc1
    v_mfma_f32_16x16x32_bf16 a[52:55], a[216:219], a[132:135], a[52:55]
    v_mfma_f32_16x16x32_bf16 a[56:59], a[216:219], a[136:139], a[56:59]
    ds_read_b64_tr_b16 a[204:205], v2 offset:8704
    v_mfma_f32_16x16x32_bf16 a[56:59], a[220:223], a[152:155], a[56:59]
    ds_read_b64_tr_b16 a[206:207], v2 offset:12800
    v_mfma_f32_16x16x32_bf16 a[60:63], a[220:223], a[156:159], a[60:63]
    v_mfma_f32_16x16x32_bf16 a[60:63], a[216:219], a[140:143], a[60:63]
    s_waitcnt lgkmcnt(4)
    v_mfma_f32_16x16x32_bf16 a[64:67], a[192:195], a[128:131], a[64:67]
    ds_read_b64_tr_b16 a[208:209], v1 offset:768
    v_mfma_f32_16x16x32_bf16 a[64:67], a[196:199], a[144:147], a[64:67]
    ds_read_b64_tr_b16 a[210:211], v1 offset:4864
    v_mfma_f32_16x16x32_bf16 a[68:71], a[196:199], a[148:151], a[68:71]
    v_mfma_f32_16x16x32_bf16 a[68:71], a[192:195], a[132:135], a[68:71]
    v_mfma_f32_16x16x32_bf16 a[72:75], a[192:195], a[136:139], a[72:75]
    ds_read_b64_tr_b16 a[212:213], v1 offset:8960
    v_mfma_f32_16x16x32_bf16 a[72:75], a[196:199], a[152:155], a[72:75]
    ds_read_b64_tr_b16 a[214:215], v1 offset:13056
    v_mfma_f32_16x16x32_bf16 a[76:79], a[196:199], a[156:159], a[76:79]
    buffer_load_dwordx4 a[176:179], v7, s[8:11], s28 offen offset:3072 sc1
    v_mfma_f32_16x16x32_bf16 a[76:79], a[192:195], a[140:143], a[76:79]
    s_waitcnt lgkmcnt(4)
    v_mfma_f32_16x16x32_bf16 a[80:83], a[200:203], a[128:131], a[80:83]
    ds_read_b64_tr_b16 a[216:217], v2 offset:768
    v_mfma_f32_16x16x32_bf16 a[80:83], a[204:207], a[144:147], a[80:83]
    ds_read_b64_tr_b16 a[218:219], v2 offset:4864
    v_mfma_f32_16x16x32_bf16 a[84:87], a[204:207], a[148:151], a[84:87]
    v_mfma_f32_16x16x32_bf16 a[84:87], a[200:203], a[132:135], a[84:87]
    v_mfma_f32_16x16x32_bf16 a[88:91], a[200:203], a[136:139], a[88:91]
    ds_read_b64_tr_b16 a[220:221], v2 offset:8960
    v_mfma_f32_16x16x32_bf16 a[88:91], a[204:207], a[152:155], a[88:91]
    ds_read_b64_tr_b16 a[222:223], v2 offset:13056
    v_mfma_f32_16x16x32_bf16 a[92:95], a[204:207], a[156:159], a[92:95]
    buffer_load_dwordx4 a[180:183], v8, s[8:11], s28 offen offset:3072 sc1
    v_mfma_f32_16x16x32_bf16 a[92:95], a[200:203], a[140:143], a[92:95]
    s_waitcnt lgkmcnt(4)
    v_mfma_f32_16x16x32_bf16 a[96:99], a[208:211], a[128:131], a[96:99]
    ds_read_b64_tr_b16 a[192:193], v3 offset:0
    v_mfma_f32_16x16x32_bf16 a[96:99], a[212:215], a[144:147], a[96:99]
    ds_read_b64_tr_b16 a[194:195], v3 offset:3584
    v_mfma_f32_16x16x32_bf16 a[100:103], a[212:215], a[148:151], a[100:103]
    v_mfma_f32_16x16x32_bf16 a[100:103], a[208:211], a[132:135], a[100:103]
    v_mfma_f32_16x16x32_bf16 a[104:107], a[208:211], a[136:139], a[104:107]
    ds_read_b64_tr_b16 a[196:197], v3 offset:7168
    v_mfma_f32_16x16x32_bf16 a[104:107], a[212:215], a[152:155], a[104:107]
    ds_read_b64_tr_b16 a[198:199], v3 offset:10752
    v_mfma_f32_16x16x32_bf16 a[108:111], a[212:215], a[156:159], a[108:111]
    buffer_load_dwordx4 a[184:187], v7, s[8:11], s29 offen offset:3072 sc1
    v_mfma_f32_16x16x32_bf16 a[108:111], a[208:211], a[140:143], a[108:111]
    s_waitcnt lgkmcnt(4)
    v_mfma_f32_16x16x32_bf16 a[112:115], a[216:219], a[128:131], a[112:115]
    ds_read_b64_tr_b16 a[200:201], v3 offset:14336
    v_mfma_f32_16x16x32_bf16 a[112:115], a[220:223], a[144:147], a[112:115]
    ds_read_b64_tr_b16 a[202:203], v3 offset:17920
    v_mfma_f32_16x16x32_bf16 a[116:119], a[220:223], a[148:151], a[116:119]
    v_mfma_f32_16x16x32_bf16 a[116:119], a[216:219], a[132:135], a[116:119]
    v_mfma_f32_16x16x32_bf16 a[120:123], a[216:219], a[136:139], a[120:123]
    ds_read_b64_tr_b16 a[204:205], v3 offset:21504
    v_mfma_f32_16x16x32_bf16 a[120:123], a[220:223], a[152:155], a[120:123]
    ds_read_b64_tr_b16 a[206:207], v3 offset:25088
    v_mfma_f32_16x16x32_bf16 a[124:127], a[220:223], a[156:159], a[124:127]
    buffer_load_dwordx4 a[188:191], v8, s[8:11], s29 offen offset:3072 sc1
    v_mfma_f32_16x16x32_bf16 a[124:127], a[216:219], a[140:143], a[124:127]
    s_waitcnt lgkmcnt(4)
    v_mfma_f32_16x16x32_bf16 v[32:35], a[192:195], a[128:131], v[32:35]
    ds_read_b64_tr_b16 a[208:209], v3 offset:32
    s_add_u32 s28, s28, 4096
    v_mfma_f32_16x16x32_bf16 v[32:35], a[196:199], a[144:147], v[32:35]
    ds_read_b64_tr_b16 a[210:211], v3 offset:3616
    s_add_u32 s29, s29, 4096
    v_mfma_f32_16x16x32_bf16 v[36:39], a[196:199], a[148:151], v[36:39]
    v_mfma_f32_16x16x32_bf16 v[36:39], a[192:195], a[132:135], v[36:39]
    v_mfma_f32_16x16x32_bf16 v[40:43], a[192:195], a[136:139], v[40:43]
    ds_read_b64_tr_b16 a[212:213], v3 offset:7200
    v_mfma_f32_16x16x32_bf16 v[40:43], a[196:199], a[152:155], v[40:43]
    ds_read_b64_tr_b16 a[214:215], v3 offset:10784
    v_mfma_f32_16x16x32_bf16 v[44:47], a[196:199], a[156:159], v[44:47]
    s_add_u32 m0, s33, s34
    v_mfma_f32_16x16x32_bf16 v[44:47], a[192:195], a[140:143], v[44:47]
    s_waitcnt lgkmcnt(4)
    v_mfma_f32_16x16x32_bf16 v[48:51], a[200:203], a[128:131], v[48:51]
    ds_read_b64_tr_b16 a[216:217], v3 offset:14368
    v_mfma_f32_16x16x32_bf16 v[48:51], a[204:207], a[144:147], v[48:51]
    ds_read_b64_tr_b16 a[218:219], v3 offset:17952
    v_mfma_f32_16x16x32_bf16 v[52:55], a[204:207], a[148:151], v[52:55]
    buffer_load_dwordx4 v9, s[12:15], s30 offen offset:0 lds
    v_mfma_f32_16x16x32_bf16 v[52:55], a[200:203], a[132:135], v[52:55]
    v_mfma_f32_16x16x32_bf16 v[56:59], a[200:203], a[136:139], v[56:59]
    ds_read_b64_tr_b16 a[220:221], v3 offset:21536
    v_mfma_f32_16x16x32_bf16 v[56:59], a[204:207], a[152:155], v[56:59]
    ds_read_b64_tr_b16 a[222:223], v3 offset:25120
    v_mfma_f32_16x16x32_bf16 v[60:63], a[204:207], a[156:159], v[60:63]
    v_mfma_f32_16x16x32_bf16 v[60:63], a[200:203], a[140:143], v[60:63]
    s_waitcnt lgkmcnt(4)
    v_mfma_f32_16x16x32_bf16 v[64:67], a[208:211], a[128:131], v[64:67]
    ds_read_b64_tr_b16 a[192:193], v3 offset:64
    v_mfma_f32_16x16x32_bf16 v[64:67], a[212:215], a[144:147], v[64:67]
    ds_read_b64_tr_b16 a[194:195], v3 offset:3648
    v_mfma_f32_16x16x32_bf16 v[68:71], a[212:215], a[148:151], v[68:71]
    buffer_load_dwordx4 v10, s[12:15], s30 offen offset:1024 lds
    v_mfma_f32_16x16x32_bf16 v[68:71], a[208:211], a[132:135], v[68:71]
    v_mfma_f32_16x16x32_bf16 v[72:75], a[208:211], a[136:139], v[72:75]
    ds_read_b64_tr_b16 a[196:197], v3 offset:7232
    v_mfma_f32_16x16x32_bf16 v[72:75], a[212:215], a[152:155], v[72:75]
    ds_read_b64_tr_b16 a[198:199], v3 offset:10816
    v_mfma_f32_16x16x32_bf16 v[76:79], a[212:215], a[156:159], v[76:79]
    buffer_load_dword a255, v0, s[12:15], s96 offen
    v_mfma_f32_16x16x32_bf16 v[76:79], a[208:211], a[140:143], v[76:79]
    s_waitcnt lgkmcnt(4)
    v_mfma_f32_16x16x32_bf16 v[80:83], a[216:219], a[128:131], v[80:83]
    ds_read_b64_tr_b16 a[200:201], v3 offset:14400
    v_mfma_f32_16x16x32_bf16 v[80:83], a[220:223], a[144:147], v[80:83]
    ds_read_b64_tr_b16 a[202:203], v3 offset:17984
    v_mfma_f32_16x16x32_bf16 v[84:87], a[220:223], a[148:151], v[84:87]
    buffer_load_dwordx4 v11, s[12:15], s30 offen offset:2048 lds
    v_mfma_f32_16x16x32_bf16 v[84:87], a[216:219], a[132:135], v[84:87]
    s_add_u32 s96, s96, 1048576
    v_mfma_f32_16x16x32_bf16 v[88:91], a[216:219], a[136:139], v[88:91]
    ds_read_b64_tr_b16 a[204:205], v3 offset:21568
    v_mfma_f32_16x16x32_bf16 v[88:91], a[220:223], a[152:155], v[88:91]
    ds_read_b64_tr_b16 a[206:207], v3 offset:25152
    v_mfma_f32_16x16x32_bf16 v[92:95], a[220:223], a[156:159], v[92:95]
    v_mfma_f32_16x16x32_bf16 v[92:95], a[216:219], a[140:143], v[92:95]
    s_waitcnt lgkmcnt(4)
    v_mfma_f32_16x16x32_bf16 v[96:99], a[192:195], a[128:131], v[96:99]
    ds_read_b64_tr_b16 a[208:209], v3 offset:96
    v_mfma_f32_16x16x32_bf16 v[96:99], a[196:199], a[144:147], v[96:99]
    ds_read_b64_tr_b16 a[210:211], v3 offset:3680
    v_mfma_f32_16x16x32_bf16 v[100:103], a[196:199], a[148:151], v[100:103]
    buffer_load_dwordx4 v12, s[12:15], s30 offen offset:3072 lds
    v_mfma_f32_16x16x32_bf16 v[100:103], a[192:195], a[132:135], v[100:103]
    v_mfma_f32_16x16x32_bf16 v[104:107], a[192:195], a[136:139], v[104:107]
    ds_read_b64_tr_b16 a[212:213], v3 offset:7264
    v_mfma_f32_16x16x32_bf16 v[104:107], a[196:199], a[152:155], v[104:107]
    ds_read_b64_tr_b16 a[214:215], v3 offset:10848
    v_mfma_f32_16x16x32_bf16 v[108:111], a[196:199], a[156:159], v[108:111]
    v_mfma_f32_16x16x32_bf16 v[108:111], a[192:195], a[140:143], v[108:111]
    s_waitcnt lgkmcnt(4)
    v_mfma_f32_16x16x32_bf16 v[112:115], a[200:203], a[128:131], v[112:115]
    ds_read_b64_tr_b16 a[216:217], v3 offset:14432
    v_mfma_f32_16x16x32_bf16 v[112:115], a[204:207], a[144:147], v[112:115]
    ds_read_b64_tr_b16 a[218:219], v3 offset:18016
    v_mfma_f32_16x16x32_bf16 v[116:119], a[204:207], a[148:151], v[116:119]
    v_mfma_f32_16x16x32_bf16 v[116:119], a[200:203], a[132:135], v[116:119]
    s_add_u32 s30, s30, 524288
    s_add_u32 m0, s33, s35
    v_mfma_f32_16x16x32_bf16 v[120:123], a[200:203], a[136:139], v[120:123]
    ds_read_b64_tr_b16 a[220:221], v3 offset:21600
    v_mfma_f32_16x16x32_bf16 v[120:123], a[204:207], a[152:155], v[120:123]
    ds_read_b64_tr_b16 a[222:223], v3 offset:25184
    v_mfma_f32_16x16x32_bf16 v[124:127], a[204:207], a[156:159], v[124:127]
    buffer_load_dwordx4 v13, s[16:19], s31 offen offset:0 lds
    v_mfma_f32_16x16x32_bf16 v[124:127], a[200:203], a[140:143], v[124:127]
    s_waitcnt lgkmcnt(4)
    v_mfma_f32_16x16x32_bf16 v[128:131], a[208:211], a[128:131], v[128:131]
    ds_read_b64_tr_b16 a[192:193], v3 offset:128
    v_mfma_f32_16x16x32_bf16 v[128:131], a[212:215], a[144:147], v[128:131]
    ds_read_b64_tr_b16 a[194:195], v3 offset:3712
    v_mfma_f32_16x16x32_bf16 v[132:135], a[212:215], a[148:151], v[132:135]
    v_mfma_f32_16x16x32_bf16 v[132:135], a[208:211], a[132:135], v[132:135]
    v_mfma_f32_16x16x32_bf16 v[136:139], a[208:211], a[136:139], v[136:139]
    ds_read_b64_tr_b16 a[196:197], v3 offset:7296
    v_mfma_f32_16x16x32_bf16 v[136:139], a[212:215], a[152:155], v[136:139]
    ds_read_b64_tr_b16 a[198:199], v3 offset:10880
    v_mfma_f32_16x16x32_bf16 v[140:143], a[212:215], a[156:159], v[140:143]
    buffer_load_dwordx4 v14, s[16:19], s31 offen offset:1024 lds
    v_mfma_f32_16x16x32_bf16 v[140:143], a[208:211], a[140:143], v[140:143]
    s_waitcnt lgkmcnt(4)
    v_mfma_f32_16x16x32_bf16 v[144:147], a[216:219], a[128:131], v[144:147]
    ds_read_b64_tr_b16 a[200:201], v3 offset:14464
    v_mfma_f32_16x16x32_bf16 v[144:147], a[220:223], a[144:147], v[144:147]
    ds_read_b64_tr_b16 a[202:203], v3 offset:18048
    v_mfma_f32_16x16x32_bf16 v[148:151], a[220:223], a[148:151], v[148:151]
    v_mfma_f32_16x16x32_bf16 v[148:151], a[216:219], a[132:135], v[148:151]
    v_mfma_f32_16x16x32_bf16 v[152:155], a[216:219], a[136:139], v[152:155]
    ds_read_b64_tr_b16 a[204:205], v3 offset:21632
    v_mfma_f32_16x16x32_bf16 v[152:155], a[220:223], a[152:155], v[152:155]
    ds_read_b64_tr_b16 a[206:207], v3 offset:25216
    v_mfma_f32_16x16x32_bf16 v[156:159], a[220:223], a[156:159], v[156:159]
    buffer_load_dwordx4 v15, s[16:19], s31 offen offset:2048 lds
    v_mfma_f32_16x16x32_bf16 v[156:159], a[216:219], a[140:143], v[156:159]
    s_waitcnt lgkmcnt(4)
    v_mfma_f32_16x16x32_bf16 v[160:163], a[192:195], a[128:131], v[160:163]
    ds_read_b64_tr_b16 a[208:209], v3 offset:160
    v_mfma_f32_16x16x32_bf16 v[160:163], a[196:199], a[144:147], v[160:163]
    ds_read_b64_tr_b16 a[210:211], v3 offset:3744
    v_mfma_f32_16x16x32_bf16 v[164:167], a[196:199], a[148:151], v[164:167]
    v_mfma_f32_16x16x32_bf16 v[164:167], a[192:195], a[132:135], v[164:167]
    v_mfma_f32_16x16x32_bf16 v[168:171], a[192:195], a[136:139], v[168:171]
    ds_read_b64_tr_b16 a[212:213], v3 offset:7328
    v_mfma_f32_16x16x32_bf16 v[168:171], a[196:199], a[152:155], v[168:171]
    ds_read_b64_tr_b16 a[214:215], v3 offset:10912
    v_mfma_f32_16x16x32_bf16 v[172:175], a[196:199], a[156:159], v[172:175]
    buffer_load_dwordx4 v16, s[16:19], s31 offen offset:3072 lds
    v_mfma_f32_16x16x32_bf16 v[172:175], a[192:195], a[140:143], v[172:175]
    s_waitcnt lgkmcnt(4)
    v_mfma_f32_16x16x32_bf16 v[176:179], a[200:203], a[128:131], v[176:179]
    ds_read_b64_tr_b16 a[216:217], v3 offset:14496
    v_mfma_f32_16x16x32_bf16 v[176:179], a[204:207], a[144:147], v[176:179]
    ds_read_b64_tr_b16 a[218:219], v3 offset:18080
    v_mfma_f32_16x16x32_bf16 v[180:183], a[204:207], a[148:151], v[180:183]
    v_mfma_f32_16x16x32_bf16 v[180:183], a[200:203], a[132:135], v[180:183]
    v_mfma_f32_16x16x32_bf16 v[184:187], a[200:203], a[136:139], v[184:187]
    ds_read_b64_tr_b16 a[220:221], v3 offset:21664
    v_mfma_f32_16x16x32_bf16 v[184:187], a[204:207], a[152:155], v[184:187]
    ds_read_b64_tr_b16 a[222:223], v3 offset:25248
    v_mfma_f32_16x16x32_bf16 v[188:191], a[204:207], a[156:159], v[188:191]
    s_add_u32 m0, s33, s36
    v_mfma_f32_16x16x32_bf16 v[188:191], a[200:203], a[140:143], v[188:191]
    s_waitcnt lgkmcnt(4)
    v_mfma_f32_16x16x32_bf16 v[192:195], a[208:211], a[128:131], v[192:195]
    ds_read_b64_tr_b16 a[192:193], v3 offset:192
    v_mfma_f32_16x16x32_bf16 v[192:195], a[212:215], a[144:147], v[192:195]
    ds_read_b64_tr_b16 a[194:195], v3 offset:3776
    v_mfma_f32_16x16x32_bf16 v[196:199], a[212:215], a[148:151], v[196:199]
    buffer_load_dwordx4 v17, s[16:19], s31 offen offset:0 lds
    s_mov_b32 s33, s32
    v_mfma_f32_16x16x32_bf16 v[196:199], a[208:211], a[132:135], v[196:199]
    v_mfma_f32_16x16x32_bf16 v[200:203], a[208:211], a[136:139], v[200:203]
    ds_read_b64_tr_b16 a[196:197], v3 offset:7360
    v_mfma_f32_16x16x32_bf16 v[200:203], a[212:215], a[152:155], v[200:203]
    ds_read_b64_tr_b16 a[198:199], v3 offset:10944
    v_mfma_f32_16x16x32_bf16 v[204:207], a[212:215], a[156:159], v[204:207]
    s_add_u32 s32, s32, 45056
    v_mfma_f32_16x16x32_bf16 v[204:207], a[208:211], a[140:143], v[204:207]
    s_waitcnt lgkmcnt(4)
    v_mfma_f32_16x16x32_bf16 v[208:211], a[216:219], a[128:131], v[208:211]
    ds_read_b64_tr_b16 a[200:201], v3 offset:14528
    v_mfma_f32_16x16x32_bf16 v[208:211], a[220:223], a[144:147], v[208:211]
    ds_read_b64_tr_b16 a[202:203], v3 offset:18112
    v_mfma_f32_16x16x32_bf16 v[212:215], a[220:223], a[148:151], v[212:215]
    buffer_load_dwordx4 v18, s[16:19], s31 offen offset:1024 lds
    s_cmp_eq_u32 s32, 135168
    s_cselect_b32 s32, 0, s32
    v_mfma_f32_16x16x32_bf16 v[212:215], a[216:219], a[132:135], v[212:215]
    v_mfma_f32_16x16x32_bf16 v[216:219], a[216:219], a[136:139], v[216:219]
    ds_read_b64_tr_b16 a[204:205], v3 offset:21696
    v_mfma_f32_16x16x32_bf16 v[216:219], a[220:223], a[152:155], v[216:219]
    ds_read_b64_tr_b16 a[206:207], v3 offset:25280
    v_mfma_f32_16x16x32_bf16 v[220:223], a[220:223], a[156:159], v[220:223]
    v_add_u32_e64 v1, s32, v4
    v_mfma_f32_16x16x32_bf16 v[220:223], a[216:219], a[140:143], v[220:223]
    v_add_u32 v2, s32, v5
    s_waitcnt lgkmcnt(4)
    v_mfma_f32_16x16x32_bf16 v[224:227], a[192:195], a[128:131], v[224:227]
    v_mfma_f32_16x16x32_bf16 v[224:227], a[196:199], a[144:147], v[224:227]
    v_mfma_f32_16x16x32_bf16 v[228:231], a[196:199], a[148:151], v[228:231]
    buffer_load_dwordx4 v19, s[16:19], s31 offen offset:2048 lds
    v_add_u32_e64 v3, s32, v6
    v_mfma_f32_16x16x32_bf16 v[228:231], a[192:195], a[132:135], v[228:231]
    v_mfma_f32_16x16x32_bf16 v[232:235], a[192:195], a[136:139], v[232:235]
    v_mfma_f32_16x16x32_bf16 v[232:235], a[196:199], a[152:155], v[232:235]
    v_mfma_f32_16x16x32_bf16 v[236:239], a[196:199], a[156:159], v[236:239]
    s_add_u32 s31, s31, 458752
    v_mfma_f32_16x16x32_bf16 v[236:239], a[192:195], a[140:143], v[236:239]
    s_waitcnt vmcnt(20) lgkmcnt(0)
    s_barrier
    v_mfma_f32_16x16x32_bf16 v[240:243], a[200:203], a[128:131], v[240:243]
    ds_read_b64_tr_b16 a[208:209], v1 offset:0
    v_mfma_f32_16x16x32_bf16 v[240:243], a[204:207], a[144:147], v[240:243]
    ds_read_b64_tr_b16 a[210:211], v1 offset:4096
    v_mfma_f32_16x16x32_bf16 v[244:247], a[204:207], a[148:151], v[244:247]
    ds_read_b64_tr_b16 a[212:213], v1 offset:8192
    v_mfma_f32_16x16x32_bf16 v[244:247], a[200:203], a[132:135], v[244:247]
    ds_read_b64_tr_b16 a[214:215], v1 offset:12288
    v_mfma_f32_16x16x32_bf16 v[248:251], a[200:203], a[136:139], v[248:251]
    ds_read_b64_tr_b16 a[216:217], v2 offset:0
    v_mfma_f32_16x16x32_bf16 v[248:251], a[204:207], a[152:155], v[248:251]
    ds_read_b64_tr_b16 a[218:219], v2 offset:4096
    v_mfma_f32_16x16x32_bf16 v[252:255], a[204:207], a[156:159], v[252:255]
    ds_read_b64_tr_b16 a[220:221], v2 offset:8192
    v_mfma_f32_16x16x32_bf16 v[252:255], a[200:203], a[140:143], v[252:255]
    ds_read_b64_tr_b16 a[222:223], v2 offset:12288
    s_waitcnt vmcnt(16) lgkmcnt(4)
    s_waitcnt vmcnt(12)
    v_mfma_f32_16x16x32_bf16 a[0:3], a[208:211], a[160:163], a[0:3]
    ds_read_b64_tr_b16 a[192:193], v1 offset:256
    v_mfma_f32_16x16x32_bf16 a[0:3], a[212:215], a[176:179], a[0:3]
    ds_read_b64_tr_b16 a[194:195], v1 offset:4352
    v_mfma_f32_16x16x32_bf16 a[4:7], a[212:215], a[180:183], a[4:7]
    buffer_load_dwordx4 a[128:131], v7, s[8:11], s28 offen offset:0 sc1
    v_mfma_f32_16x16x32_bf16 a[4:7], a[208:211], a[164:167], a[4:7]
    v_mfma_f32_16x16x32_bf16 a[8:11], a[208:211], a[168:171], a[8:11]
    ds_read_b64_tr_b16 a[196:197], v1 offset:8448
    v_mfma_f32_16x16x32_bf16 a[8:11], a[212:215], a[184:187], a[8:11]
    ds_read_b64_tr_b16 a[198:199], v1 offset:12544
    v_mfma_f32_16x16x32_bf16 a[12:15], a[212:215], a[188:191], a[12:15]
    v_mfma_f32_16x16x32_bf16 a[12:15], a[208:211], a[172:175], a[12:15]
    s_waitcnt lgkmcnt(4)
    v_mfma_f32_16x16x32_bf16 a[16:19], a[216:219], a[160:163], a[16:19]
    ds_read_b64_tr_b16 a[200:201], v2 offset:256
    v_mfma_f32_16x16x32_bf16 a[16:19], a[220:223], a[176:179], a[16:19]
    ds_read_b64_tr_b16 a[202:203], v2 offset:4352
    v_mfma_f32_16x16x32_bf16 a[20:23], a[220:223], a[180:183], a[20:23]
    buffer_load_dwordx4 a[132:135], v8, s[8:11], s28 offen offset:0 sc1
    v_mfma_f32_16x16x32_bf16 a[20:23], a[216:219], a[164:167], a[20:23]
    v_mfma_f32_16x16x32_bf16 a[24:27], a[216:219], a[168:171], a[24:27]
    ds_read_b64_tr_b16 a[204:205], v2 offset:8448
    v_mfma_f32_16x16x32_bf16 a[24:27], a[220:223], a[184:187], a[24:27]
    ds_read_b64_tr_b16 a[206:207], v2 offset:12544
    v_mfma_f32_16x16x32_bf16 a[28:31], a[220:223], a[188:191], a[28:31]
    v_mfma_f32_16x16x32_bf16 a[28:31], a[216:219], a[172:175], a[28:31]
    s_waitcnt lgkmcnt(4)
    v_mfma_f32_16x16x32_bf16 a[32:35], a[192:195], a[160:163], a[32:35]
    ds_read_b64_tr_b16 a[208:209], v1 offset:512
    v_mfma_f32_16x16x32_bf16 a[32:35], a[196:199], a[176:179], a[32:35]
    ds_read_b64_tr_b16 a[210:211], v1 offset:4608
    v_mfma_f32_16x16x32_bf16 a[36:39], a[196:199], a[180:183], a[36:39]
    buffer_load_dwordx4 a[136:139], v7, s[8:11], s29 offen offset:0 sc1
    v_mfma_f32_16x16x32_bf16 a[36:39], a[192:195], a[164:167], a[36:39]
    v_mfma_f32_16x16x32_bf16 a[40:43], a[192:195], a[168:171], a[40:43]
    ds_read_b64_tr_b16 a[212:213], v1 offset:8704
    v_mfma_f32_16x16x32_bf16 a[40:43], a[196:199], a[184:187], a[40:43]
    ds_read_b64_tr_b16 a[214:215], v1 offset:12800
    v_mfma_f32_16x16x32_bf16 a[44:47], a[196:199], a[188:191], a[44:47]
    v_mfma_f32_16x16x32_bf16 a[44:47], a[192:195], a[172:175], a[44:47]
    s_waitcnt lgkmcnt(4)
    v_mfma_f32_16x16x32_bf16 a[48:51], a[200:203], a[160:163], a[48:51]
    ds_read_b64_tr_b16 a[216:217], v2 offset:512
    v_mfma_f32_16x16x32_bf16 a[48:51], a[204:207], a[176:179], a[48:51]
    ds_read_b64_tr_b16 a[218:219], v2 offset:4608
    v_mfma_f32_16x16x32_bf16 a[52:55], a[204:207], a[180:183], a[52:55]
    buffer_load_dwordx4 a[140:143], v8, s[8:11], s29 offen offset:0 sc1
    v_mfma_f32_16x16x32_bf16 a[52:55], a[200:203], a[164:167], a[52:55]
    v_mfma_f32_16x16x32_bf16 a[56:59], a[200:203], a[168:171], a[56:59]
    ds_read_b64_tr_b16 a[220:221], v2 offset:8704
    v_mfma_f32_16x16x32_bf16 a[56:59], a[204:207], a[184:187], a[56:59]
    ds_read_b64_tr_b16 a[222:223], v2 offset:12800
    v_mfma_f32_16x16x32_bf16 a[60:63], a[204:207], a[188:191], a[60:63]
    v_mfma_f32_16x16x32_bf16 a[60:63], a[200:203], a[172:175], a[60:63]
    s_waitcnt lgkmcnt(4)
    v_mfma_f32_16x16x32_bf16 a[64:67], a[208:211], a[160:163], a[64:67]
    ds_read_b64_tr_b16 a[192:193], v1 offset:768
    v_mfma_f32_16x16x32_bf16 a[64:67], a[212:215], a[176:179], a[64:67]
    ds_read_b64_tr_b16 a[194:195], v1 offset:4864
    v_mfma_f32_16x16x32_bf16 a[68:71], a[212:215], a[180:183], a[68:71]
    v_mfma_f32_16x16x32_bf16 a[68:71], a[208:211], a[164:167], a[68:71]
    v_mfma_f32_16x16x32_bf16 a[72:75], a[208:211], a[168:171], a[72:75]
    ds_read_b64_tr_b16 a[196:197], v1 offset:8960
    v_mfma_f32_16x16x32_bf16 a[72:75], a[212:215], a[184:187], a[72:75]
    ds_read_b64_tr_b16 a[198:199], v1 offset:13056
    v_mfma_f32_16x16x32_bf16 a[76:79], a[212:215], a[188:191], a[76:79]
    buffer_load_dwordx4 a[144:147], v7, s[8:11], s28 offen offset:1024 sc1
    v_mfma_f32_16x16x32_bf16 a[76:79], a[208:211], a[172:175], a[76:79]
    s_waitcnt lgkmcnt(4)
    v_mfma_f32_16x16x32_bf16 a[80:83], a[216:219], a[160:163], a[80:83]
    ds_read_b64_tr_b16 a[200:201], v2 offset:768
    v_mfma_f32_16x16x32_bf16 a[80:83], a[220:223], a[176:179], a[80:83]
    ds_read_b64_tr_b16 a[202:203], v2 offset:4864
    v_mfma_f32_16x16x32_bf16 a[84:87], a[220:223], a[180:183], a[84:87]
    v_mfma_f32_16x16x32_bf16 a[84:87], a[216:219], a[164:167], a[84:87]
    v_mfma_f32_16x16x32_bf16 a[88:91], a[216:219], a[168:171], a[88:91]
    ds_read_b64_tr_b16 a[204:205], v2 offset:8960
    v_mfma_f32_16x16x32_bf16 a[88:91], a[220:223], a[184:187], a[88:91]
    ds_read_b64_tr_b16 a[206:207], v2 offset:13056
    v_mfma_f32_16x16x32_bf16 a[92:95], a[220:223], a[188:191], a[92:95]
    buffer_load_dwordx4 a[148:151], v8, s[8:11], s28 offen offset:1024 sc1
    v_mfma_f32_16x16x32_bf16 a[92:95], a[216:219], a[172:175], a[92:95]
    s_waitcnt lgkmcnt(4)
    v_mfma_f32_16x16x32_bf16 a[96:99], a[192:195], a[160:163], a[96:99]
    ds_read_b64_tr_b16 a[208:209], v3 offset:0
    v_mfma_f32_16x16x32_bf16 a[96:99], a[196:199], a[176:179], a[96:99]
    ds_read_b64_tr_b16 a[210:211], v3 offset:3584
    v_mfma_f32_16x16x32_bf16 a[100:103], a[196:199], a[180:183], a[100:103]
    v_mfma_f32_16x16x32_bf16 a[100:103], a[192:195], a[164:167], a[100:103]
    v_mfma_f32_16x16x32_bf16 a[104:107], a[192:195], a[168:171], a[104:107]
    ds_read_b64_tr_b16 a[212:213], v3 offset:7168
    v_mfma_f32_16x16x32_bf16 a[104:107], a[196:199], a[184:187], a[104:107]
    ds_read_b64_tr_b16 a[214:215], v3 offset:10752
    v_mfma_f32_16x16x32_bf16 a[108:111], a[196:199], a[188:191], a[108:111]
    buffer_load_dwordx4 a[152:155], v7, s[8:11], s29 offen offset:1024 sc1
    v_mfma_f32_16x16x32_bf16 a[108:111], a[192:195], a[172:175], a[108:111]
    s_waitcnt lgkmcnt(4)
    v_mfma_f32_16x16x32_bf16 a[112:115], a[200:203], a[160:163], a[112:115]
    ds_read_b64_tr_b16 a[216:217], v3 offset:14336
    v_mfma_f32_16x16x32_bf16 a[112:115], a[204:207], a[176:179], a[112:115]
    ds_read_b64_tr_b16 a[218:219], v3 offset:17920
    v_mfma_f32_16x16x32_bf16 a[116:119], a[204:207], a[180:183], a[116:119]
    v_mfma_f32_16x16x32_bf16 a[116:119], a[200:203], a[164:167], a[116:119]
    v_mfma_f32_16x16x32_bf16 a[120:123], a[200:203], a[168:171], a[120:123]
    ds_read_b64_tr_b16 a[220:221], v3 offset:21504
    v_mfma_f32_16x16x32_bf16 a[120:123], a[204:207], a[184:187], a[120:123]
    ds_read_b64_tr_b16 a[222:223], v3 offset:25088
    v_mfma_f32_16x16x32_bf16 a[124:127], a[204:207], a[188:191], a[124:127]
    buffer_load_dwordx4 a[156:159], v8, s[8:11], s29 offen offset:1024 sc1
    v_mfma_f32_16x16x32_bf16 a[124:127], a[200:203], a[172:175], a[124:127]
    s_waitcnt lgkmcnt(4)
    v_mfma_f32_16x16x32_bf16 v[32:35], a[208:211], a[160:163], v[32:35]
    ds_read_b64_tr_b16 a[192:193], v3 offset:32
    v_mfma_f32_16x16x32_bf16 v[32:35], a[212:215], a[176:179], v[32:35]
    ds_read_b64_tr_b16 a[194:195], v3 offset:3616
    v_mfma_f32_16x16x32_bf16 v[36:39], a[212:215], a[180:183], v[36:39]
    v_mfma_f32_16x16x32_bf16 v[36:39], a[208:211], a[164:167], v[36:39]
    v_mfma_f32_16x16x32_bf16 v[40:43], a[208:211], a[168:171], v[40:43]
    ds_read_b64_tr_b16 a[196:197], v3 offset:7200
    v_mfma_f32_16x16x32_bf16 v[40:43], a[212:215], a[184:187], v[40:43]
    ds_read_b64_tr_b16 a[198:199], v3 offset:10784
    v_mfma_f32_16x16x32_bf16 v[44:47], a[212:215], a[188:191], v[44:47]
    s_add_u32 m0, s33, s34
    v_mfma_f32_16x16x32_bf16 v[44:47], a[208:211], a[172:175], v[44:47]
    s_waitcnt lgkmcnt(4)
    v_mfma_f32_16x16x32_bf16 v[48:51], a[216:219], a[160:163], v[48:51]
    ds_read_b64_tr_b16 a[200:201], v3 offset:14368
    v_mfma_f32_16x16x32_bf16 v[48:51], a[220:223], a[176:179], v[48:51]
    ds_read_b64_tr_b16 a[202:203], v3 offset:17952
    v_mfma_f32_16x16x32_bf16 v[52:55], a[220:223], a[180:183], v[52:55]
    buffer_load_dwordx4 v9, s[12:15], s30 offen offset:0 lds
    v_mfma_f32_16x16x32_bf16 v[52:55], a[216:219], a[164:167], v[52:55]
    v_mfma_f32_16x16x32_bf16 v[56:59], a[216:219], a[168:171], v[56:59]
    ds_read_b64_tr_b16 a[204:205], v3 offset:21536
    v_mfma_f32_16x16x32_bf16 v[56:59], a[220:223], a[184:187], v[56:59]
    ds_read_b64_tr_b16 a[206:207], v3 offset:25120
    v_mfma_f32_16x16x32_bf16 v[60:63], a[220:223], a[188:191], v[60:63]
    v_mfma_f32_16x16x32_bf16 v[60:63], a[216:219], a[172:175], v[60:63]
    s_waitcnt lgkmcnt(4)
    v_mfma_f32_16x16x32_bf16 v[64:67], a[192:195], a[160:163], v[64:67]
    ds_read_b64_tr_b16 a[208:209], v3 offset:64
    v_mfma_f32_16x16x32_bf16 v[64:67], a[196:199], a[176:179], v[64:67]
    ds_read_b64_tr_b16 a[210:211], v3 offset:3648
    v_mfma_f32_16x16x32_bf16 v[68:71], a[196:199], a[180:183], v[68:71]
    buffer_load_dwordx4 v10, s[12:15], s30 offen offset:1024 lds
    v_mfma_f32_16x16x32_bf16 v[68:71], a[192:195], a[164:167], v[68:71]
    v_mfma_f32_16x16x32_bf16 v[72:75], a[192:195], a[168:171], v[72:75]
    ds_read_b64_tr_b16 a[212:213], v3 offset:7232
    v_mfma_f32_16x16x32_bf16 v[72:75], a[196:199], a[184:187], v[72:75]
    ds_read_b64_tr_b16 a[214:215], v3 offset:10816
    v_mfma_f32_16x16x32_bf16 v[76:79], a[196:199], a[188:191], v[76:79]
    buffer_load_dword a255, v31, s[16:19], s97 offen
    v_mfma_f32_16x16x32_bf16 v[76:79], a[192:195], a[172:175], v[76:79]
    s_waitcnt lgkmcnt(4)
    v_mfma_f32_16x16x32_bf16 v[80:83], a[200:203], a[160:163], v[80:83]
    ds_read_b64_tr_b16 a[216:217], v3 offset:14400
    v_mfma_f32_16x16x32_bf16 v[80:83], a[204:207], a[176:179], v[80:83]
    ds_read_b64_tr_b16 a[218:219], v3 offset:17984
    v_mfma_f32_16x16x32_bf16 v[84:87], a[204:207], a[180:183], v[84:87]
    buffer_load_dwordx4 v11, s[12:15], s30 offen offset:2048 lds
    v_mfma_f32_16x16x32_bf16 v[84:87], a[200:203], a[164:167], v[84:87]
    s_add_u32 s97, s97, 917504
    v_mfma_f32_16x16x32_bf16 v[88:91], a[200:203], a[168:171], v[88:91]
    ds_read_b64_tr_b16 a[220:221], v3 offset:21568
    v_mfma_f32_16x16x32_bf16 v[88:91], a[204:207], a[184:187], v[88:91]
    ds_read_b64_tr_b16 a[222:223], v3 offset:25152
    v_mfma_f32_16x16x32_bf16 v[92:95], a[204:207], a[188:191], v[92:95]
    v_mfma_f32_16x16x32_bf16 v[92:95], a[200:203], a[172:175], v[92:95]
    s_waitcnt lgkmcnt(4)
    v_mfma_f32_16x16x32_bf16 v[96:99], a[208:211], a[160:163], v[96:99]
    ds_read_b64_tr_b16 a[192:193], v3 offset:96
    v_mfma_f32_16x16x32_bf16 v[96:99], a[212:215], a[176:179], v[96:99]
    ds_read_b64_tr_b16 a[194:195], v3 offset:3680
    v_mfma_f32_16x16x32_bf16 v[100:103], a[212:215], a[180:183], v[100:103]
    buffer_load_dwordx4 v12, s[12:15], s30 offen offset:3072 lds
    v_mfma_f32_16x16x32_bf16 v[100:103], a[208:211], a[164:167], v[100:103]
    v_mfma_f32_16x16x32_bf16 v[104:107], a[208:211], a[168:171], v[104:107]
    ds_read_b64_tr_b16 a[196:197], v3 offset:7264
    v_mfma_f32_16x16x32_bf16 v[104:107], a[212:215], a[184:187], v[104:107]
    ds_read_b64_tr_b16 a[198:199], v3 offset:10848
    v_mfma_f32_16x16x32_bf16 v[108:111], a[212:215], a[188:191], v[108:111]
    v_mfma_f32_16x16x32_bf16 v[108:111], a[208:211], a[172:175], v[108:111]
    s_waitcnt lgkmcnt(4)
    v_mfma_f32_16x16x32_bf16 v[112:115], a[216:219], a[160:163], v[112:115]
    ds_read_b64_tr_b16 a[200:201], v3 offset:14432
    v_mfma_f32_16x16x32_bf16 v[112:115], a[220:223], a[176:179], v[112:115]
    ds_read_b64_tr_b16 a[202:203], v3 offset:18016
    v_mfma_f32_16x16x32_bf16 v[116:119], a[220:223], a[180:183], v[116:119]
    v_mfma_f32_16x16x32_bf16 v[116:119], a[216:219], a[164:167], v[116:119]
    s_add_u32 s30, s30, 524288
    s_add_u32 m0, s33, s35
    v_mfma_f32_16x16x32_bf16 v[120:123], a[216:219], a[168:171], v[120:123]
    ds_read_b64_tr_b16 a[204:205], v3 offset:21600
    v_mfma_f32_16x16x32_bf16 v[120:123], a[220:223], a[184:187], v[120:123]
    ds_read_b64_tr_b16 a[206:207], v3 offset:25184
    v_mfma_f32_16x16x32_bf16 v[124:127], a[220:223], a[188:191], v[124:127]
    buffer_load_dwordx4 v13, s[16:19], s31 offen offset:0 lds
    v_mfma_f32_16x16x32_bf16 v[124:127], a[216:219], a[172:175], v[124:127]
    s_waitcnt lgkmcnt(4)
    v_mfma_f32_16x16x32_bf16 v[128:131], a[192:195], a[160:163], v[128:131]
    ds_read_b64_tr_b16 a[208:209], v3 offset:128
    v_mfma_f32_16x16x32_bf16 v[128:131], a[196:199], a[176:179], v[128:131]
    ds_read_b64_tr_b16 a[210:211], v3 offset:3712
    v_mfma_f32_16x16x32_bf16 v[132:135], a[196:199], a[180:183], v[132:135]
    v_mfma_f32_16x16x32_bf16 v[132:135], a[192:195], a[164:167], v[132:135]
    v_mfma_f32_16x16x32_bf16 v[136:139], a[192:195], a[168:171], v[136:139]
    ds_read_b64_tr_b16 a[212:213], v3 offset:7296
    v_mfma_f32_16x16x32_bf16 v[136:139], a[196:199], a[184:187], v[136:139]
    ds_read_b64_tr_b16 a[214:215], v3 offset:10880
    v_mfma_f32_16x16x32_bf16 v[140:143], a[196:199], a[188:191], v[140:143]
    buffer_load_dwordx4 v14, s[16:19], s31 offen offset:1024 lds
    v_mfma_f32_16x16x32_bf16 v[140:143], a[192:195], a[172:175], v[140:143]
    s_waitcnt lgkmcnt(4)
    v_mfma_f32_16x16x32_bf16 v[144:147], a[200:203], a[160:163], v[144:147]
    ds_read_b64_tr_b16 a[216:217], v3 offset:14464
    v_mfma_f32_16x16x32_bf16 v[144:147], a[204:207], a[176:179], v[144:147]
    ds_read_b64_tr_b16 a[218:219], v3 offset:18048
    v_mfma_f32_16x16x32_bf16 v[148:151], a[204:207], a[180:183], v[148:151]
    v_mfma_f32_16x16x32_bf16 v[148:151], a[200:203], a[164:167], v[148:151]
    v_mfma_f32_16x16x32_bf16 v[152:155], a[200:203], a[168:171], v[152:155]
    ds_read_b64_tr_b16 a[220:221], v3 offset:21632
    v_mfma_f32_16x16x32_bf16 v[152:155], a[204:207], a[184:187], v[152:155]
    ds_read_b64_tr_b16 a[222:223], v3 offset:25216
    v_mfma_f32_16x16x32_bf16 v[156:159], a[204:207], a[188:191], v[156:159]
    buffer_load_dwordx4 v15, s[16:19], s31 offen offset:2048 lds
    v_mfma_f32_16x16x32_bf16 v[156:159], a[200:203], a[172:175], v[156:159]
    s_waitcnt lgkmcnt(4)
    v_mfma_f32_16x16x32_bf16 v[160:163], a[208:211], a[160:163], v[160:163]
    ds_read_b64_tr_b16 a[192:193], v3 offset:160
    v_mfma_f32_16x16x32_bf16 v[160:163], a[212:215], a[176:179], v[160:163]
    ds_read_b64_tr_b16 a[194:195], v3 offset:3744
    v_mfma_f32_16x16x32_bf16 v[164:167], a[212:215], a[180:183], v[164:167]
    v_mfma_f32_16x16x32_bf16 v[164:167], a[208:211], a[164:167], v[164:167]
    v_mfma_f32_16x16x32_bf16 v[168:171], a[208:211], a[168:171], v[168:171]
    ds_read_b64_tr_b16 a[196:197], v3 offset:7328
    v_mfma_f32_16x16x32_bf16 v[168:171], a[212:215], a[184:187], v[168:171]
    ds_read_b64_tr_b16 a[198:199], v3 offset:10912
    v_mfma_f32_16x16x32_bf16 v[172:175], a[212:215], a[188:191], v[172:175]
    buffer_load_dwordx4 v16, s[16:19], s31 offen offset:3072 lds
    v_mfma_f32_16x16x32_bf16 v[172:175], a[208:211], a[172:175], v[172:175]
    s_waitcnt lgkmcnt(4)
    v_mfma_f32_16x16x32_bf16 v[176:179], a[216:219], a[160:163], v[176:179]
    ds_read_b64_tr_b16 a[200:201], v3 offset:14496
    v_mfma_f32_16x16x32_bf16 v[176:179], a[220:223], a[176:179], v[176:179]
    ds_read_b64_tr_b16 a[202:203], v3 offset:18080
    v_mfma_f32_16x16x32_bf16 v[180:183], a[220:223], a[180:183], v[180:183]
    v_mfma_f32_16x16x32_bf16 v[180:183], a[216:219], a[164:167], v[180:183]
    v_mfma_f32_16x16x32_bf16 v[184:187], a[216:219], a[168:171], v[184:187]
    ds_read_b64_tr_b16 a[204:205], v3 offset:21664
    v_mfma_f32_16x16x32_bf16 v[184:187], a[220:223], a[184:187], v[184:187]
    ds_read_b64_tr_b16 a[206:207], v3 offset:25248
    v_mfma_f32_16x16x32_bf16 v[188:191], a[220:223], a[188:191], v[188:191]
    s_add_u32 m0, s33, s36
    v_mfma_f32_16x16x32_bf16 v[188:191], a[216:219], a[172:175], v[188:191]
    s_waitcnt lgkmcnt(4)
    v_mfma_f32_16x16x32_bf16 v[192:195], a[192:195], a[160:163], v[192:195]
    ds_read_b64_tr_b16 a[208:209], v3 offset:192
    v_mfma_f32_16x16x32_bf16 v[192:195], a[196:199], a[176:179], v[192:195]
    ds_read_b64_tr_b16 a[210:211], v3 offset:3776
    v_mfma_f32_16x16x32_bf16 v[196:199], a[196:199], a[180:183], v[196:199]
    buffer_load_dwordx4 v17, s[16:19], s31 offen offset:0 lds
    s_mov_b32 s33, s32
    v_mfma_f32_16x16x32_bf16 v[196:199], a[192:195], a[164:167], v[196:199]
    v_mfma_f32_16x16x32_bf16 v[200:203], a[192:195], a[168:171], v[200:203]
    ds_read_b64_tr_b16 a[212:213], v3 offset:7360
    v_mfma_f32_16x16x32_bf16 v[200:203], a[196:199], a[184:187], v[200:203]
    ds_read_b64_tr_b16 a[214:215], v3 offset:10944
    v_mfma_f32_16x16x32_bf16 v[204:207], a[196:199], a[188:191], v[204:207]
    s_add_u32 s32, s32, 45056
    v_mfma_f32_16x16x32_bf16 v[204:207], a[192:195], a[172:175], v[204:207]
    s_waitcnt lgkmcnt(4)
    v_mfma_f32_16x16x32_bf16 v[208:211], a[200:203], a[160:163], v[208:211]
    ds_read_b64_tr_b16 a[216:217], v3 offset:14528
    v_mfma_f32_16x16x32_bf16 v[208:211], a[204:207], a[176:179], v[208:211]
    ds_read_b64_tr_b16 a[218:219], v3 offset:18112
    v_mfma_f32_16x16x32_bf16 v[212:215], a[204:207], a[180:183], v[212:215]
    buffer_load_dwordx4 v18, s[16:19], s31 offen offset:1024 lds
    s_cmp_eq_u32 s32, 135168
    s_cselect_b32 s32, 0, s32
    v_mfma_f32_16x16x32_bf16 v[212:215], a[200:203], a[164:167], v[212:215]
    v_mfma_f32_16x16x32_bf16 v[216:219], a[200:203], a[168:171], v[216:219]
    ds_read_b64_tr_b16 a[220:221], v3 offset:21696
    v_mfma_f32_16x16x32_bf16 v[216:219], a[204:207], a[184:187], v[216:219]
    ds_read_b64_tr_b16 a[222:223], v3 offset:25280
    v_mfma_f32_16x16x32_bf16 v[220:223], a[204:207], a[188:191], v[220:223]
    v_add_u32_e64 v1, s32, v4
    v_mfma_f32_16x16x32_bf16 v[220:223], a[200:203], a[172:175], v[220:223]
    v_add_u32 v2, s32, v5
    s_waitcnt lgkmcnt(4)
    v_mfma_f32_16x16x32_bf16 v[224:227], a[208:211], a[160:163], v[224:227]
    v_mfma_f32_16x16x32_bf16 v[224:227], a[212:215], a[176:179], v[224:227]
    v_mfma_f32_16x16x32_bf16 v[228:231], a[212:215], a[180:183], v[228:231]
    buffer_load_dwordx4 v19, s[16:19], s31 offen offset:2048 lds
    v_add_u32_e64 v3, s32, v6
    v_mfma_f32_16x16x32_bf16 v[228:231], a[208:211], a[164:167], v[228:231]
    v_mfma_f32_16x16x32_bf16 v[232:235], a[208:211], a[168:171], v[232:235]
    v_mfma_f32_16x16x32_bf16 v[232:235], a[212:215], a[184:187], v[232:235]
    v_mfma_f32_16x16x32_bf16 v[236:239], a[212:215], a[188:191], v[236:239]
    s_add_u32 s31, s31, 458752
    v_mfma_f32_16x16x32_bf16 v[236:239], a[208:211], a[172:175], v[236:239]
    s_waitcnt vmcnt(20) lgkmcnt(0)
    s_barrier
    v_mfma_f32_16x16x32_bf16 v[240:243], a[216:219], a[160:163], v[240:243]
    ds_read_b64_tr_b16 a[192:193], v1 offset:0
    v_mfma_f32_16x16x32_bf16 v[240:243], a[220:223], a[176:179], v[240:243]
    ds_read_b64_tr_b16 a[194:195], v1 offset:4096
    v_mfma_f32_16x16x32_bf16 v[244:247], a[220:223], a[180:183], v[244:247]
    ds_read_b64_tr_b16 a[196:197], v1 offset:8192
    v_mfma_f32_16x16x32_bf16 v[244:247], a[216:219], a[164:167], v[244:247]
    ds_read_b64_tr_b16 a[198:199], v1 offset:12288
    v_mfma_f32_16x16x32_bf16 v[248:251], a[216:219], a[168:171], v[248:251]
    ds_read_b64_tr_b16 a[200:201], v2 offset:0
    v_mfma_f32_16x16x32_bf16 v[248:251], a[220:223], a[184:187], v[248:251]
    ds_read_b64_tr_b16 a[202:203], v2 offset:4096
    v_mfma_f32_16x16x32_bf16 v[252:255], a[220:223], a[188:191], v[252:255]
    ds_read_b64_tr_b16 a[204:205], v2 offset:8192
    v_mfma_f32_16x16x32_bf16 v[252:255], a[216:219], a[172:175], v[252:255]
    ds_read_b64_tr_b16 a[206:207], v2 offset:12288
    s_sub_u32 s37, s37, 1
    s_cmp_lg_u32 s37, 0
    s_cbranch_scc1 L_g1
    s_waitcnt vmcnt(16) lgkmcnt(4)
    s_waitcnt vmcnt(12)
    v_mfma_f32_16x16x32_bf16 a[0:3], a[192:195], a[128:131], a[0:3]
    ds_read_b64_tr_b16 a[208:209], v1 offset:256
    v_mfma_f32_16x16x32_bf16 a[0:3], a[196:199], a[144:147], a[0:3]
    ds_read_b64_tr_b16 a[210:211], v1 offset:4352
    v_mfma_f32_16x16x32_bf16 a[4:7], a[196:199], a[148:151], a[4:7]
    buffer_load_dwordx4 a[160:163], v7, s[8:11], s28 offen offset:2048 sc1
    v_mfma_f32_16x16x32_bf16 a[4:7], a[192:195], a[132:135], a[4:7]
    v_mfma_f32_16x16x32_bf16 a[8:11], a[192:195], a[136:139], a[8:11]
    ds_read_b64_tr_b16 a[212:213], v1 offset:8448
    v_mfma_f32_16x16x32_bf16 a[8:11], a[196:199], a[152:155], a[8:11]
    ds_read_b64_tr_b16 a[214:215], v1 offset:12544
    v_mfma_f32_16x16x32_bf16 a[12:15], a[196:199], a[156:159], a[12:15]
    v_mfma_f32_16x16x32_bf16 a[12:15], a[192:195], a[140:143], a[12:15]
    s_waitcnt lgkmcnt(4)
    v_mfma_f32_16x16x32_bf16 a[16:19], a[200:203], a[128:131], a[16:19]
    ds_read_b64_tr_b16 a[216:217], v2 offset:256
    v_mfma_f32_16x16x32_bf16 a[16:19], a[204:207], a[144:147], a[16:19]
    ds_read_b64_tr_b16 a[218:219], v2 offset:4352
    v_mfma_f32_16x16x32_bf16 a[20:23], a[204:207], a[148:151], a[20:23]
    buffer_load_dwordx4 a[164:167], v8, s[8:11], s28 offen offset:2048 sc1
    v_mfma_f32_16x16x32_bf16 a[20:23], a[200:203], a[132:135], a[20:23]
    v_mfma_f32_16x16x32_bf16 a[24:27], a[200:203], a[136:139], a[24:27]
    ds_read_b64_tr_b16 a[220:221], v2 offset:8448
    v_mfma_f32_16x16x32_bf16 a[24:27], a[204:207], a[152:155], a[24:27]
    ds_read_b64_tr_b16 a[222:223], v2 offset:12544
    v_mfma_f32_16x16x32_bf16 a[28:31], a[204:207], a[156:159], a[28:31]
    v_mfma_f32_16x16x32_bf16 a[28:31], a[200:203], a[140:143], a[28:31]
    s_waitcnt lgkmcnt(4)
    v_mfma_f32_16x16x32_bf16 a[32:35], a[208:211], a[128:131], a[32:35]
    ds_read_b64_tr_b16 a[192:193], v1 offset:512
    v_mfma_f32_16x16x32_bf16 a[32:35], a[212:215], a[144:147], a[32:35]
    ds_read_b64_tr_b16 a[194:195], v1 offset:4608
    v_mfma_f32_16x16x32_bf16 a[36:39], a[212:215], a[148:151], a[36:39]
    buffer_load_dwordx4 a[168:171], v7, s[8:11], s29 offen offset:2048 sc1
    v_mfma_f32_16x16x32_bf16 a[36:39], a[208:211], a[132:135], a[36:39]
    v_mfma_f32_16x16x32_bf16 a[40:43], a[208:211], a[136:139], a[40:43]
    ds_read_b64_tr_b16 a[196:197], v1 offset:8704
    v_mfma_f32_16x16x32_bf16 a[40:43], a[212:215], a[152:155], a[40:43]
    ds_read_b64_tr_b16 a[198:199], v1 offset:12800
    v_mfma_f32_16x16x32_bf16 a[44:47], a[212:215], a[156:159], a[44:47]
    v_mfma_f32_16x16x32_bf16 a[44:47], a[208:211], a[140:143], a[44:47]
    s_waitcnt lgkmcnt(4)
    v_mfma_f32_16x16x32_bf16 a[48:51], a[216:219], a[128:131], a[48:51]
    ds_read_b64_tr_b16 a[200:201], v2 offset:512
    v_mfma_f32_16x16x32_bf16 a[48:51], a[220:223], a[144:147], a[48:51]
    ds_read_b64_tr_b16 a[202:203], v2 offset:4608
    v_mfma_f32_16x16x32_bf16 a[52:55], a[220:223], a[148:151], a[52:55]
    buffer_load_dwordx4 a[172:175], v8, s[8:11], s29 offen offset:2048 sc1
    v_mfma_f32_16x16x32_bf16 a[52:55], a[216:219], a[132:135], a[52:55]
    v_mfma_f32_16x16x32_bf16 a[56:59], a[216:219], a[136:139], a[56:59]
    ds_read_b64_tr_b16 a[204:205], v2 offset:8704
    v_mfma_f32_16x16x32_bf16 a[56:59], a[220:223], a[152:155], a[56:59]
    ds_read_b64_tr_b16 a[206:207], v2 offset:12800
    v_mfma_f32_16x16x32_bf16 a[60:63], a[220:223], a[156:159], a[60:63]
    v_mfma_f32_16x16x32_bf16 a[60:63], a[216:219], a[140:143], a[60:63]
    s_waitcnt lgkmcnt(4)
    v_mfma_f32_16x16x32_bf16 a[64:67], a[192:195], a[128:131], a[64:67]
    ds_read_b64_tr_b16 a[208:209], v1 offset:768
    v_mfma_f32_16x16x32_bf16 a[64:67], a[196:199], a[144:147], a[64:67]
    ds_read_b64_tr_b16 a[210:211], v1 offset:4864
    v_mfma_f32_16x16x32_bf16 a[68:71], a[196:199], a[148:151], a[68:71]
    v_mfma_f32_16x16x32_bf16 a[68:71], a[192:195], a[132:135], a[68:71]
    v_mfma_f32_16x16x32_bf16 a[72:75], a[192:195], a[136:139], a[72:75]
    ds_read_b64_tr_b16 a[212:213], v1 offset:8960
    v_mfma_f32_16x16x32_bf16 a[72:75], a[196:199], a[152:155], a[72:75]
    ds_read_b64_tr_b16 a[214:215], v1 offset:13056
    v_mfma_f32_16x16x32_bf16 a[76:79], a[196:199], a[156:159], a[76:79]
    buffer_load_dwordx4 a[176:179], v7, s[8:11], s28 offen offset:3072 sc1
    v_mfma_f32_16x16x32_bf16 a[76:79], a[192:195], a[140:143], a[76:79]
    s_waitcnt lgkmcnt(4)
    v_mfma_f32_16x16x32_bf16 a[80:83], a[200:203], a[128:131], a[80:83]
    ds_read_b64_tr_b16 a[216:217], v2 offset:768
    v_mfma_f32_16x16x32_bf16 a[80:83], a[204:207], a[144:147], a[80:83]
    ds_read_b64_tr_b16 a[218:219], v2 offset:4864
    v_mfma_f32_16x16x32_bf16 a[84:87], a[204:207], a[148:151], a[84:87]
    v_mfma_f32_16x16x32_bf16 a[84:87], a[200:203], a[132:135], a[84:87]
    v_mfma_f32_16x16x32_bf16 a[88:91], a[200:203], a[136:139], a[88:91]
    ds_read_b64_tr_b16 a[220:221], v2 offset:8960
    v_mfma_f32_16x16x32_bf16 a[88:91], a[204:207], a[152:155], a[88:91]
    ds_read_b64_tr_b16 a[222:223], v2 offset:13056
    v_mfma_f32_16x16x32_bf16 a[92:95], a[204:207], a[156:159], a[92:95]
    buffer_load_dwordx4 a[180:183], v8, s[8:11], s28 offen offset:3072 sc1
    v_mfma_f32_16x16x32_bf16 a[92:95], a[200:203], a[140:143], a[92:95]
    s_waitcnt lgkmcnt(4)
    v_mfma_f32_16x16x32_bf16 a[96:99], a[208:211], a[128:131], a[96:99]
    ds_read_b64_tr_b16 a[192:193], v3 offset:0
    v_mfma_f32_16x16x32_bf16 a[96:99], a[212:215], a[144:147], a[96:99]
    ds_read_b64_tr_b16 a[194:195], v3 offset:3584
    v_mfma_f32_16x16x32_bf16 a[100:103], a[212:215], a[148:151], a[100:103]
    v_mfma_f32_16x16x32_bf16 a[100:103], a[208:211], a[132:135], a[100:103]
    v_mfma_f32_16x16x32_bf16 a[104:107], a[208:211], a[136:139], a[104:107]
    ds_read_b64_tr_b16 a[196:197], v3 offset:7168
    v_mfma_f32_16x16x32_bf16 a[104:107], a[212:215], a[152:155], a[104:107]
    ds_read_b64_tr_b16 a[198:199], v3 offset:10752
    v_mfma_f32_16x16x32_bf16 a[108:111], a[212:215], a[156:159], a[108:111]
    buffer_load_dwordx4 a[184:187], v7, s[8:11], s29 offen offset:3072 sc1
    v_mfma_f32_16x16x32_bf16 a[108:111], a[208:211], a[140:143], a[108:111]
    s_waitcnt lgkmcnt(4)
    v_mfma_f32_16x16x32_bf16 a[112:115], a[216:219], a[128:131], a[112:115]
    ds_read_b64_tr_b16 a[200:201], v3 offset:14336
    v_mfma_f32_16x16x32_bf16 a[112:115], a[220:223], a[144:147], a[112:115]
    ds_read_b64_tr_b16 a[202:203], v3 offset:17920
    v_mfma_f32_16x16x32_bf16 a[116:119], a[220:223], a[148:151], a[116:119]
    v_mfma_f32_16x16x32_bf16 a[116:119], a[216:219], a[132:135], a[116:119]
    v_mfma_f32_16x16x32_bf16 a[120:123], a[216:219], a[136:139], a[120:123]
    ds_read_b64_tr_b16 a[204:205], v3 offset:21504
    v_mfma_f32_16x16x32_bf16 a[120:123], a[220:223], a[152:155], a[120:123]
    ds_read_b64_tr_b16 a[206:207], v3 offset:25088
    v_mfma_f32_16x16x32_bf16 a[124:127], a[220:223], a[156:159], a[124:127]
    buffer_load_dwordx4 a[188:191], v8, s[8:11], s29 offen offset:3072 sc1
    v_mfma_f32_16x16x32_bf16 a[124:127], a[216:219], a[140:143], a[124:127]
    s_waitcnt lgkmcnt(4)
    v_mfma_f32_16x16x32_bf16 v[32:35], a[192:195], a[128:131], v[32:35]
    ds_read_b64_tr_b16 a[208:209], v3 offset:32
    s_add_u32 s28, s28, 4096
    v_mfma_f32_16x16x32_bf16 v[32:35], a[196:199], a[144:147], v[32:35]
    ds_read_b64_tr_b16 a[210:211], v3 offset:3616
    s_add_u32 s29, s29, 4096
    v_mfma_f32_16x16x32_bf16 v[36:39], a[196:199], a[148:151], v[36:39]
    v_mfma_f32_16x16x32_bf16 v[36:39], a[192:195], a[132:135], v[36:39]
    v_mfma_f32_16x16x32_bf16 v[40:43], a[192:195], a[136:139], v[40:43]
    ds_read_b64_tr_b16 a[212:213], v3 offset:7200
    v_mfma_f32_16x16x32_bf16 v[40:43], a[196:199], a[152:155], v[40:43]
    ds_read_b64_tr_b16 a[214:215], v3 offset:10784
    v_mfma_f32_16x16x32_bf16 v[44:47], a[196:199], a[156:159], v[44:47]
    s_add_u32 m0, s42, s43
    v_mfma_f32_16x16x32_bf16 v[44:47], a[192:195], a[140:143], v[44:47]
    s_waitcnt lgkmcnt(4)
    v_mfma_f32_16x16x32_bf16 v[48:51], a[200:203], a[128:131], v[48:51]
    ds_read_b64_tr_b16 a[216:217], v3 offset:14368
    v_mfma_f32_16x16x32_bf16 v[48:51], a[204:207], a[144:147], v[48:51]
    ds_read_b64_tr_b16 a[218:219], v3 offset:17952
    v_mfma_f32_16x16x32_bf16 v[52:55], a[204:207], a[148:151], v[52:55]
    buffer_load_dwordx4 v21, s[20:23], s41 offen lds
    v_mfma_f32_16x16x32_bf16 v[52:55], a[200:203], a[132:135], v[52:55]
    v_mfma_f32_16x16x32_bf16 v[56:59], a[200:203], a[136:139], v[56:59]
    ds_read_b64_tr_b16 a[220:221], v3 offset:21536
    v_mfma_f32_16x16x32_bf16 v[56:59], a[204:207], a[152:155], v[56:59]
    ds_read_b64_tr_b16 a[222:223], v3 offset:25120
    v_mfma_f32_16x16x32_bf16 v[60:63], a[204:207], a[156:159], v[60:63]
    v_mfma_f32_16x16x32_bf16 v[60:63], a[200:203], a[140:143], v[60:63]
    s_waitcnt lgkmcnt(4)
    v_mfma_f32_16x16x32_bf16 v[64:67], a[208:211], a[128:131], v[64:67]
    ds_read_b64_tr_b16 a[192:193], v3 offset:64
    v_mfma_f32_16x16x32_bf16 v[64:67], a[212:215], a[144:147], v[64:67]
    ds_read_b64_tr_b16 a[194:195], v3 offset:3648
    v_mfma_f32_16x16x32_bf16 v[68:71], a[212:215], a[148:151], v[68:71]
    buffer_load_dwordx4 v22, s[20:23], s41 offen offset:1024 lds
    v_mfma_f32_16x16x32_bf16 v[68:71], a[208:211], a[132:135], v[68:71]
    v_mfma_f32_16x16x32_bf16 v[72:75], a[208:211], a[136:139], v[72:75]
    ds_read_b64_tr_b16 a[196:197], v3 offset:7232
    v_mfma_f32_16x16x32_bf16 v[72:75], a[212:215], a[152:155], v[72:75]
    ds_read_b64_tr_b16 a[198:199], v3 offset:10816
    v_mfma_f32_16x16x32_bf16 v[76:79], a[212:215], a[156:159], v[76:79]
    v_mfma_f32_16x16x32_bf16 v[76:79], a[208:211], a[140:143], v[76:79]
    s_waitcnt lgkmcnt(4)
    v_mfma_f32_16x16x32_bf16 v[80:83], a[216:219], a[128:131], v[80:83]
    ds_read_b64_tr_b16 a[200:201], v3 offset:14400
    v_mfma_f32_16x16x32_bf16 v[80:83], a[220:223], a[144:147], v[80:83]
    ds_read_b64_tr_b16 a[202:203], v3 offset:17984
    v_mfma_f32_16x16x32_bf16 v[84:87], a[220:223], a[148:151], v[84:87]
    buffer_load_dwordx4 v23, s[24:27], s41 offen offset:2048 lds
    v_mfma_f32_16x16x32_bf16 v[84:87], a[216:219], a[132:135], v[84:87]
    v_mfma_f32_16x16x32_bf16 v[88:91], a[216:219], a[136:139], v[88:91]
    ds_read_b64_tr_b16 a[204:205], v3 offset:21568
    v_mfma_f32_16x16x32_bf16 v[88:91], a[220:223], a[152:155], v[88:91]
    ds_read_b64_tr_b16 a[206:207], v3 offset:25152
    v_mfma_f32_16x16x32_bf16 v[92:95], a[220:223], a[156:159], v[92:95]
    v_mfma_f32_16x16x32_bf16 v[92:95], a[216:219], a[140:143], v[92:95]
    s_waitcnt lgkmcnt(4)
    v_mfma_f32_16x16x32_bf16 v[96:99], a[192:195], a[128:131], v[96:99]
    ds_read_b64_tr_b16 a[208:209], v3 offset:96
    v_mfma_f32_16x16x32_bf16 v[96:99], a[196:199], a[144:147], v[96:99]
    ds_read_b64_tr_b16 a[210:211], v3 offset:3680
    v_mfma_f32_16x16x32_bf16 v[100:103], a[196:199], a[148:151], v[100:103]
    buffer_load_dwordx4 v26, s[24:27], s41 offen offset:3072 lds
    v_mfma_f32_16x16x32_bf16 v[100:103], a[192:195], a[132:135], v[100:103]
    v_mfma_f32_16x16x32_bf16 v[104:107], a[192:195], a[136:139], v[104:107]
    ds_read_b64_tr_b16 a[212:213], v3 offset:7264
    v_mfma_f32_16x16x32_bf16 v[104:107], a[196:199], a[152:155], v[104:107]
    ds_read_b64_tr_b16 a[214:215], v3 offset:10848
    v_mfma_f32_16x16x32_bf16 v[108:111], a[196:199], a[156:159], v[108:111]
    v_mfma_f32_16x16x32_bf16 v[108:111], a[192:195], a[140:143], v[108:111]
    s_waitcnt lgkmcnt(4)
    v_mfma_f32_16x16x32_bf16 v[112:115], a[200:203], a[128:131], v[112:115]
    ds_read_b64_tr_b16 a[216:217], v3 offset:14432
    v_mfma_f32_16x16x32_bf16 v[112:115], a[204:207], a[144:147], v[112:115]
    ds_read_b64_tr_b16 a[218:219], v3 offset:18016
    v_mfma_f32_16x16x32_bf16 v[116:119], a[204:207], a[148:151], v[116:119]
    v_mfma_f32_16x16x32_bf16 v[116:119], a[200:203], a[132:135], v[116:119]
    s_nop 0
    s_add_u32 s41, s41, 8192
    s_add_u32 s42, s42, 16896
    s_cmp_eq_u32 s42, 135168
    s_cselect_b32 s42, 0, s42
    s_add_u32 m0, s42, s43
    v_mfma_f32_16x16x32_bf16 v[120:123], a[200:203], a[136:139], v[120:123]
    ds_read_b64_tr_b16 a[220:221], v3 offset:21600
    v_mfma_f32_16x16x32_bf16 v[120:123], a[204:207], a[152:155], v[120:123]
    ds_read_b64_tr_b16 a[222:223], v3 offset:25184
    v_mfma_f32_16x16x32_bf16 v[124:127], a[204:207], a[156:159], v[124:127]
    buffer_load_dwordx4 v21, s[20:23], s41 offen lds
    v_mfma_f32_16x16x32_bf16 v[124:127], a[200:203], a[140:143], v[124:127]
    s_waitcnt lgkmcnt(4)
    v_mfma_f32_16x16x32_bf16 v[128:131], a[208:211], a[128:131], v[128:131]
    ds_read_b64_tr_b16 a[192:193], v3 offset:128
    v_mfma_f32_16x16x32_bf16 v[128:131], a[212:215], a[144:147], v[128:131]
    ds_read_b64_tr_b16 a[194:195], v3 offset:3712
    v_mfma_f32_16x16x32_bf16 v[132:135], a[212:215], a[148:151], v[132:135]
    v_mfma_f32_16x16x32_bf16 v[132:135], a[208:211], a[132:135], v[132:135]
    v_mfma_f32_16x16x32_bf16 v[136:139], a[208:211], a[136:139], v[136:139]
    ds_read_b64_tr_b16 a[196:197], v3 offset:7296
    v_mfma_f32_16x16x32_bf16 v[136:139], a[212:215], a[152:155], v[136:139]
    ds_read_b64_tr_b16 a[198:199], v3 offset:10880
    v_mfma_f32_16x16x32_bf16 v[140:143], a[212:215], a[156:159], v[140:143]
    buffer_load_dwordx4 v22, s[20:23], s41 offen offset:1024 lds
    v_mfma_f32_16x16x32_bf16 v[140:143], a[208:211], a[140:143], v[140:143]
    s_waitcnt lgkmcnt(4)
    v_mfma_f32_16x16x32_bf16 v[144:147], a[216:219], a[128:131], v[144:147]
    ds_read_b64_tr_b16 a[200:201], v3 offset:14464
    v_mfma_f32_16x16x32_bf16 v[144:147], a[220:223], a[144:147], v[144:147]
    ds_read_b64_tr_b16 a[202:203], v3 offset:18048
    v_mfma_f32_16x16x32_bf16 v[148:151], a[220:223], a[148:151], v[148:151]
    v_mfma_f32_16x16x32_bf16 v[148:151], a[216:219], a[132:135], v[148:151]
    v_mfma_f32_16x16x32_bf16 v[152:155], a[216:219], a[136:139], v[152:155]
    ds_read_b64_tr_b16 a[204:205], v3 offset:21632
    v_mfma_f32_16x16x32_bf16 v[152:155], a[220:223], a[152:155], v[152:155]
    ds_read_b64_tr_b16 a[206:207], v3 offset:25216
    v_mfma_f32_16x16x32_bf16 v[156:159], a[220:223], a[156:159], v[156:159]
    buffer_load_dwordx4 v23, s[24:27], s41 offen offset:2048 lds
    v_mfma_f32_16x16x32_bf16 v[156:159], a[216:219], a[140:143], v[156:159]
    s_waitcnt lgkmcnt(4)
    v_mfma_f32_16x16x32_bf16 v[160:163], a[192:195], a[128:131], v[160:163]
    ds_read_b64_tr_b16 a[208:209], v3 offset:160
    v_mfma_f32_16x16x32_bf16 v[160:163], a[196:199], a[144:147], v[160:163]
    ds_read_b64_tr_b16 a[210:211], v3 offset:3744
    v_mfma_f32_16x16x32_bf16 v[164:167], a[196:199], a[148:151], v[164:167]
    v_mfma_f32_16x16x32_bf16 v[164:167], a[192:195], a[132:135], v[164:167]
    v_mfma_f32_16x16x32_bf16 v[168:171], a[192:195], a[136:139], v[168:171]
    ds_read_b64_tr_b16 a[212:213], v3 offset:7328
    v_mfma_f32_16x16x32_bf16 v[168:171], a[196:199], a[152:155], v[168:171]
    ds_read_b64_tr_b16 a[214:215], v3 offset:10912
    v_mfma_f32_16x16x32_bf16 v[172:175], a[196:199], a[156:159], v[172:175]
    buffer_load_dwordx4 v26, s[24:27], s41 offen offset:3072 lds
    v_mfma_f32_16x16x32_bf16 v[172:175], a[192:195], a[140:143], v[172:175]
    s_waitcnt lgkmcnt(4)
    v_mfma_f32_16x16x32_bf16 v[176:179], a[200:203], a[128:131], v[176:179]
    ds_read_b64_tr_b16 a[216:217], v3 offset:14496
    v_mfma_f32_16x16x32_bf16 v[176:179], a[204:207], a[144:147], v[176:179]
    ds_read_b64_tr_b16 a[218:219], v3 offset:18080
    v_mfma_f32_16x16x32_bf16 v[180:183], a[204:207], a[148:151], v[180:183]
    v_mfma_f32_16x16x32_bf16 v[180:183], a[200:203], a[132:135], v[180:183]
    v_mfma_f32_16x16x32_bf16 v[184:187], a[200:203], a[136:139], v[184:187]
    ds_read_b64_tr_b16 a[220:221], v3 offset:21664
    v_mfma_f32_16x16x32_bf16 v[184:187], a[204:207], a[152:155], v[184:187]
    ds_read_b64_tr_b16 a[222:223], v3 offset:25248
    v_mfma_f32_16x16x32_bf16 v[188:191], a[204:207], a[156:159], v[188:191]
    s_add_u32 s41, s41, 8192
    s_add_u32 s42, s42, 16896
    s_cmp_eq_u32 s42, 135168
    s_cselect_b32 s42, 0, s42
    v_mfma_f32_16x16x32_bf16 v[188:191], a[200:203], a[140:143], v[188:191]
    s_waitcnt lgkmcnt(4)
    v_mfma_f32_16x16x32_bf16 v[192:195], a[208:211], a[128:131], v[192:195]
    ds_read_b64_tr_b16 a[192:193], v3 offset:192
    v_mfma_f32_16x16x32_bf16 v[192:195], a[212:215], a[144:147], v[192:195]
    ds_read_b64_tr_b16 a[194:195], v3 offset:3776
    v_mfma_f32_16x16x32_bf16 v[196:199], a[212:215], a[148:151], v[196:199]
    s_mov_b32 s33, s32
    v_mfma_f32_16x16x32_bf16 v[196:199], a[208:211], a[132:135], v[196:199]
    v_mfma_f32_16x16x32_bf16 v[200:203], a[208:211], a[136:139], v[200:203]
    ds_read_b64_tr_b16 a[196:197], v3 offset:7360
    v_mfma_f32_16x16x32_bf16 v[200:203], a[212:215], a[152:155], v[200:203]
    ds_read_b64_tr_b16 a[198:199], v3 offset:10944
    v_mfma_f32_16x16x32_bf16 v[204:207], a[212:215], a[156:159], v[204:207]
    s_add_u32 s32, s32, 45056
    v_mfma_f32_16x16x32_bf16 v[204:207], a[208:211], a[140:143], v[204:207]
    s_waitcnt lgkmcnt(4)
    v_mfma_f32_16x16x32_bf16 v[208:211], a[216:219], a[128:131], v[208:211]
    ds_read_b64_tr_b16 a[200:201], v3 offset:14528
    v_mfma_f32_16x16x32_bf16 v[208:211], a[220:223], a[144:147], v[208:211]
    ds_read_b64_tr_b16 a[202:203], v3 offset:18112
    v_mfma_f32_16x16x32_bf16 v[212:215], a[220:223], a[148:151], v[212:215]
    s_cmp_eq_u32 s32, 135168
    s_cselect_b32 s32, 0, s32
    v_mfma_f32_16x16x32_bf16 v[212:215], a[216:219], a[132:135], v[212:215]
    v_mfma_f32_16x16x32_bf16 v[216:219], a[216:219], a[136:139], v[216:219]
    ds_read_b64_tr_b16 a[204:205], v3 offset:21696
    v_mfma_f32_16x16x32_bf16 v[216:219], a[220:223], a[152:155], v[216:219]
    ds_read_b64_tr_b16 a[206:207], v3 offset:25280
    v_mfma_f32_16x16x32_bf16 v[220:223], a[220:223], a[156:159], v[220:223]
    v_add_u32 v1, s32, v4
    v_mfma_f32_16x16x32_bf16 v[220:223], a[216:219], a[140:143], v[220:223]
    v_add_u32 v2, s32, v5
    s_waitcnt lgkmcnt(4)
    v_mfma_f32_16x16x32_bf16 v[224:227], a[192:195], a[128:131], v[224:227]
    v_mfma_f32_16x16x32_bf16 v[224:227], a[196:199], a[144:147], v[224:227]
    v_mfma_f32_16x16x32_bf16 v[228:231], a[196:199], a[148:151], v[228:231]
    v_add_u32_e64 v3, s32, v6
    v_mfma_f32_16x16x32_bf16 v[228:231], a[192:195], a[132:135], v[228:231]
    v_mfma_f32_16x16x32_bf16 v[232:235], a[192:195], a[136:139], v[232:235]
    v_mfma_f32_16x16x32_bf16 v[232:235], a[196:199], a[152:155], v[232:235]
    v_mfma_f32_16x16x32_bf16 v[236:239], a[196:199], a[156:159], v[236:239]
    v_mfma_f32_16x16x32_bf16 v[236:239], a[192:195], a[140:143], v[236:239]
    s_waitcnt vmcnt(16) lgkmcnt(0)
    s_barrier
    v_mfma_f32_16x16x32_bf16 v[240:243], a[200:203], a[128:131], v[240:243]
    ds_read_b64_tr_b16 a[208:209], v1 offset:0
    v_mfma_f32_16x16x32_bf16 v[240:243], a[204:207], a[144:147], v[240:243]
    ds_read_b64_tr_b16 a[210:211], v1 offset:4096
    v_mfma_f32_16x16x32_bf16 v[244:247], a[204:207], a[148:151], v[244:247]
    ds_read_b64_tr_b16 a[212:213], v1 offset:8192
    v_mfma_f32_16x16x32_bf16 v[244:247], a[200:203], a[132:135], v[244:247]
    ds_read_b64_tr_b16 a[214:215], v1 offset:12288
    v_mfma_f32_16x16x32_bf16 v[248:251], a[200:203], a[136:139], v[248:251]
    ds_read_b64_tr_b16 a[216:217], v2 offset:0
    v_mfma_f32_16x16x32_bf16 v[248:251], a[204:207], a[152:155], v[248:251]
    ds_read_b64_tr_b16 a[218:219], v2 offset:4096
    v_mfma_f32_16x16x32_bf16 v[252:255], a[204:207], a[156:159], v[252:255]
    ds_read_b64_tr_b16 a[220:221], v2 offset:8192
    v_mfma_f32_16x16x32_bf16 v[252:255], a[200:203], a[140:143], v[252:255]
    ds_read_b64_tr_b16 a[222:223], v2 offset:12288
    s_waitcnt vmcnt(12) lgkmcnt(4)
    s_waitcnt vmcnt(8)
    v_mfma_f32_16x16x32_bf16 a[0:3], a[208:211], a[160:163], a[0:3]
    ds_read_b64_tr_b16 a[192:193], v1 offset:256
    v_mfma_f32_16x16x32_bf16 a[0:3], a[212:215], a[176:179], a[0:3]
    ds_read_b64_tr_b16 a[194:195], v1 offset:4352
    s_add_u32 m0, s42, s43
    v_mfma_f32_16x16x32_bf16 a[4:7], a[212:215], a[180:183], a[4:7]
    buffer_load_dwordx4 v21, s[20:23], s41 offen lds
    v_mfma_f32_16x16x32_bf16 a[4:7], a[208:211], a[164:167], a[4:7]
    v_mfma_f32_16x16x32_bf16 a[8:11], a[208:211], a[168:171], a[8:11]
    ds_read_b64_tr_b16 a[196:197], v1 offset:8448
    v_mfma_f32_16x16x32_bf16 a[8:11], a[212:215], a[184:187], a[8:11]
    ds_read_b64_tr_b16 a[198:199], v1 offset:12544
    v_mfma_f32_16x16x32_bf16 a[12:15], a[212:215], a[188:191], a[12:15]
    v_mfma_f32_16x16x32_bf16 a[12:15], a[208:211], a[172:175], a[12:15]
    s_waitcnt lgkmcnt(4)
    v_mfma_f32_16x16x32_bf16 a[16:19], a[216:219], a[160:163], a[16:19]
    ds_read_b64_tr_b16 a[200:201], v2 offset:256
    v_mfma_f32_16x16x32_bf16 a[16:19], a[220:223], a[176:179], a[16:19]
    ds_read_b64_tr_b16 a[202:203], v2 offset:4352
    v_mfma_f32_16x16x32_bf16 a[20:23], a[220:223], a[180:183], a[20:23]
    v_mfma_f32_16x16x32_bf16 a[20:23], a[216:219], a[164:167], a[20:23]
    v_mfma_f32_16x16x32_bf16 a[24:27], a[216:219], a[168:171], a[24:27]
    ds_read_b64_tr_b16 a[204:205], v2 offset:8448
    v_mfma_f32_16x16x32_bf16 a[24:27], a[220:223], a[184:187], a[24:27]
    ds_read_b64_tr_b16 a[206:207], v2 offset:12544
    v_mfma_f32_16x16x32_bf16 a[28:31], a[220:223], a[188:191], a[28:31]
    buffer_load_dwordx4 v22, s[20:23], s41 offen offset:1024 lds
    v_mfma_f32_16x16x32_bf16 a[28:31], a[216:219], a[172:175], a[28:31]
    s_waitcnt lgkmcnt(4)
    v_mfma_f32_16x16x32_bf16 a[32:35], a[192:195], a[160:163], a[32:35]
    ds_read_b64_tr_b16 a[208:209], v1 offset:512
    v_mfma_f32_16x16x32_bf16 a[32:35], a[196:199], a[176:179], a[32:35]
    ds_read_b64_tr_b16 a[210:211], v1 offset:4608
    v_mfma_f32_16x16x32_bf16 a[36:39], a[196:199], a[180:183], a[36:39]
    v_mfma_f32_16x16x32_bf16 a[36:39], a[192:195], a[164:167], a[36:39]
    v_mfma_f32_16x16x32_bf16 a[40:43], a[192:195], a[168:171], a[40:43]
    ds_read_b64_tr_b16 a[212:213], v1 offset:8704
    v_mfma_f32_16x16x32_bf16 a[40:43], a[196:199], a[184:187], a[40:43]
    ds_read_b64_tr_b16 a[214:215], v1 offset:12800
    v_mfma_f32_16x16x32_bf16 a[44:47], a[196:199], a[188:191], a[44:47]
    v_mfma_f32_16x16x32_bf16 a[44:47], a[192:195], a[172:175], a[44:47]
    s_waitcnt lgkmcnt(4)
    v_mfma_f32_16x16x32_bf16 a[48:51], a[200:203], a[160:163], a[48:51]
    ds_read_b64_tr_b16 a[216:217], v2 offset:512
    v_mfma_f32_16x16x32_bf16 a[48:51], a[204:207], a[176:179], a[48:51]
    ds_read_b64_tr_b16 a[218:219], v2 offset:4608
    v_mfma_f32_16x16x32_bf16 a[52:55], a[204:207], a[180:183], a[52:55]
    buffer_load_dwordx4 v23, s[24:27], s41 offen offset:2048 lds
    v_mfma_f32_16x16x32_bf16 a[52:55], a[200:203], a[164:167], a[52:55]
    v_mfma_f32_16x16x32_bf16 a[56:59], a[200:203], a[168:171], a[56:59]
    ds_read_b64_tr_b16 a[220:221], v2 offset:8704
    v_mfma_f32_16x16x32_bf16 a[56:59], a[204:207], a[184:187], a[56:59]
    ds_read_b64_tr_b16 a[222:223], v2 offset:12800
    v_mfma_f32_16x16x32_bf16 a[60:63], a[204:207], a[188:191], a[60:63]
    v_mfma_f32_16x16x32_bf16 a[60:63], a[200:203], a[172:175], a[60:63]
    s_waitcnt lgkmcnt(4)
    v_mfma_f32_16x16x32_bf16 a[64:67], a[208:211], a[160:163], a[64:67]
    ds_read_b64_tr_b16 a[192:193], v1 offset:768
    v_mfma_f32_16x16x32_bf16 a[64:67], a[212:215], a[176:179], a[64:67]
    ds_read_b64_tr_b16 a[194:195], v1 offset:4864
    v_mfma_f32_16x16x32_bf16 a[68:71], a[212:215], a[180:183], a[68:71]
    v_mfma_f32_16x16x32_bf16 a[68:71], a[208:211], a[164:167], a[68:71]
    v_mfma_f32_16x16x32_bf16 a[72:75], a[208:211], a[168:171], a[72:75]
    ds_read_b64_tr_b16 a[196:197], v1 offset:8960
    v_mfma_f32_16x16x32_bf16 a[72:75], a[212:215], a[184:187], a[72:75]
    ds_read_b64_tr_b16 a[198:199], v1 offset:13056
    v_mfma_f32_16x16x32_bf16 a[76:79], a[212:215], a[188:191], a[76:79]
    buffer_load_dwordx4 v26, s[24:27], s41 offen offset:3072 lds
    v_mfma_f32_16x16x32_bf16 a[76:79], a[208:211], a[172:175], a[76:79]
    s_waitcnt lgkmcnt(4)
    v_mfma_f32_16x16x32_bf16 a[80:83], a[216:219], a[160:163], a[80:83]
    ds_read_b64_tr_b16 a[200:201], v2 offset:768
    v_mfma_f32_16x16x32_bf16 a[80:83], a[220:223], a[176:179], a[80:83]
    ds_read_b64_tr_b16 a[202:203], v2 offset:4864
    v_mfma_f32_16x16x32_bf16 a[84:87], a[220:223], a[180:183], a[84:87]
    v_mfma_f32_16x16x32_bf16 a[84:87], a[216:219], a[164:167], a[84:87]
    v_mfma_f32_16x16x32_bf16 a[88:91], a[216:219], a[168:171], a[88:91]
    ds_read_b64_tr_b16 a[204:205], v2 offset:8960
    v_mfma_f32_16x16x32_bf16 a[88:91], a[220:223], a[184:187], a[88:91]
    ds_read_b64_tr_b16 a[206:207], v2 offset:13056
    v_mfma_f32_16x16x32_bf16 a[92:95], a[220:223], a[188:191], a[92:95]
    s_add_u32 s41, s41, 8192
    s_add_u32 s42, s42, 16896
    s_cmp_eq_u32 s42, 135168
    s_cselect_b32 s42, 0, s42
    s_add_u32 m0, s42, s43
    v_mfma_f32_16x16x32_bf16 a[92:95], a[216:219], a[172:175], a[92:95]
    s_waitcnt lgkmcnt(4)
    v_mfma_f32_16x16x32_bf16 a[96:99], a[192:195], a[160:163], a[96:99]
    ds_read_b64_tr_b16 a[208:209], v3 offset:0
    v_mfma_f32_16x16x32_bf16 a[96:99], a[196:199], a[176:179], a[96:99]
    ds_read_b64_tr_b16 a[210:211], v3 offset:3584
    v_mfma_f32_16x16x32_bf16 a[100:103], a[196:199], a[180:183], a[100:103]
    buffer_load_dwordx4 v21, s[20:23], s41 offen lds
    v_mfma_f32_16x16x32_bf16 a[100:103], a[192:195], a[164:167], a[100:103]
    v_mfma_f32_16x16x32_bf16 a[104:107], a[192:195], a[168:171], a[104:107]
    ds_read_b64_tr_b16 a[212:213], v3 offset:7168
    v_mfma_f32_16x16x32_bf16 a[104:107], a[196:199], a[184:187], a[104:107]
    ds_read_b64_tr_b16 a[214:215], v3 offset:10752
    v_mfma_f32_16x16x32_bf16 a[108:111], a[196:199], a[188:191], a[108:111]
    v_mfma_f32_16x16x32_bf16 a[108:111], a[192:195], a[172:175], a[108:111]
    s_waitcnt lgkmcnt(4)
    v_mfma_f32_16x16x32_bf16 a[112:115], a[200:203], a[160:163], a[112:115]
    ds_read_b64_tr_b16 a[216:217], v3 offset:14336
    v_mfma_f32_16x16x32_bf16 a[112:115], a[204:207], a[176:179], a[112:115]
    ds_read_b64_tr_b16 a[218:219], v3 offset:17920
    v_mfma_f32_16x16x32_bf16 a[116:119], a[204:207], a[180:183], a[116:119]
    v_mfma_f32_16x16x32_bf16 a[116:119], a[200:203], a[164:167], a[116:119]
    v_mfma_f32_16x16x32_bf16 a[120:123], a[200:203], a[168:171], a[120:123]
    ds_read_b64_tr_b16 a[220:221], v3 offset:21504
    v_mfma_f32_16x16x32_bf16 a[120:123], a[204:207], a[184:187], a[120:123]
    ds_read_b64_tr_b16 a[222:223], v3 offset:25088
    v_mfma_f32_16x16x32_bf16 a[124:127], a[204:207], a[188:191], a[124:127]
    buffer_load_dwordx4 v22, s[20:23], s41 offen offset:1024 lds
    v_mfma_f32_16x16x32_bf16 a[124:127], a[200:203], a[172:175], a[124:127]
    s_waitcnt lgkmcnt(4)
    v_mfma_f32_16x16x32_bf16 v[32:35], a[208:211], a[160:163], v[32:35]
    ds_read_b64_tr_b16 a[192:193], v3 offset:32
    v_mfma_f32_16x16x32_bf16 v[32:35], a[212:215], a[176:179], v[32:35]
    ds_read_b64_tr_b16 a[194:195], v3 offset:3616
    v_mfma_f32_16x16x32_bf16 v[36:39], a[212:215], a[180:183], v[36:39]
    v_mfma_f32_16x16x32_bf16 v[36:39], a[208:211], a[164:167], v[36:39]
    v_mfma_f32_16x16x32_bf16 v[40:43], a[208:211], a[168:171], v[40:43]
    ds_read_b64_tr_b16 a[196:197], v3 offset:7200
    v_mfma_f32_16x16x32_bf16 v[40:43], a[212:215], a[184:187], v[40:43]
    ds_read_b64_tr_b16 a[198:199], v3 offset:10784
    v_mfma_f32_16x16x32_bf16 v[44:47], a[212:215], a[188:191], v[44:47]
    v_mfma_f32_16x16x32_bf16 v[44:47], a[208:211], a[172:175], v[44:47]
    s_waitcnt lgkmcnt(4)
    v_mfma_f32_16x16x32_bf16 v[48:51], a[216:219], a[160:163], v[48:51]
    ds_read_b64_tr_b16 a[200:201], v3 offset:14368
    v_accvgpr_read_b32 v9, a0
    v_accvgpr_read_b32 v10, a1
    v_mfma_f32_16x16x32_bf16 v[48:51], a[220:223], a[176:179], v[48:51]
    ds_read_b64_tr_b16 a[202:203], v3 offset:17952
    v_accvgpr_read_b32 v11, a2
    v_mfma_f32_16x16x32_bf16 v[52:55], a[220:223], a[180:183], v[52:55]
    buffer_load_dwordx4 v23, s[24:27], s41 offen offset:2048 lds
    v_accvgpr_read_b32 v12, a3
    v_accvgpr_read_b32 v13, a16
    v_mfma_f32_16x16x32_bf16 v[52:55], a[216:219], a[164:167], v[52:55]
    v_accvgpr_read_b32 v14, a17
    v_accvgpr_read_b32 v15, a18
    v_accvgpr_read_b32 v16, a19
    v_mfma_f32_16x16x32_bf16 v[56:59], a[216:219], a[168:171], v[56:59]
    ds_read_b64_tr_b16 a[204:205], v3 offset:21536
    v_mul_f32 v9, s52, v9
    v_mul_f32 v10, s52, v10
    v_mfma_f32_16x16x32_bf16 v[56:59], a[220:223], a[184:187], v[56:59]
    ds_read_b64_tr_b16 a[206:207], v3 offset:25120
    v_mul_f32 v11, s52, v11
    v_mul_f32 v12, s52, v12
    v_mfma_f32_16x16x32_bf16 v[60:63], a[220:223], a[188:191], v[60:63]
    v_mul_f32 v13, s52, v13
    v_mul_f32 v14, s52, v14
    v_mul_f32_e64 v15, s52, v15
    v_mfma_f32_16x16x32_bf16 v[60:63], a[216:219], a[172:175], v[60:63]
    v_mul_f32_e64 v16, s52, v16
    v_cvt_pk_bf16_f32 v9, v9, v10
    s_waitcnt lgkmcnt(4)
    v_mfma_f32_16x16x32_bf16 v[64:67], a[192:195], a[160:163], v[64:67]
    ds_read_b64_tr_b16 a[208:209], v3 offset:64
    v_cvt_pk_bf16_f32 v10, v11, v12
    v_cvt_pk_bf16_f32 v11, v13, v14
    v_mfma_f32_16x16x32_bf16 v[64:67], a[196:199], a[176:179], v[64:67]
    ds_read_b64_tr_b16 a[210:211], v3 offset:3648
    v_cvt_pk_bf16_f32 v12, v15, v16
    v_mfma_f32_16x16x32_bf16 v[68:71], a[196:199], a[180:183], v[68:71]
    s_nop 0
    v_permlane32_swap_b32 v9, v11
    v_permlane32_swap_b32 v10, v12
    s_nop 0
    v_mfma_f32_16x16x32_bf16 v[68:71], a[192:195], a[164:167], v[68:71]
    v_permlane16_swap_b32 v9, v11
    v_permlane16_swap_b32 v10, v12
    v_accvgpr_write_b32 a128, v9
    v_mfma_f32_16x16x32_bf16 v[72:75], a[192:195], a[168:171], v[72:75]
    ds_read_b64_tr_b16 a[212:213], v3 offset:7232
    v_accvgpr_write_b32 a129, v10
    v_accvgpr_write_b32 a130, v11
    v_mfma_f32_16x16x32_bf16 v[72:75], a[196:199], a[184:187], v[72:75]
    ds_read_b64_tr_b16 a[214:215], v3 offset:10816
    v_accvgpr_write_b32 a131, v12
    v_accvgpr_read_b32 v9, a32
    v_mfma_f32_16x16x32_bf16 v[76:79], a[196:199], a[188:191], v[76:79]
    buffer_load_dwordx4 v26, s[24:27], s41 offen offset:3072 lds
    v_accvgpr_read_b32 v10, a33
    v_mfma_f32_16x16x32_bf16 v[76:79], a[192:195], a[172:175], v[76:79]
    v_accvgpr_read_b32 v11, a34
    v_accvgpr_read_b32 v12, a35
    s_waitcnt lgkmcnt(4)
    v_mfma_f32_16x16x32_bf16 v[80:83], a[200:203], a[160:163], v[80:83]
    ds_read_b64_tr_b16 a[216:217], v3 offset:14400
    v_accvgpr_read_b32 v13, a48
    v_accvgpr_read_b32 v14, a49
    v_mfma_f32_16x16x32_bf16 v[80:83], a[204:207], a[176:179], v[80:83]
    ds_read_b64_tr_b16 a[218:219], v3 offset:17984
    v_accvgpr_read_b32 v15, a50
    v_mfma_f32_16x16x32_bf16 v[84:87], a[204:207], a[180:183], v[84:87]
    v_accvgpr_read_b32 v16, a51
    v_mul_f32 v9, s52, v9
    v_mul_f32 v10, s52, v10
    v_mul_f32_e64 v11, s52, v11
    v_mfma_f32_16x16x32_bf16 v[84:87], a[200:203], a[164:167], v[84:87]
    v_mul_f32 v12, s52, v12
    v_mul_f32 v13, s52, v13
    v_mul_f32_e64 v14, s52, v14
    v_mfma_f32_16x16x32_bf16 v[88:91], a[200:203], a[168:171], v[88:91]
    ds_read_b64_tr_b16 a[220:221], v3 offset:21568
    v_mul_f32 v15, s52, v15
    v_mul_f32 v16, s52, v16
    v_mfma_f32_16x16x32_bf16 v[88:91], a[204:207], a[184:187], v[88:91]
    ds_read_b64_tr_b16 a[222:223], v3 offset:25152
    v_cvt_pk_bf16_f32 v9, v9, v10
    v_mfma_f32_16x16x32_bf16 v[92:95], a[204:207], a[188:191], v[92:95]
    s_add_u32 s41, s41, 8192
    s_add_u32 s42, s42, 16896
    s_cmp_eq_u32 s42, 135168
    s_cselect_b32 s42, 0, s42
    s_add_u32 m0, s42, s43
    v_cvt_pk_bf16_f32 v10, v11, v12
    v_mfma_f32_16x16x32_bf16 v[92:95], a[200:203], a[172:175], v[92:95]
    v_cvt_pk_bf16_f32 v11, v13, v14
    v_cvt_pk_bf16_f32 v12, v15, v16
    s_waitcnt lgkmcnt(4)
    v_mfma_f32_16x16x32_bf16 v[96:99], a[208:211], a[160:163], v[96:99]
    ds_read_b64_tr_b16 a[192:193], v3 offset:96
    s_nop 0
    v_mfma_f32_16x16x32_bf16 v[96:99], a[212:215], a[176:179], v[96:99]
    ds_read_b64_tr_b16 a[194:195], v3 offset:3680
    v_permlane32_swap_b32 v9, v11
    v_permlane32_swap_b32 v10, v12
    v_mfma_f32_16x16x32_bf16 v[100:103], a[212:215], a[180:183], v[100:103]
    buffer_load_dwordx4 v21, s[20:23], s41 offen lds
    s_nop 0
    v_permlane16_swap_b32 v9, v11
    v_mfma_f32_16x16x32_bf16 v[100:103], a[208:211], a[164:167], v[100:103]
    v_permlane16_swap_b32 v10, v12
    v_accvgpr_write_b32 a132, v9
    v_accvgpr_write_b32 a133, v10
    v_mfma_f32_16x16x32_bf16 v[104:107], a[208:211], a[168:171], v[104:107]
    ds_read_b64_tr_b16 a[196:197], v3 offset:7264
    v_accvgpr_write_b32 a134, v11
    v_accvgpr_write_b32 a135, v12
    v_mfma_f32_16x16x32_bf16 v[104:107], a[212:215], a[184:187], v[104:107]
    ds_read_b64_tr_b16 a[198:199], v3 offset:10848
    v_accvgpr_read_b32 v9, a64
    v_mfma_f32_16x16x32_bf16 v[108:111], a[212:215], a[188:191], v[108:111]
    v_accvgpr_read_b32 v10, a65
    v_accvgpr_read_b32 v11, a66
    v_accvgpr_read_b32 v12, a67
    v_accvgpr_read_b32 v13, a80
    v_mfma_f32_16x16x32_bf16 v[108:111], a[208:211], a[172:175], v[108:111]
    v_accvgpr_read_b32 v14, a81
    v_accvgpr_read_b32 v15, a82
    s_waitcnt lgkmcnt(4)
    v_mfma_f32_16x16x32_bf16 v[112:115], a[216:219], a[160:163], v[112:115]
    ds_read_b64_tr_b16 a[200:201], v3 offset:14432
    v_accvgpr_read_b32 v16, a83
    v_mfma_f32_16x16x32_bf16 v[112:115], a[220:223], a[176:179], v[112:115]
    ds_read_b64_tr_b16 a[202:203], v3 offset:18016
    v_mul_f32 v9, s52, v9
    v_mul_f32 v10, s52, v10
    v_mfma_f32_16x16x32_bf16 v[116:119], a[220:223], a[180:183], v[116:119]
    v_mul_f32 v11, s52, v11
    v_mul_f32 v12, s52, v12
    v_mul_f32_e64 v13, s52, v13
    v_mfma_f32_16x16x32_bf16 v[116:119], a[216:219], a[164:167], v[116:119]
    v_mul_f32 v14, s52, v14
    v_mul_f32 v15, s52, v15
    v_mul_f32_e64 v16, s52, v16
    v_cvt_pk_bf16_f32 v9, v9, v10
    v_mfma_f32_16x16x32_bf16 v[120:123], a[216:219], a[168:171], v[120:123]
    ds_read_b64_tr_b16 a[204:205], v3 offset:21600
    v_cvt_pk_bf16_f32 v10, v11, v12
    v_mfma_f32_16x16x32_bf16 v[120:123], a[220:223], a[184:187], v[120:123]
    ds_read_b64_tr_b16 a[206:207], v3 offset:25184
    v_cvt_pk_bf16_f32 v11, v13, v14
    v_cvt_pk_bf16_f32 v12, v15, v16
    v_mfma_f32_16x16x32_bf16 v[124:127], a[220:223], a[188:191], v[124:127]
    buffer_load_dwordx4 v22, s[20:23], s41 offen offset:1024 lds
    s_nop 0
    v_permlane32_swap_b32 v9, v11
    v_mfma_f32_16x16x32_bf16 v[124:127], a[216:219], a[172:175], v[124:127]
    v_permlane32_swap_b32 v10, v12
    s_nop 0
    s_waitcnt lgkmcnt(4)
    v_mfma_f32_16x16x32_bf16 v[128:131], a[192:195], a[160:163], v[128:131]
    ds_read_b64_tr_b16 a[208:209], v3 offset:128
    v_permlane16_swap_b32 v9, v11
    v_mfma_f32_16x16x32_bf16 v[128:131], a[196:199], a[176:179], v[128:131]
    ds_read_b64_tr_b16 a[210:211], v3 offset:3712
    v_permlane16_swap_b32 v10, v12
    v_accvgpr_write_b32 a136, v9
    v_mfma_f32_16x16x32_bf16 v[132:135], a[196:199], a[180:183], v[132:135]
    v_accvgpr_write_b32 a137, v10
    v_accvgpr_write_b32 a138, v11
    v_accvgpr_write_b32 a139, v12
    v_mfma_f32_16x16x32_bf16 v[132:135], a[192:195], a[164:167], v[132:135]
    v_accvgpr_read_b32 v9, a96
    v_accvgpr_read_b32 v10, a97
    v_accvgpr_read_b32 v11, a98
    v_accvgpr_read_b32 v12, a99
    v_mfma_f32_16x16x32_bf16 v[136:139], a[192:195], a[168:171], v[136:139]
    ds_read_b64_tr_b16 a[212:213], v3 offset:7296
    v_accvgpr_read_b32 v13, a112
    v_mfma_f32_16x16x32_bf16 v[136:139], a[196:199], a[184:187], v[136:139]
    ds_read_b64_tr_b16 a[214:215], v3 offset:10880
    v_accvgpr_read_b32 v14, a113
    v_accvgpr_read_b32 v15, a114
    v_mfma_f32_16x16x32_bf16 v[140:143], a[196:199], a[188:191], v[140:143]
    v_accvgpr_read_b32 v16, a115
    v_mul_f32 v9, s52, v9
    v_mul_f32_e64 v10, s52, v10
    v_mfma_f32_16x16x32_bf16 v[140:143], a[192:195], a[172:175], v[140:143]
    v_mul_f32 v11, s52, v11
    v_mul_f32_e64 v12, s52, v12
    s_waitcnt lgkmcnt(4)
    v_mfma_f32_16x16x32_bf16 v[144:147], a[200:203], a[160:163], v[144:147]
    ds_read_b64_tr_b16 a[216:217], v3 offset:14464
    v_mul_f32 v13, s52, v13
    v_mul_f32 v14, s52, v14
    v_mfma_f32_16x16x32_bf16 v[144:147], a[204:207], a[176:179], v[144:147]
    ds_read_b64_tr_b16 a[218:219], v3 offset:18048
    v_mul_f32 v15, s52, v15
    v_mul_f32 v16, s52, v16
    v_mfma_f32_16x16x32_bf16 v[148:151], a[204:207], a[180:183], v[148:151]
    buffer_load_dwordx4 v23, s[24:27], s41 offen offset:2048 lds
    v_cvt_pk_bf16_f32 v9, v9, v10
    v_mfma_f32_16x16x32_bf16 v[148:151], a[200:203], a[164:167], v[148:151]
    v_cvt_pk_bf16_f32 v10, v11, v12
    v_cvt_pk_bf16_f32 v11, v13, v14
    v_cvt_pk_bf16_f32 v12, v15, v16
    s_nop 0
    v_mfma_f32_16x16x32_bf16 v[152:155], a[200:203], a[168:171], v[152:155]
    ds_read_b64_tr_b16 a[220:221], v3 offset:21632
    v_permlane32_swap_b32 v9, v11
    v_mfma_f32_16x16x32_bf16 v[152:155], a[204:207], a[184:187], v[152:155]
    ds_read_b64_tr_b16 a[222:223], v3 offset:25216
    v_permlane32_swap_b32 v10, v12
    s_nop 0
    v_mfma_f32_16x16x32_bf16 v[156:159], a[204:207], a[188:191], v[156:159]
    v_permlane16_swap_b32 v9, v11
    v_permlane16_swap_b32 v10, v12
    v_accvgpr_write_b32 a140, v9
    v_mfma_f32_16x16x32_bf16 v[156:159], a[200:203], a[172:175], v[156:159]
    v_accvgpr_write_b32 a141, v10
    v_accvgpr_write_b32 a142, v11
    s_waitcnt lgkmcnt(4)
    v_mfma_f32_16x16x32_bf16 v[160:163], a[208:211], a[160:163], v[160:163]
    ds_read_b64_tr_b16 a[192:193], v3 offset:160
    v_accvgpr_write_b32 a143, v12
    v_accvgpr_read_b32 v9, a4
    v_mfma_f32_16x16x32_bf16 v[160:163], a[212:215], a[176:179], v[160:163]
    ds_read_b64_tr_b16 a[194:195], v3 offset:3744
    v_accvgpr_read_b32 v10, a5
    v_accvgpr_read_b32 v11, a6
    v_mfma_f32_16x16x32_bf16 v[164:167], a[212:215], a[180:183], v[164:167]
    v_accvgpr_read_b32 v12, a7
    v_accvgpr_read_b32 v13, a20
    v_accvgpr_read_b32 v14, a21
    v_mfma_f32_16x16x32_bf16 v[164:167], a[208:211], a[164:167], v[164:167]
    v_accvgpr_read_b32 v15, a22
    v_accvgpr_read_b32 v16, a23
    v_mul_f32 v9, s52, v9
    v_mfma_f32_16x16x32_bf16 v[168:171], a[208:211], a[168:171], v[168:171]
    ds_read_b64_tr_b16 a[196:197], v3 offset:7328
    v_mul_f32 v10, s52, v10
    v_mul_f32 v11, s52, v11
    v_mfma_f32_16x16x32_bf16 v[168:171], a[212:215], a[184:187], v[168:171]
    ds_read_b64_tr_b16 a[198:199], v3 offset:10912
    v_mul_f32 v12, s52, v12
    v_mul_f32 v13, s52, v13
    v_mfma_f32_16x16x32_bf16 v[172:175], a[212:215], a[188:191], v[172:175]
    buffer_load_dwordx4 v26, s[24:27], s41 offen offset:3072 lds
    v_mul_f32_e64 v14, s52, v14
    v_mfma_f32_16x16x32_bf16 v[172:175], a[208:211], a[172:175], v[172:175]
    v_mul_f32 v15, s52, v15
    v_mul_f32_e64 v16, s52, v16
    s_waitcnt lgkmcnt(4)
    v_mfma_f32_16x16x32_bf16 v[176:179], a[216:219], a[160:163], v[176:179]
    ds_read_b64_tr_b16 a[200:201], v3 offset:14496
    v_cvt_pk_bf16_f32 v9, v9, v10
    v_cvt_pk_bf16_f32 v10, v11, v12
    v_mfma_f32_16x16x32_bf16 v[176:179], a[220:223], a[176:179], v[176:179]
    ds_read_b64_tr_b16 a[202:203], v3 offset:18080
    v_cvt_pk_bf16_f32 v11, v13, v14
    v_cvt_pk_bf16_f32 v12, v15, v16
    v_mfma_f32_16x16x32_bf16 v[180:183], a[220:223], a[180:183], v[180:183]
    s_add_u32 s41, s41, 8192
    s_add_u32 s42, s42, 16896
    s_cmp_eq_u32 s42, 135168
    s_cselect_b32 s42, 0, s42
    v_mfma_f32_16x16x32_bf16 v[180:183], a[216:219], a[164:167], v[180:183]
    s_nop 0
    v_permlane32_swap_b32 v9, v11
    v_permlane32_swap_b32 v10, v12
    v_mfma_f32_16x16x32_bf16 v[184:187], a[216:219], a[168:171], v[184:187]
    ds_read_b64_tr_b16 a[204:205], v3 offset:21664
    s_nop 0
    v_permlane16_swap_b32 v9, v11
    v_mfma_f32_16x16x32_bf16 v[184:187], a[220:223], a[184:187], v[184:187]
    ds_read_b64_tr_b16 a[206:207], v3 offset:25248
    v_permlane16_swap_b32 v10, v12
    v_accvgpr_write_b32 a144, v9
    v_mfma_f32_16x16x32_bf16 v[188:191], a[220:223], a[188:191], v[188:191]
    v_accvgpr_write_b32 a145, v10
    v_accvgpr_write_b32 a146, v11
    v_accvgpr_write_b32 a147, v12
    v_mfma_f32_16x16x32_bf16 v[188:191], a[216:219], a[172:175], v[188:191]
    v_accvgpr_read_b32 v9, a36
    v_accvgpr_read_b32 v10, a37
    s_waitcnt lgkmcnt(4)
    v_mfma_f32_16x16x32_bf16 v[192:195], a[192:195], a[160:163], v[192:195]
    ds_read_b64_tr_b16 a[208:209], v3 offset:192
    v_accvgpr_read_b32 v11, a38
    v_mfma_f32_16x16x32_bf16 v[192:195], a[196:199], a[176:179], v[192:195]
    ds_read_b64_tr_b16 a[210:211], v3 offset:3776
    v_accvgpr_read_b32 v12, a39
    v_accvgpr_read_b32 v13, a52
    v_mfma_f32_16x16x32_bf16 v[196:199], a[196:199], a[180:183], v[196:199]
    v_accvgpr_read_b32 v14, a53
    v_accvgpr_read_b32 v15, a54
    v_accvgpr_read_b32 v16, a55
    v_mul_f32_e64 v9, s52, v9
    v_mfma_f32_16x16x32_bf16 v[196:199], a[192:195], a[164:167], v[196:199]
    v_mul_f32 v10, s52, v10
    v_mul_f32 v11, s52, v11
    v_mul_f32_e64 v12, s52, v12
    v_mfma_f32_16x16x32_bf16 v[200:203], a[192:195], a[168:171], v[200:203]
    ds_read_b64_tr_b16 a[212:213], v3 offset:7360
    v_mul_f32 v13, s52, v13
    v_mul_f32 v14, s52, v14
    v_mfma_f32_16x16x32_bf16 v[200:203], a[196:199], a[184:187], v[200:203]
    ds_read_b64_tr_b16 a[214:215], v3 offset:10944
    v_mul_f32_e64 v15, s52, v15
    v_mfma_f32_16x16x32_bf16 v[204:207], a[196:199], a[188:191], v[204:207]
    v_mul_f32_e64 v16, s52, v16
    v_cvt_pk_bf16_f32 v9, v9, v10
    v_cvt_pk_bf16_f32 v10, v11, v12
    v_cvt_pk_bf16_f32 v11, v13, v14
    v_mfma_f32_16x16x32_bf16 v[204:207], a[192:195], a[172:175], v[204:207]
    v_cvt_pk_bf16_f32 v12, v15, v16
    s_waitcnt lgkmcnt(4)
    v_mfma_f32_16x16x32_bf16 v[208:211], a[200:203], a[160:163], v[208:211]
    ds_read_b64_tr_b16 a[216:217], v3 offset:14528
    s_nop 0
    v_permlane32_swap_b32 v9, v11
    v_mfma_f32_16x16x32_bf16 v[208:211], a[204:207], a[176:179], v[208:211]
    ds_read_b64_tr_b16 a[218:219], v3 offset:18112
    v_permlane32_swap_b32 v10, v12
    s_nop 0
    v_mfma_f32_16x16x32_bf16 v[212:215], a[204:207], a[180:183], v[212:215]
    v_permlane16_swap_b32 v9, v11
    v_permlane16_swap_b32 v10, v12
    v_accvgpr_write_b32 a148, v9
    v_mfma_f32_16x16x32_bf16 v[212:215], a[200:203], a[164:167], v[212:215]
    v_accvgpr_write_b32 a149, v10
    v_accvgpr_write_b32 a150, v11
    v_accvgpr_write_b32 a151, v12
    v_accvgpr_read_b32 v9, a68
    v_mfma_f32_16x16x32_bf16 v[216:219], a[200:203], a[168:171], v[216:219]
    ds_read_b64_tr_b16 a[220:221], v3 offset:21696
    v_accvgpr_read_b32 v10, a69
    v_mfma_f32_16x16x32_bf16 v[216:219], a[204:207], a[184:187], v[216:219]
    ds_read_b64_tr_b16 a[222:223], v3 offset:25280
    v_accvgpr_read_b32 v11, a70
    v_accvgpr_read_b32 v12, a71
    v_mfma_f32_16x16x32_bf16 v[220:223], a[204:207], a[188:191], v[220:223]
    v_accvgpr_read_b32 v13, a84
    v_accvgpr_read_b32 v14, a85
    v_accvgpr_read_b32 v15, a86
    v_mfma_f32_16x16x32_bf16 v[220:223], a[200:203], a[172:175], v[220:223]
    v_accvgpr_read_b32 v16, a87
    v_mul_f32_e64 v9, s52, v9
    s_waitcnt lgkmcnt(4)
    v_mfma_f32_16x16x32_bf16 v[224:227], a[208:211], a[160:163], v[224:227]
    v_mul_f32 v10, s52, v10
    v_mul_f32 v11, s52, v11
    v_mul_f32 v12, s52, v12
    v_mul_f32 v13, s52, v13
    v_mfma_f32_16x16x32_bf16 v[224:227], a[212:215], a[176:179], v[224:227]
    v_mul_f32 v14, s52, v14
    v_mul_f32 v15, s52, v15
    v_mul_f32_e64 v16, s52, v16
    v_mfma_f32_16x16x32_bf16 v[228:231], a[212:215], a[180:183], v[228:231]
    v_cvt_pk_bf16_f32 v9, v9, v10
    v_cvt_pk_bf16_f32 v10, v11, v12
    v_cvt_pk_bf16_f32 v11, v13, v14
    v_mfma_f32_16x16x32_bf16 v[228:231], a[208:211], a[164:167], v[228:231]
    v_cvt_pk_bf16_f32 v12, v15, v16
    s_nop 0
    v_permlane32_swap_b32 v9, v11
    v_permlane32_swap_b32 v10, v12
    v_mfma_f32_16x16x32_bf16 v[232:235], a[208:211], a[168:171], v[232:235]
    s_nop 0
    v_permlane16_swap_b32 v9, v11
    v_permlane16_swap_b32 v10, v12
    v_mfma_f32_16x16x32_bf16 v[232:235], a[212:215], a[184:187], v[232:235]
    v_accvgpr_write_b32 a152, v9
    v_accvgpr_write_b32 a153, v10
    v_accvgpr_write_b32 a154, v11
    v_mfma_f32_16x16x32_bf16 v[236:239], a[212:215], a[188:191], v[236:239]
    v_accvgpr_write_b32 a155, v12
    v_accvgpr_read_b32 v9, a100
    v_accvgpr_read_b32 v10, a101
    v_accvgpr_read_b32 v11, a102
    v_mfma_f32_16x16x32_bf16 v[236:239], a[208:211], a[172:175], v[236:239]
    v_accvgpr_read_b32 v12, a103
    v_accvgpr_read_b32 v13, a116
    s_waitcnt vmcnt(12) lgkmcnt(0)
    s_barrier
    v_mfma_f32_16x16x32_bf16 v[240:243], a[216:219], a[160:163], v[240:243]
    v_accvgpr_read_b32 v14, a117
    v_accvgpr_read_b32 v15, a118
    v_accvgpr_read_b32 v16, a119
    v_mfma_f32_16x16x32_bf16 v[240:243], a[220:223], a[176:179], v[240:243]
    v_mul_f32 v9, s52, v9
    v_mul_f32 v10, s52, v10
    v_mul_f32_e64 v11, s52, v11
    v_mfma_f32_16x16x32_bf16 v[244:247], a[220:223], a[180:183], v[244:247]
    v_mul_f32 v12, s52, v12
    v_mul_f32 v13, s52, v13
    v_mul_f32 v14, s52, v14
    v_mul_f32 v15, s52, v15
    v_mfma_f32_16x16x32_bf16 v[244:247], a[216:219], a[164:167], v[244:247]
    v_mul_f32_e64 v16, s52, v16
    v_cvt_pk_bf16_f32 v9, v9, v10
    v_cvt_pk_bf16_f32 v10, v11, v12
    v_mfma_f32_16x16x32_bf16 v[248:251], a[216:219], a[168:171], v[248:251]
    v_cvt_pk_bf16_f32 v11, v13, v14
    v_cvt_pk_bf16_f32 v12, v15, v16
    s_nop 0
    v_permlane32_swap_b32 v9, v11
    v_mfma_f32_16x16x32_bf16 v[248:251], a[220:223], a[184:187], v[248:251]
    v_permlane32_swap_b32 v10, v12
    s_nop 0
    v_permlane16_swap_b32 v9, v11
    v_mfma_f32_16x16x32_bf16 v[252:255], a[220:223], a[188:191], v[252:255]
    v_permlane16_swap_b32 v10, v12
    v_accvgpr_write_b32 a156, v9
    v_accvgpr_write_b32 a157, v10
    v_mfma_f32_16x16x32_bf16 v[252:255], a[216:219], a[172:175], v[252:255]
    v_accvgpr_write_b32 a158, v11
    v_accvgpr_write_b32 a159, v12
    v_lshrrev_b32_e64 v0, 4, v20
    s_add_u32 m0, s42, s43
    s_nop 0
    buffer_load_dwordx4 v21, s[20:23], s41 offen lds
    buffer_load_dwordx4 v22, s[20:23], s41 offen offset:1024 lds
    buffer_load_dwordx4 v23, s[24:27], s41 offen offset:2048 lds
    buffer_load_dwordx4 v26, s[24:27], s41 offen offset:3072 lds
    s_add_u32 s41, s41, 8192
    s_add_u32 s42, s42, 16896
    s_cmp_eq_u32 s42, 135168
    s_cselect_b32 s42, 0, s42
    s_add_u32 m0, s42, s43
    s_nop 0
    s_nop 0
    buffer_load_dwordx4 v21, s[20:23], s41 offen lds
    buffer_load_dwordx4 v22, s[20:23], s41 offen offset:1024 lds
    buffer_load_dwordx4 v23, s[24:27], s41 offen offset:2048 lds
    buffer_load_dwordx4 v26, s[24:27], s41 offen offset:3072 lds
    s_add_u32 s41, s41, 8192
    s_add_u32 s42, s42, 16896
    s_cmp_eq_u32 s42, 135168
    s_cselect_b32 s42, 0, s42
    s_add_u32 m0, s42, s43
    s_nop 0
    s_nop 0
    buffer_load_dwordx4 v21, s[20:23], s41 offen lds
    buffer_load_dwordx4 v22, s[20:23], s41 offen offset:1024 lds
    buffer_load_dwordx4 v23, s[24:27], s41 offen offset:2048 lds
    buffer_load_dwordx4 v26, s[24:27], s41 offen offset:3072 lds
    s_add_u32 s41, s41, 8192
    s_add_u32 s42, s42, 16896
    s_cmp_eq_u32 s42, 135168
    s_cselect_b32 s42, 0, s42
    s_nop 0
    v_pk_mul_f32 v[32:33], v[32:33], v[48:49]
    v_pk_mul_f32 v[34:35], v[34:35], v[50:51]
    v_cvt_pk_bf16_f32 v48, v32, v33
    v_cvt_pk_bf16_f32 v49, v34, v35
    v_accvgpr_write_b32 a0, v48
    v_accvgpr_write_b32 a1, v49
    v_pk_mul_f32 v[36:37], v[36:37], v[52:53]
    v_pk_mul_f32 v[38:39], v[38:39], v[54:55]
    v_cvt_pk_bf16_f32 v52, v36, v37
    v_cvt_pk_bf16_f32 v53, v38, v39
    v_accvgpr_write_b32 a4, v52
    v_accvgpr_write_b32 a5, v53
    v_pk_mul_f32 v[40:41], v[40:41], v[56:57]
    v_pk_mul_f32 v[42:43], v[42:43], v[58:59]
    v_cvt_pk_bf16_f32 v56, v40, v41
    v_cvt_pk_bf16_f32 v57, v42, v43
    v_accvgpr_write_b32 a16, v56
    v_accvgpr_write_b32 a17, v57
    v_pk_mul_f32 v[44:45], v[44:45], v[60:61]
    v_pk_mul_f32 v[46:47], v[46:47], v[62:63]
    v_cvt_pk_bf16_f32 v60, v44, v45
    v_cvt_pk_bf16_f32 v61, v46, v47
    v_accvgpr_write_b32 a20, v60
    v_accvgpr_write_b32 a21, v61
    v_pk_mul_f32 v[64:65], v[64:65], v[80:81]
    v_pk_mul_f32 v[66:67], v[66:67], v[82:83]
    v_cvt_pk_bf16_f32 v80, v64, v65
    v_cvt_pk_bf16_f32 v81, v66, v67
    v_accvgpr_write_b32 a2, v80
    v_accvgpr_write_b32 a3, v81
    v_pk_mul_f32 v[68:69], v[68:69], v[84:85]
    v_pk_mul_f32 v[70:71], v[70:71], v[86:87]
    v_cvt_pk_bf16_f32 v84, v68, v69
    v_cvt_pk_bf16_f32 v85, v70, v71
    v_accvgpr_write_b32 a6, v84
    v_accvgpr_write_b32 a7, v85
    v_pk_mul_f32 v[72:73], v[72:73], v[88:89]
    v_pk_mul_f32 v[74:75], v[74:75], v[90:91]
    v_cvt_pk_bf16_f32 v88, v72, v73
    v_cvt_pk_bf16_f32 v89, v74, v75
    v_accvgpr_write_b32 a18, v88
    v_accvgpr_write_b32 a19, v89
    v_pk_mul_f32 v[76:77], v[76:77], v[92:93]
    v_pk_mul_f32 v[78:79], v[78:79], v[94:95]
    v_cvt_pk_bf16_f32 v92, v76, v77
    v_cvt_pk_bf16_f32 v93, v78, v79
    v_accvgpr_write_b32 a22, v92
    v_accvgpr_write_b32 a23, v93
    v_pk_mul_f32 v[96:97], v[96:97], v[112:113]
    v_pk_mul_f32 v[98:99], v[98:99], v[114:115]
    v_cvt_pk_bf16_f32 v112, v96, v97
    v_cvt_pk_bf16_f32 v113, v98, v99
    v_accvgpr_write_b32 a32, v112
    v_accvgpr_write_b32 a33, v113
    buffer_store_dwordx4 a[0:3], v20, s[8:11], s44 offen offset:0 sc1
    v_pk_mul_f32 v[100:101], v[100:101], v[116:117]
    v_pk_mul_f32 v[102:103], v[102:103], v[118:119]
    v_cvt_pk_bf16_f32 v116, v100, v101
    v_cvt_pk_bf16_f32 v117, v102, v103
    v_accvgpr_write_b32 a36, v116
    v_accvgpr_write_b32 a37, v117
    v_pk_mul_f32 v[104:105], v[104:105], v[120:121]
    v_pk_mul_f32 v[106:107], v[106:107], v[122:123]
    v_cvt_pk_bf16_f32 v120, v104, v105
    v_cvt_pk_bf16_f32 v121, v106, v107
    v_accvgpr_write_b32 a48, v120
    v_accvgpr_write_b32 a49, v121
    v_pk_mul_f32 v[108:109], v[108:109], v[124:125]
    v_pk_mul_f32 v[110:111], v[110:111], v[126:127]
    v_cvt_pk_bf16_f32 v124, v108, v109
    v_cvt_pk_bf16_f32 v125, v110, v111
    v_accvgpr_write_b32 a52, v124
    v_accvgpr_write_b32 a53, v125
    v_pk_mul_f32 v[128:129], v[128:129], v[144:145]
    v_pk_mul_f32 v[130:131], v[130:131], v[146:147]
    v_cvt_pk_bf16_f32 v144, v128, v129
    v_cvt_pk_bf16_f32 v145, v130, v131
    v_accvgpr_write_b32 a34, v144
    v_accvgpr_write_b32 a35, v145
    v_pk_mul_f32 v[132:133], v[132:133], v[148:149]
    v_pk_mul_f32 v[134:135], v[134:135], v[150:151]
    v_cvt_pk_bf16_f32 v148, v132, v133
    v_cvt_pk_bf16_f32 v149, v134, v135
    v_accvgpr_write_b32 a38, v148
    v_accvgpr_write_b32 a39, v149
    v_pk_mul_f32 v[136:137], v[136:137], v[152:153]
    v_pk_mul_f32 v[138:139], v[138:139], v[154:155]
    v_cvt_pk_bf16_f32 v152, v136, v137
    v_cvt_pk_bf16_f32 v153, v138, v139
    v_accvgpr_write_b32 a50, v152
    v_accvgpr_write_b32 a51, v153
    v_pk_mul_f32 v[140:141], v[140:141], v[156:157]
    v_pk_mul_f32 v[142:143], v[142:143], v[158:159]
    v_cvt_pk_bf16_f32 v156, v140, v141
    v_cvt_pk_bf16_f32 v157, v142, v143
    v_accvgpr_write_b32 a54, v156
    v_accvgpr_write_b32 a55, v157
    v_pk_mul_f32 v[160:161], v[160:161], v[176:177]
    v_pk_mul_f32 v[162:163], v[162:163], v[178:179]
    v_cvt_pk_bf16_f32 v176, v160, v161
    v_cvt_pk_bf16_f32 v177, v162, v163
    v_accvgpr_write_b32 a64, v176
    v_accvgpr_write_b32 a65, v177
    buffer_store_dwordx4 a[4:7], v20, s[8:11], s45 offen offset:0 sc1
    v_pk_mul_f32 v[164:165], v[164:165], v[180:181]
    v_pk_mul_f32 v[166:167], v[166:167], v[182:183]
    v_cvt_pk_bf16_f32 v180, v164, v165
    v_cvt_pk_bf16_f32 v181, v166, v167
    v_accvgpr_write_b32 a68, v180
    v_accvgpr_write_b32 a69, v181
    v_pk_mul_f32 v[168:169], v[168:169], v[184:185]
    v_pk_mul_f32 v[170:171], v[170:171], v[186:187]
    v_cvt_pk_bf16_f32 v184, v168, v169
    v_cvt_pk_bf16_f32 v185, v170, v171
    v_accvgpr_write_b32 a80, v184
    v_accvgpr_write_b32 a81, v185
    v_pk_mul_f32 v[172:173], v[172:173], v[188:189]
    v_pk_mul_f32 v[174:175], v[174:175], v[190:191]
    v_cvt_pk_bf16_f32 v188, v172, v173
    v_cvt_pk_bf16_f32 v189, v174, v175
    v_accvgpr_write_b32 a84, v188
    v_accvgpr_write_b32 a85, v189
    v_pk_mul_f32 v[192:193], v[192:193], v[208:209]
    v_pk_mul_f32 v[194:195], v[194:195], v[210:211]
    v_cvt_pk_bf16_f32 v208, v192, v193
    v_cvt_pk_bf16_f32 v209, v194, v195
    v_accvgpr_write_b32 a66, v208
    v_accvgpr_write_b32 a67, v209
    v_pk_mul_f32 v[196:197], v[196:197], v[212:213]
    v_pk_mul_f32 v[198:199], v[198:199], v[214:215]
    v_cvt_pk_bf16_f32 v212, v196, v197
    v_cvt_pk_bf16_f32 v213, v198, v199
    v_accvgpr_write_b32 a70, v212
    v_accvgpr_write_b32 a71, v213
    v_pk_mul_f32 v[200:201], v[200:201], v[216:217]
    v_pk_mul_f32 v[202:203], v[202:203], v[218:219]
    v_cvt_pk_bf16_f32 v216, v200, v201
    v_cvt_pk_bf16_f32 v217, v202, v203
    v_accvgpr_write_b32 a82, v216
    v_accvgpr_write_b32 a83, v217
    v_pk_mul_f32 v[204:205], v[204:205], v[220:221]
    v_pk_mul_f32 v[206:207], v[206:207], v[222:223]
    v_cvt_pk_bf16_f32 v220, v204, v205
    v_cvt_pk_bf16_f32 v221, v206, v207
    v_accvgpr_write_b32 a86, v220
    v_accvgpr_write_b32 a87, v221
    v_pk_mul_f32 v[224:225], v[224:225], v[240:241]
    v_pk_mul_f32 v[226:227], v[226:227], v[242:243]
    v_cvt_pk_bf16_f32 v240, v224, v225
    v_cvt_pk_bf16_f32 v241, v226, v227
    v_accvgpr_write_b32 a96, v240
    v_accvgpr_write_b32 a97, v241
    buffer_store_dwordx4 a[16:19], v20, s[8:11], s46 offen offset:0 sc1
    v_pk_mul_f32 v[228:229], v[228:229], v[244:245]
    v_pk_mul_f32 v[230:231], v[230:231], v[246:247]
    v_cvt_pk_bf16_f32 v244, v228, v229
    v_cvt_pk_bf16_f32 v245, v230, v231
    v_accvgpr_write_b32 a100, v244
    v_accvgpr_write_b32 a101, v245
    v_pk_mul_f32 v[232:233], v[232:233], v[248:249]
    v_pk_mul_f32 v[234:235], v[234:235], v[250:251]
    v_cvt_pk_bf16_f32 v248, v232, v233
    v_cvt_pk_bf16_f32 v249, v234, v235
    v_accvgpr_write_b32 a112, v248
    v_accvgpr_write_b32 a113, v249
    v_pk_mul_f32 v[236:237], v[236:237], v[252:253]
    v_pk_mul_f32 v[238:239], v[238:239], v[254:255]
    v_cvt_pk_bf16_f32 v252, v236, v237
    v_cvt_pk_bf16_f32 v253, v238, v239
    v_accvgpr_write_b32 a116, v252
    v_accvgpr_write_b32 a117, v253
    v_mov_b32 v1, v24
    v_mov_b32 v3, v27
    v_mov_b32 v2, v25
    v_mov_b32 v6, v28
    ds_read_b128 a[192:195], v1 offset:0
    ds_read_b128 a[196:199], v2 offset:0
    ds_read_b128 a[200:203], v1 offset:128
    ds_read_b128 a[204:207], v2 offset:128
    ds_read_b128 a[208:211], v1 offset:8448
    ds_read_b128 a[212:215], v2 offset:8448
    ds_read_b128 a[216:219], v1 offset:8576
    ds_read_b128 a[220:223], v2 offset:8576
    ds_read_b64_tr_b16 a[224:225], v3 offset:0
    ds_read_b64_tr_b16 a[226:227], v3 offset:8448
    ds_read_b64_tr_b16 a[228:229], v6 offset:0
    ds_read_b64_tr_b16 a[230:231], v6 offset:8448
    ds_read_b64_tr_b16 a[232:233], v3 offset:256
    ds_read_b64_tr_b16 a[234:235], v3 offset:8704
    ds_read_b64_tr_b16 a[236:237], v6 offset:256
    ds_read_b64_tr_b16 a[238:239], v6 offset:8704
    ds_read_b64_tr_b16 a[240:241], v3 offset:512
    ds_read_b64_tr_b16 a[242:243], v3 offset:8960
    ds_read_b64_tr_b16 a[244:245], v6 offset:512
    ds_read_b64_tr_b16 a[246:247], v6 offset:8960
    ds_read_b64_tr_b16 a[248:249], v3 offset:768
    ds_read_b64_tr_b16 a[250:251], v3 offset:9216
    ds_read_b64_tr_b16 a[252:253], v6 offset:768
    ds_read_b64_tr_b16 a[254:255], v6 offset:9216
L_retouch:
    s_getpc_b64 s[96:97]
    s_lshr_b32 s98, s2, 3
    s_mul_i32 s98, s98, 10
    v_min_u32 v64, 9, v0
    v_add_u32_e64 v64, s98, v64
    v_min_u32 v64, 316, v64
    v_lshlrev_b32_e64 v64, 7, v64
    global_load_dword v31, v64, s[96:97]
    s_mov_b32 s12, s70
    s_nop 0
    s_and_b32 s13, s71, 0xffff
    s_mov_b32 s14, 8388608
    s_mov_b32 s15, 0x20000
    s_mov_b32 s16, s76
    s_nop 0
    s_and_b32 s17, s77, 0xffff
    s_mov_b32 s18, 7340032
    s_mov_b32 s19, 0x20000
    s_lshl_b32 s60, s2, 2
    s_add_u32 s60, s60, s38
    s_lshl_b32 s30, s60, 13
    s_mul_i32 s31, s60, 7168
    v_lshlrev_b32 v64, 7, v0
    v_mov_b32 v65, 0x80000000
    v_cmp_gt_u32 vcc, 11, v0
    s_nop 1
    v_cndmask_b32 v8, v65, v64, vcc
    v_cmp_gt_u32 vcc, 10, v0
    s_nop 1
    v_cndmask_b32 v9, v65, v64, vcc
    s_and_b32 s34, s2, 3
    s_bfe_u32 s61, s2, 0x10002
    s_lshl_b32 s61, s61, 2
    s_and_b32 s62, s40, 3
    s_add_u32 s36, s61, s62
    v_bfe_u32 v64, v0, 2, 2
    v_lshrrev_b32 v65, 4, v0
    v_xor_b32 v65, s34, v65
    v_and_b32 v66, 3, v0
    v_lshlrev_b32 v67, 6, v65
    v_lshl_add_u32 v67, v66, 4, v67
    v_lshl_add_u32 v10, v64, 11, v67
    s_lshl_b32 s62, s36, 8
    s_lshl_b32 s63, s38, 15
    s_add_u32 s62, s62, s63
    v_add_u32 v10, s62, v10
    v_xor_b32_e64 v67, 32, v10
    v_add_u32 v11, 7168, v67
    v_add_u32 v12, 14336, v10
    v_add_u32 v13, 21504, v67
    s_lshl_b32 s35, s38, 12
    s_add_u32 s29, s35, 0x10000
    s_lshl_b32 s62, s59, 17
    v_add_u32_e64 v14, s62, v20
    v_add_u32 v15, 0x20000, v14
    s_lshr_b32 s62, s59, 3
    s_lshl_b32 s62, s62, 8
    v_lshl_add_u32 v18, v0, 2, s62
    v_mov_b32 v16, 0
    v_mov_b32 v17, 1
    v_accvgpr_read_b32 v64, a8
    v_accvgpr_read_b32 v65, a9
    v_accvgpr_read_b32 v66, a10
    v_accvgpr_read_b32 v67, a11
    v_accvgpr_read_b32 v68, a24
    v_accvgpr_read_b32 v69, a25
    v_accvgpr_read_b32 v70, a26
    v_accvgpr_read_b32 v71, a27
    v_pk_mul_f32 v[64:65], v[64:65], s[52:53]
    v_pk_mul_f32 v[66:67], v[66:67], s[52:53]
    v_pk_mul_f32 v[68:69], v[68:69], s[52:53]
    v_pk_mul_f32 v[70:71], v[70:71], s[52:53]
    v_cvt_pk_bf16_f32 v64, v64, v65
    v_cvt_pk_bf16_f32 v65, v66, v67
    v_cvt_pk_bf16_f32 v66, v68, v69
    v_cvt_pk_bf16_f32 v67, v70, v71
    s_nop 0
    v_permlane32_swap_b32 v64, v66
    v_permlane32_swap_b32 v65, v67
    s_nop 0
    v_permlane16_swap_b32 v64, v66
    v_permlane16_swap_b32 v65, v67
    v_accvgpr_write_b32 a160, v64
    v_accvgpr_write_b32 a161, v65
    v_accvgpr_write_b32 a162, v66
    v_accvgpr_write_b32 a163, v67
    buffer_store_dwordx4 a[20:23], v20, s[8:11], s47 offen offset:0 sc1
    v_accvgpr_read_b32 v128, a40
    v_accvgpr_read_b32 v129, a41
    v_accvgpr_read_b32 v130, a42
    v_accvgpr_read_b32 v131, a43
    v_accvgpr_read_b32 v132, a56
    v_accvgpr_read_b32 v133, a57
    v_accvgpr_read_b32 v134, a58
    v_accvgpr_read_b32 v135, a59
    v_pk_mul_f32 v[128:129], v[128:129], s[52:53]
    v_pk_mul_f32 v[130:131], v[130:131], s[52:53]
    v_pk_mul_f32 v[132:133], v[132:133], s[52:53]
    v_pk_mul_f32 v[134:135], v[134:135], s[52:53]
    v_cvt_pk_bf16_f32 v128, v128, v129
    v_cvt_pk_bf16_f32 v129, v130, v131
    v_cvt_pk_bf16_f32 v130, v132, v133
    v_cvt_pk_bf16_f32 v131, v134, v135
    s_nop 0
    v_permlane32_swap_b32 v128, v130
    v_permlane32_swap_b32 v129, v131
    s_nop 0
    v_permlane16_swap_b32 v128, v130
    v_permlane16_swap_b32 v129, v131
    v_accvgpr_write_b32 a164, v128
    v_accvgpr_write_b32 a165, v129
    v_accvgpr_write_b32 a166, v130
    v_accvgpr_write_b32 a167, v131
    v_accvgpr_read_b32 v64, a72
    v_accvgpr_read_b32 v65, a73
    v_accvgpr_read_b32 v66, a74
    v_accvgpr_read_b32 v67, a75
    v_accvgpr_read_b32 v68, a88
    v_accvgpr_read_b32 v69, a89
    v_accvgpr_read_b32 v70, a90
    v_accvgpr_read_b32 v71, a91
    v_pk_mul_f32 v[64:65], v[64:65], s[52:53]
    v_pk_mul_f32 v[66:67], v[66:67], s[52:53]
    v_pk_mul_f32 v[68:69], v[68:69], s[52:53]
    v_pk_mul_f32 v[70:71], v[70:71], s[52:53]
    v_cvt_pk_bf16_f32 v64, v64, v65
    v_cvt_pk_bf16_f32 v65, v66, v67
    v_cvt_pk_bf16_f32 v66, v68, v69
    v_cvt_pk_bf16_f32 v67, v70, v71
    s_nop 0
    v_permlane32_swap_b32 v64, v66
    v_permlane32_swap_b32 v65, v67
    s_nop 0
    v_permlane16_swap_b32 v64, v66
    v_permlane16_swap_b32 v65, v67
    v_accvgpr_write_b32 a168, v64
    v_accvgpr_write_b32 a169, v65
    v_accvgpr_write_b32 a170, v66
    v_accvgpr_write_b32 a171, v67
    v_accvgpr_read_b32 v128, a104
    v_accvgpr_read_b32 v129, a105
    v_accvgpr_read_b32 v130, a106
    v_accvgpr_read_b32 v131, a107
    v_accvgpr_read_b32 v132, a120
    v_accvgpr_read_b32 v133, a121
    v_accvgpr_read_b32 v134, a122
    v_accvgpr_read_b32 v135, a123
    v_pk_mul_f32 v[128:129], v[128:129], s[52:53]
    v_pk_mul_f32 v[130:131], v[130:131], s[52:53]
    v_pk_mul_f32 v[132:133], v[132:133], s[52:53]
    v_pk_mul_f32 v[134:135], v[134:135], s[52:53]
    v_cvt_pk_bf16_f32 v128, v128, v129
    v_cvt_pk_bf16_f32 v129, v130, v131
    v_cvt_pk_bf16_f32 v130, v132, v133
    v_cvt_pk_bf16_f32 v131, v134, v135
    s_nop 0
    v_permlane32_swap_b32 v128, v130
    v_permlane32_swap_b32 v129, v131
    s_nop 0
    v_permlane16_swap_b32 v128, v130
    v_permlane16_swap_b32 v129, v131
    v_accvgpr_write_b32 a172, v128
    v_accvgpr_write_b32 a173, v129
    v_accvgpr_write_b32 a174, v130
    v_accvgpr_write_b32 a175, v131
    v_accvgpr_read_b32 v64, a12
    v_accvgpr_read_b32 v65, a13
    v_accvgpr_read_b32 v66, a14
    v_accvgpr_read_b32 v67, a15
    v_accvgpr_read_b32 v68, a28
    v_accvgpr_read_b32 v69, a29
    v_accvgpr_read_b32 v70, a30
    v_accvgpr_read_b32 v71, a31
    v_pk_mul_f32 v[64:65], v[64:65], s[52:53]
    v_pk_mul_f32 v[66:67], v[66:67], s[52:53]
    v_pk_mul_f32 v[68:69], v[68:69], s[52:53]
    v_pk_mul_f32 v[70:71], v[70:71], s[52:53]
    v_cvt_pk_bf16_f32 v64, v64, v65
    v_cvt_pk_bf16_f32 v65, v66, v67
    v_cvt_pk_bf16_f32 v66, v68, v69
    v_cvt_pk_bf16_f32 v67, v70, v71
    s_nop 0
    v_permlane32_swap_b32 v64, v66
    v_permlane32_swap_b32 v65, v67
    s_nop 0
    v_permlane16_swap_b32 v64, v66
    v_permlane16_swap_b32 v65, v67
    v_accvgpr_write_b32 a176, v64
    v_accvgpr_write_b32 a177, v65
    v_accvgpr_write_b32 a178, v66
    v_accvgpr_write_b32 a179, v67
    buffer_store_dwordx4 a[32:35], v20, s[8:11], s44 offen offset:1024 sc1
    v_accvgpr_read_b32 v128, a44
    v_accvgpr_read_b32 v129, a45
    v_accvgpr_read_b32 v130, a46
    v_accvgpr_read_b32 v131, a47
    v_accvgpr_read_b32 v132, a60
    v_accvgpr_read_b32 v133, a61
    v_accvgpr_read_b32 v134, a62
    v_accvgpr_read_b32 v135, a63
    v_pk_mul_f32 v[128:129], v[128:129], s[52:53]
    v_pk_mul_f32 v[130:131], v[130:131], s[52:53]
    v_pk_mul_f32 v[132:133], v[132:133], s[52:53]
    v_pk_mul_f32 v[134:135], v[134:135], s[52:53]
    v_cvt_pk_bf16_f32 v128, v128, v129
    v_cvt_pk_bf16_f32 v129, v130, v131
    v_cvt_pk_bf16_f32 v130, v132, v133
    v_cvt_pk_bf16_f32 v131, v134, v135
    s_nop 0
    v_permlane32_swap_b32 v128, v130
    v_permlane32_swap_b32 v129, v131
    s_nop 0
    v_permlane16_swap_b32 v128, v130
    v_permlane16_swap_b32 v129, v131
    v_accvgpr_write_b32 a180, v128
    v_accvgpr_write_b32 a181, v129
    v_accvgpr_write_b32 a182, v130
    v_accvgpr_write_b32 a183, v131
    v_accvgpr_read_b32 v64, a76
    v_accvgpr_read_b32 v65, a77
    v_accvgpr_read_b32 v66, a78
    v_accvgpr_read_b32 v67, a79
    v_accvgpr_read_b32 v68, a92
    v_accvgpr_read_b32 v69, a93
    v_accvgpr_read_b32 v70, a94
    v_accvgpr_read_b32 v71, a95
    v_pk_mul_f32 v[64:65], v[64:65], s[52:53]
    v_pk_mul_f32 v[66:67], v[66:67], s[52:53]
    v_pk_mul_f32 v[68:69], v[68:69], s[52:53]
    v_pk_mul_f32 v[70:71], v[70:71], s[52:53]
    v_cvt_pk_bf16_f32 v64, v64, v65
    v_cvt_pk_bf16_f32 v65, v66, v67
    v_cvt_pk_bf16_f32 v66, v68, v69
    v_cvt_pk_bf16_f32 v67, v70, v71
    s_nop 0
    v_permlane32_swap_b32 v64, v66
    v_permlane32_swap_b32 v65, v67
    s_nop 0
    v_permlane16_swap_b32 v64, v66
    v_permlane16_swap_b32 v65, v67
    v_accvgpr_write_b32 a184, v64
    v_accvgpr_write_b32 a185, v65
    v_accvgpr_write_b32 a186, v66
    v_accvgpr_write_b32 a187, v67
    v_accvgpr_read_b32 v128, a108
    v_accvgpr_read_b32 v129, a109
    v_accvgpr_read_b32 v130, a110
    v_accvgpr_read_b32 v131, a111
    v_accvgpr_read_b32 v132, a124
    v_accvgpr_read_b32 v133, a125
    v_accvgpr_read_b32 v134, a126
    v_accvgpr_read_b32 v135, a127
    v_pk_mul_f32 v[128:129], v[128:129], s[52:53]
    v_pk_mul_f32 v[130:131], v[130:131], s[52:53]
    v_pk_mul_f32 v[132:133], v[132:133], s[52:53]
    v_pk_mul_f32 v[134:135], v[134:135], s[52:53]
    v_cvt_pk_bf16_f32 v128, v128, v129
    v_cvt_pk_bf16_f32 v129, v130, v131
    v_cvt_pk_bf16_f32 v130, v132, v133
    v_cvt_pk_bf16_f32 v131, v134, v135
    s_nop 0
    v_permlane32_swap_b32 v128, v130
    v_permlane32_swap_b32 v129, v131
    s_nop 0
    v_permlane16_swap_b32 v128, v130
    v_permlane16_swap_b32 v129, v131
    v_accvgpr_write_b32 a188, v128
    v_accvgpr_write_b32 a189, v129
    v_accvgpr_write_b32 a190, v130
    v_accvgpr_write_b32 a191, v131
    s_mov_b32 s58, 0
    s_mov_b32 s54, 0x40004000
    v_mov_b32 v246, 0x3f803f80
    v_mov_b32 v247, 0x3f803f80
    v_mov_b32 v248, 0x3f803f80
    v_mov_b32 v249, 0x3f803f80
    ds_read_b128 a[72:75], v1 offset:16896
    ds_read_b128 a[76:79], v2 offset:16896
    ds_read_b128 a[88:91], v1 offset:17024
    ds_read_b128 a[92:95], v2 offset:17024
    ds_read_b128 a[104:107], v1 offset:25344
    ds_read_b128 a[108:111], v2 offset:25344
    ds_read_b128 a[120:123], v1 offset:25472
    ds_read_b128 a[124:127], v2 offset:25472
    v_mfma_f32_16x16x32_bf16 v[160:163], a[192:195], a[128:131], 0
    buffer_store_dwordx4 a[36:39], v20, s[8:11], s45 offen offset:1024 sc1
    v_mov_b64 v[40:41], 0
    v_mov_b64_e64 v[42:43], 0
    v_mfma_f32_16x16x32_bf16 v[160:163], a[196:199], a[132:135], v[160:163]
    v_mov_b64 v[44:45], 0
    v_mov_b64 v[46:47], 0
    v_mov_b64_e64 v[56:57], 0
    v_mfma_f32_16x16x32_bf16 v[160:163], a[200:203], a[136:139], v[160:163]
    v_mov_b64 v[58:59], 0
    v_mov_b64 v[60:61], 0
    v_mfma_f32_16x16x32_bf16 v[160:163], a[204:207], a[140:143], v[160:163]
    v_mov_b64 v[62:63], 0
    v_mov_b64 v[72:73], 0
    v_mfma_f32_16x16x32_bf16 v[164:167], a[208:211], a[128:131], 0
    v_mov_b64 v[74:75], 0
    v_mov_b64 v[76:77], 0
    v_mfma_f32_16x16x32_bf16 v[164:167], a[212:215], a[132:135], v[164:167]
    v_mov_b64 v[78:79], 0
    v_mov_b64 v[88:89], 0
    v_mov_b64_e64 v[90:91], 0
    v_mfma_f32_16x16x32_bf16 v[164:167], a[216:219], a[136:139], v[164:167]
    v_mov_b64 v[92:93], 0
    v_mov_b64 v[94:95], 0
    v_mfma_f32_16x16x32_bf16 v[164:167], a[220:223], a[140:143], v[164:167]
    v_mov_b64 v[104:105], 0
    v_mov_b64 v[106:107], 0
    v_mfma_f32_16x16x32_bf16 v[172:175], a[208:211], a[144:147], 0
    v_mov_b64 v[108:109], 0
    v_mov_b64 v[110:111], 0
    v_mfma_f32_16x16x32_bf16 v[172:175], a[212:215], a[148:151], v[172:175]
    v_mov_b64 v[120:121], 0
    v_mov_b64 v[122:123], 0
    v_mov_b64_e64 v[124:125], 0
    v_mfma_f32_16x16x32_bf16 v[172:175], a[216:219], a[152:155], v[172:175]
    v_mov_b64 v[126:127], 0
    v_mov_b64 v[136:137], 0
    v_mfma_f32_16x16x32_bf16 v[172:175], a[220:223], a[156:159], v[172:175]
    v_mov_b64 v[138:139], 0
    v_mov_b64 v[140:141], 0
    v_mfma_f32_16x16x32_bf16 v[168:171], a[192:195], a[144:147], 0
    v_mov_b64 v[142:143], 0
    v_mov_b64 v[152:153], 0
    v_mfma_f32_16x16x32_bf16 v[168:171], a[196:199], a[148:151], v[168:171]
    v_mov_b64 v[154:155], 0
    v_mov_b64 v[156:157], 0
    v_mov_b64_e64 v[158:159], 0
    v_mfma_f32_16x16x32_bf16 v[168:171], a[200:203], a[152:155], v[168:171]
    v_mov_b64 v[216:217], 0
    v_mov_b64 v[218:219], 0
    v_mfma_f32_16x16x32_bf16 v[168:171], a[204:207], a[156:159], v[168:171]
    v_mov_b64 v[220:221], 0
    v_mov_b64 v[222:223], 0
    s_waitcnt vmcnt(27)
    s_barrier
    v_mfma_f32_16x16x32_bf16 v[176:179], a[192:195], a[160:163], 0
    s_add_u32 s58, s58, 33792
    v_mfma_f32_16x16x32_bf16 v[176:179], a[196:199], a[164:167], v[176:179]
    s_cmp_eq_u32 s58, 135168
    v_mfma_f32_16x16x32_bf16 v[176:179], a[200:203], a[168:171], v[176:179]
    s_cselect_b32 s58, 0, s58
    s_nop 0
    v_max3_f32 v250, v160, v161, v162
    v_max3_f32 v251, v163, v164, v165
    v_max3_f32 v250, v250, v166, v167
    v_max_f32 v250, v250, v251
    v_mov_b32_e64 v251, v250
    s_nop 1
    v_mfma_f32_16x16x32_bf16 v[176:179], a[204:207], a[172:175], v[176:179]
    v_add_u32 v1, s58, v24
    v_permlane16_swap_b32 v250, v251
    v_max_f32 v250, v250, v251
    v_mov_b32 v251, v250
    s_nop 1
    v_permlane32_swap_b32 v250, v251
    v_max_f32_e64 v250, v250, v251
    v_mfma_f32_16x16x32_bf16 v[180:183], a[208:211], a[160:163], 0
    v_sub_f32 v250, 0xc1800000, v250
    v_mov_b32_e64 v251, v250
    v_pk_add_f32 v[160:161], v[160:161], v[250:251]
    v_pk_add_f32 v[162:163], v[162:163], v[250:251]
    v_pk_add_f32 v[164:165], v[164:165], v[250:251]
    v_mfma_f32_16x16x32_bf16 v[180:183], a[212:215], a[164:167], v[180:183]
    v_pk_add_f32 v[166:167], v[166:167], v[250:251]
    v_mov_b64 v[192:193], v[250:251]
    v_mov_b64 v[194:195], v[250:251]
    v_max3_f32 v252, v168, v169, v170
    v_max3_f32 v253, v171, v172, v173
    v_max3_f32 v252, v252, v174, v175
    v_mfma_f32_16x16x32_bf16 v[180:183], a[216:219], a[168:171], v[180:183]
    v_max_f32 v252, v252, v253
    v_mov_b32 v253, v252
    s_nop 1
    v_permlane16_swap_b32 v252, v253
    v_max_f32 v252, v252, v253
    v_mov_b32 v253, v252
    v_mfma_f32_16x16x32_bf16 v[180:183], a[220:223], a[172:175], v[180:183]
    s_nop 1
    v_permlane32_swap_b32 v252, v253
    v_max_f32_e64 v252, v252, v253
    v_sub_f32 v252, 0xc1800000, v252
    v_mov_b32_e64 v253, v252
    v_pk_add_f32 v[168:169], v[168:169], v[252:253]
    v_mfma_f32_16x16x32_bf16 v[188:191], a[208:211], a[176:179], 0
    v_pk_add_f32 v[170:171], v[170:171], v[252:253]
    v_pk_add_f32 v[172:173], v[172:173], v[252:253]
    v_pk_add_f32 v[174:175], v[174:175], v[252:253]
    v_mov_b64 v[196:197], v[252:253]
    v_mov_b64 v[198:199], v[252:253]
    v_mfma_f32_16x16x32_bf16 v[188:191], a[212:215], a[180:183], v[188:191]
    v_add_u32 v2, s58, v25
    v_exp_f32 v240, v160
    v_exp_f32 v241, v161
    v_exp_f32 v242, v162
    v_mfma_f32_16x16x32_bf16 v[188:191], a[216:219], a[184:187], v[188:191]
    buffer_store_dwordx4 a[48:51], v20, s[8:11], s46 offen offset:1024 sc1
    v_exp_f32_e64 v243, v163
    v_cvt_pk_bf16_f32 v224, v240, v241
    v_exp_f32 v244, v164
    v_exp_f32 v245, v165
    v_mfma_f32_16x16x32_bf16 v[188:191], a[220:223], a[188:191], v[188:191]
    v_cvt_pk_bf16_f32 v225, v242, v243
    v_exp_f32 v240, v166
    v_exp_f32 v241, v167
    v_mfma_f32_16x16x32_bf16 v[184:187], a[192:195], a[176:179], 0
    v_cvt_pk_bf16_f32 v226, v244, v245
    v_exp_f32 v242, v168
    v_exp_f32 v243, v169
    v_cvt_pk_bf16_f32 v227, v240, v241
    v_mfma_f32_16x16x32_bf16 v[184:187], a[196:199], a[180:183], v[184:187]
    v_exp_f32 v244, v170
    v_exp_f32 v245, v171
    v_cvt_pk_bf16_f32 v228, v242, v243
    v_mfma_f32_16x16x32_bf16 v[184:187], a[200:203], a[184:187], v[184:187]
    v_exp_f32 v240, v172
    v_exp_f32 v241, v173
    v_cvt_pk_bf16_f32 v229, v244, v245
    v_exp_f32_e64 v242, v174
    v_mfma_f32_16x16x32_bf16 v[184:187], a[204:207], a[188:191], v[184:187]
    v_exp_f32_e64 v243, v175
    v_cvt_pk_bf16_f32 v230, v240, v241
    s_nop 0
    v_cvt_pk_bf16_f32 v231, v242, v243
    s_waitcnt lgkmcnt(12)
    v_mfma_f32_16x16x32_bf16 v[32:35], a[224:227], v[224:227], 0
    buffer_store_dwordx4 a[52:55], v20, s[8:11], s47 offen offset:1024 sc1
    v_mfma_f32_16x16x32_bf16 v[36:39], a[224:227], v[228:231], 0
    v_mfma_f32_16x16x32_bf16 v[52:55], a[228:231], v[228:231], 0
    v_max3_f32 v250, v176, v177, v178
    v_max3_f32 v251, v179, v180, v181
    v_max3_f32 v250, v250, v182, v183
    v_max_f32_e64 v250, v250, v251
    v_mfma_f32_16x16x32_bf16 v[48:51], a[228:231], v[224:227], 0
    v_mov_b32 v251, v250
    s_nop 1
    v_permlane16_swap_b32 v250, v251
    v_max_f32 v250, v250, v251
    v_mfma_f32_16x16x32_bf16 v[64:67], a[232:235], v[224:227], 0
    v_mov_b32 v251, v250
    s_nop 1
    v_permlane32_swap_b32 v250, v251
    v_max_f32 v250, v250, v251
    v_mfma_f32_16x16x32_bf16 v[68:71], a[232:235], v[228:231], 0
    v_sub_f32 v250, 0xc1800000, v250
    v_mov_b32_e64 v251, v250
    v_pk_add_f32 v[176:177], v[176:177], v[250:251]
    v_pk_add_f32 v[178:179], v[178:179], v[250:251]
    v_mfma_f32_16x16x32_bf16 v[208:211], v[246:249], v[224:227], 0
    v_pk_add_f32 v[180:181], v[180:181], v[250:251]
    v_pk_add_f32 v[182:183], v[182:183], v[250:251]
    v_mov_b64 v[200:201], v[250:251]
    v_mov_b64 v[202:203], v[250:251]
    v_mfma_f32_16x16x32_bf16 v[84:87], a[236:239], v[228:231], 0
    v_max3_f32 v252, v184, v185, v186
    v_max3_f32 v253, v187, v188, v189
    v_max3_f32 v252, v252, v190, v191
    v_max_f32_e64 v252, v252, v253
    v_mfma_f32_16x16x32_bf16 v[80:83], a[236:239], v[224:227], 0
    v_mov_b32 v253, v252
    s_nop 1
    v_permlane16_swap_b32 v252, v253
    v_max_f32 v252, v252, v253
    v_mfma_f32_16x16x32_bf16 v[96:99], a[240:243], v[224:227], 0
    v_mov_b32 v253, v252
    s_nop 1
    v_permlane32_swap_b32 v252, v253
    v_max_f32 v252, v252, v253
    v_sub_f32 v252, 0xc1800000, v252
    v_mfma_f32_16x16x32_bf16 v[100:103], a[240:243], v[228:231], 0
    v_mov_b32_e64 v253, v252
    v_pk_add_f32 v[184:185], v[184:185], v[252:253]
    v_pk_add_f32 v[186:187], v[186:187], v[252:253]
    v_pk_add_f32 v[188:189], v[188:189], v[252:253]
    v_mfma_f32_16x16x32_bf16 v[116:119], a[244:247], v[228:231], 0
    ds_read_b128 a[192:195], v1 offset:0
    v_pk_add_f32 v[190:191], v[190:191], v[252:253]
    v_mov_b64 v[204:205], v[252:253]
    v_mov_b64 v[206:207], v[252:253]
    v_mfma_f32_16x16x32_bf16 v[112:115], a[244:247], v[224:227], 0
    ds_read_b128 a[196:199], v2 offset:0
    v_exp_f32 v240, v176
    v_exp_f32 v241, v177
    v_mfma_f32_16x16x32_bf16 v[212:215], v[246:249], v[228:231], 0
    ds_read_b128 a[200:203], v1 offset:128
    v_exp_f32_e64 v242, v178
    v_cvt_pk_bf16_f32 v232, v240, v241
    v_exp_f32 v243, v179
    s_waitcnt lgkmcnt(11)
    v_mfma_f32_16x16x32_bf16 v[128:131], a[248:251], v[224:227], 0
    v_cvt_pk_bf16_f32 v233, v242, v243
    v_exp_f32_e64 v244, v180
    v_mfma_f32_16x16x32_bf16 v[132:135], a[248:251], v[228:231], 0
    v_exp_f32 v245, v181
    v_exp_f32 v240, v182
    v_cvt_pk_bf16_f32 v234, v244, v245
    v_mfma_f32_16x16x32_bf16 v[148:151], a[252:255], v[228:231], 0
    ds_read_b128 a[204:207], v2 offset:128
    v_or3_b32 v254, v232, v233, v234
    v_exp_f32_e64 v241, v183
    v_mfma_f32_16x16x32_bf16 v[144:147], a[252:255], v[224:227], 0
    v_exp_f32_e64 v242, v184
    v_cvt_pk_bf16_f32 v235, v240, v241
    v_exp_f32 v243, v185
    s_waitcnt lgkmcnt(4)
    v_mfma_f32_16x16x32_bf16 v[160:163], a[72:75], a[128:131], v[192:195]
    ds_read_b128 a[208:211], v1 offset:8448
    buffer_store_dwordx4 a[64:67], v20, s[8:11], s44 offen offset:2048 sc1
    v_mfma_f32_16x16x32_bf16 v[160:163], a[76:79], a[132:135], v[160:163]
    ds_read_b128 a[212:215], v2 offset:8448
    v_cvt_pk_bf16_f32 v236, v242, v243
    v_mfma_f32_16x16x32_bf16 v[160:163], a[88:91], a[136:139], v[160:163]
    v_exp_f32_e64 v244, v186
    v_mfma_f32_16x16x32_bf16 v[160:163], a[92:95], a[140:143], v[160:163]
    v_exp_f32_e64 v245, v187
    v_mfma_f32_16x16x32_bf16 v[164:167], a[104:107], a[128:131], v[192:195]
    v_exp_f32_e64 v240, v188
    v_mfma_f32_16x16x32_bf16 v[164:167], a[108:111], a[132:135], v[164:167]
    v_exp_f32_e64 v241, v189
    v_mfma_f32_16x16x32_bf16 v[164:167], a[120:123], a[136:139], v[164:167]
    v_exp_f32_e64 v242, v190
    v_mfma_f32_16x16x32_bf16 v[164:167], a[124:127], a[140:143], v[164:167]
    v_exp_f32_e64 v243, v191
    v_mfma_f32_16x16x32_bf16 v[172:175], a[104:107], a[144:147], v[196:199]
    ds_read_b128 a[216:219], v1 offset:8576
    v_or3_b32 v254, v254, v235, v236
    v_mfma_f32_16x16x32_bf16 v[172:175], a[108:111], a[148:151], v[172:175]
    ds_read_b128 a[220:223], v2 offset:8576
    v_cvt_pk_bf16_f32 v237, v244, v245
    v_mfma_f32_16x16x32_bf16 v[172:175], a[120:123], a[152:155], v[172:175]
    v_cvt_pk_bf16_f32 v238, v240, v241
    v_or3_b32 v254, v254, v237, v238
    v_mfma_f32_16x16x32_bf16 v[172:175], a[124:127], a[156:159], v[172:175]
    v_cvt_pk_bf16_f32 v239, v242, v243
    v_bitop3_b32 v254, v254, v239, s54 bitop3:0xa8
    v_mfma_f32_16x16x32_bf16 v[168:171], a[72:75], a[144:147], v[196:199]
    v_cmp_ne_u32 vcc, 0, v254
    v_mfma_f32_16x16x32_bf16 v[168:171], a[76:79], a[148:151], v[168:171]
    v_mfma_f32_16x16x32_bf16 v[168:171], a[88:91], a[152:155], v[168:171]
    v_mfma_f32_16x16x32_bf16 v[168:171], a[92:95], a[156:159], v[168:171]
    s_cbranch_vccnz L_slow1_6
L_slow1_6_ret:
    v_mfma_f32_16x16x32_bf16 v[40:43], a[224:227], v[232:235], v[40:43]
    buffer_store_dwordx4 a[68:71], v20, s[8:11], s45 offen offset:2048 sc1
    buffer_load_dword v31, v8, s[12:15], s30 offen
    v_mfma_f32_16x16x32_bf16 v[44:47], a[224:227], v[236:239], v[44:47]
    ds_read_b64_tr_b16 a[224:225], v3 offset:16896
    s_add_u32 s30, s30, 1408
    v_mfma_f32_16x16x32_bf16 v[60:63], a[228:231], v[236:239], v[60:63]
    v_exp_f32_e64 v240, v160
    v_mfma_f32_16x16x32_bf16 v[56:59], a[228:231], v[232:235], v[56:59]
    v_exp_f32_e64 v241, v161
    v_mfma_f32_16x16x32_bf16 v[72:75], a[232:235], v[232:235], v[72:75]
    v_exp_f32_e64 v242, v162
    v_mfma_f32_16x16x32_bf16 v[76:79], a[232:235], v[236:239], v[76:79]
    ds_read_b64_tr_b16 a[226:227], v3 offset:25344
    v_cvt_pk_bf16_f32 v224, v240, v241
    v_mfma_f32_16x16x32_bf16 v[216:219], v[246:249], v[232:235], v[216:219]
    v_exp_f32_e64 v243, v163
    v_mfma_f32_16x16x32_bf16 v[92:95], a[236:239], v[236:239], v[92:95]
    v_exp_f32_e64 v244, v164
    v_mfma_f32_16x16x32_bf16 v[88:91], a[236:239], v[232:235], v[88:91]
    ds_read_b64_tr_b16 a[228:229], v6 offset:16896
    v_cvt_pk_bf16_f32 v225, v242, v243
    v_mfma_f32_16x16x32_bf16 v[104:107], a[240:243], v[232:235], v[104:107]
    v_exp_f32_e64 v245, v165
    v_mfma_f32_16x16x32_bf16 v[108:111], a[240:243], v[236:239], v[108:111]
    v_exp_f32_e64 v240, v166
    v_mfma_f32_16x16x32_bf16 v[124:127], a[244:247], v[236:239], v[124:127]
    ds_read_b64_tr_b16 a[230:231], v6 offset:25344
    v_cvt_pk_bf16_f32 v226, v244, v245
    v_mfma_f32_16x16x32_bf16 v[120:123], a[244:247], v[232:235], v[120:123]
    ds_read_b64_tr_b16 a[232:233], v3 offset:17152
    v_or3_b32 v254, v224, v225, v226
    v_mfma_f32_16x16x32_bf16 v[220:223], v[246:249], v[236:239], v[220:223]
    v_exp_f32_e64 v241, v167
    v_mfma_f32_16x16x32_bf16 v[136:139], a[248:251], v[232:235], v[136:139]
    v_exp_f32_e64 v242, v168
    v_mfma_f32_16x16x32_bf16 v[140:143], a[248:251], v[236:239], v[140:143]
    ds_read_b64_tr_b16 a[234:235], v3 offset:25600
    v_cvt_pk_bf16_f32 v227, v240, v241
    v_mfma_f32_16x16x32_bf16 v[156:159], a[252:255], v[236:239], v[156:159]
    v_exp_f32_e64 v243, v169
    v_mfma_f32_16x16x32_bf16 v[152:155], a[252:255], v[232:235], v[152:155]
    v_exp_f32_e64 v244, v170
    v_mfma_f32_16x16x32_bf16 v[176:179], a[72:75], a[160:163], v[200:203]
    ds_read_b64_tr_b16 a[236:237], v6 offset:17152
    buffer_store_dwordx4 a[80:83], v20, s[8:11], s46 offen offset:2048 sc1
    v_mfma_f32_16x16x32_bf16 v[176:179], a[76:79], a[164:167], v[176:179]
    ds_read_b64_tr_b16 a[238:239], v6 offset:25600
    buffer_load_dword v31, v9, s[16:19], s31 offen
    v_mfma_f32_16x16x32_bf16 v[176:179], a[88:91], a[168:171], v[176:179]
    ds_read_b64_tr_b16 a[240:241], v3 offset:17408
    s_add_u32 s31, s31, 1280
    v_mfma_f32_16x16x32_bf16 v[176:179], a[92:95], a[172:175], v[176:179]
    v_exp_f32_e64 v245, v171
    v_mfma_f32_16x16x32_bf16 v[180:183], a[104:107], a[160:163], v[200:203]
    v_exp_f32_e64 v240, v172
    v_mfma_f32_16x16x32_bf16 v[180:183], a[108:111], a[164:167], v[180:183]
    v_exp_f32_e64 v241, v173
    v_mfma_f32_16x16x32_bf16 v[180:183], a[120:123], a[168:171], v[180:183]
    v_cvt_pk_bf16_f32 v228, v242, v243
    v_or3_b32 v254, v254, v227, v228
    v_mfma_f32_16x16x32_bf16 v[180:183], a[124:127], a[172:175], v[180:183]
    ds_read_b64_tr_b16 a[242:243], v3 offset:25856
    v_cvt_pk_bf16_f32 v229, v244, v245
    v_mfma_f32_16x16x32_bf16 v[188:191], a[104:107], a[176:179], v[204:207]
    ds_read_b64_tr_b16 a[244:245], v6 offset:17408
    v_cvt_pk_bf16_f32 v230, v240, v241
    v_mfma_f32_16x16x32_bf16 v[188:191], a[108:111], a[180:183], v[188:191]
    ds_read_b64_tr_b16 a[246:247], v6 offset:25856
    v_or3_b32 v254, v254, v229, v230
    v_mfma_f32_16x16x32_bf16 v[188:191], a[120:123], a[184:187], v[188:191]
    v_exp_f32_e64 v242, v174
    v_mfma_f32_16x16x32_bf16 v[188:191], a[124:127], a[188:191], v[188:191]
    v_exp_f32_e64 v243, v175
    v_mfma_f32_16x16x32_bf16 v[184:187], a[72:75], a[176:179], v[204:207]
    v_mfma_f32_16x16x32_bf16 v[184:187], a[76:79], a[180:183], v[184:187]
    v_cvt_pk_bf16_f32 v231, v242, v243
    v_bitop3_b32 v254, v254, v231, s54 bitop3:0xa8
    v_mfma_f32_16x16x32_bf16 v[184:187], a[88:91], a[184:187], v[184:187]
    v_cmp_ne_u32 vcc, 0, v254
    v_mfma_f32_16x16x32_bf16 v[184:187], a[92:95], a[188:191], v[184:187]
    s_cbranch_vccnz L_slow0_6
L_slow0_6_ret:
    s_waitcnt lgkmcnt(0)
    v_mfma_f32_16x16x32_bf16 v[32:35], a[224:227], v[224:227], v[32:35]
    v_exp_f32 v240, v176
    v_mfma_f32_16x16x32_bf16 v[36:39], a[224:227], v[228:231], v[36:39]
    v_exp_f32_e64 v241, v177
    v_mfma_f32_16x16x32_bf16 v[52:55], a[228:231], v[228:231], v[52:55]
    v_exp_f32_e64 v242, v178
    v_mfma_f32_16x16x32_bf16 v[48:51], a[228:231], v[224:227], v[48:51]
    ds_read_b64_tr_b16 a[248:249], v3 offset:17664
    v_cvt_pk_bf16_f32 v232, v240, v241
    v_mfma_f32_16x16x32_bf16 v[64:67], a[232:235], v[224:227], v[64:67]
    v_exp_f32_e64 v243, v179
    v_mfma_f32_16x16x32_bf16 v[68:71], a[232:235], v[228:231], v[68:71]
    ds_read_b64_tr_b16 a[250:251], v3 offset:26112
    v_mfma_f32_16x16x32_bf16 v[208:211], v[246:249], v[224:227], v[208:211]
    ds_read_b64_tr_b16 a[252:253], v6 offset:17664
    v_cvt_pk_bf16_f32 v233, v242, v243
    v_mfma_f32_16x16x32_bf16 v[84:87], a[236:239], v[228:231], v[84:87]
    ds_read_b64_tr_b16 a[254:255], v6 offset:26112
    v_mfma_f32_16x16x32_bf16 v[80:83], a[236:239], v[224:227], v[80:83]
    s_waitcnt vmcnt(26) lgkmcnt(0)
    s_barrier
    v_mfma_f32_16x16x32_bf16 v[96:99], a[240:243], v[224:227], v[96:99]
    ds_read_b128 a[72:75], v1 offset:16896
    v_add_u32_e64 v3, s58, v27
    v_mfma_f32_16x16x32_bf16 v[100:103], a[240:243], v[228:231], v[100:103]
    ds_read_b128 a[76:79], v2 offset:16896
    v_add_u32_e64 v6, s58, v28
    v_mfma_f32_16x16x32_bf16 v[116:119], a[244:247], v[228:231], v[116:119]
    ds_read_b128 a[88:91], v1 offset:17024
    buffer_store_dwordx4 a[84:87], v20, s[8:11], s47 offen offset:2048 sc1
    v_mfma_f32_16x16x32_bf16 v[112:115], a[244:247], v[224:227], v[112:115]
    v_exp_f32_e64 v244, v180
    v_mfma_f32_16x16x32_bf16 v[212:215], v[246:249], v[228:231], v[212:215]
    ds_read_b128 a[92:95], v2 offset:17024
    v_mfma_f32_16x16x32_bf16 v[128:131], a[248:251], v[224:227], v[128:131]
    v_exp_f32_e64 v245, v181
    v_mfma_f32_16x16x32_bf16 v[132:135], a[248:251], v[228:231], v[132:135]
    s_add_u32 m0, s42, s43
    ds_read_b128 a[104:107], v1 offset:25344
    v_mfma_f32_16x16x32_bf16 v[148:151], a[252:255], v[228:231], v[148:151]
    buffer_load_dwordx4 v21, s[20:23], s41 offen lds
    v_cvt_pk_bf16_f32 v234, v244, v245
    v_mfma_f32_16x16x32_bf16 v[144:147], a[252:255], v[224:227], v[144:147]
    buffer_load_dwordx4 v22, s[20:23], s41 offen offset:1024 lds
    v_or3_b32 v254, v232, v233, v234
    v_mfma_f32_16x16x32_bf16 v[160:163], a[192:195], a[128:131], v[192:195]
    buffer_load_dwordx4 v23, s[24:27], s41 offen offset:2048 lds
    ds_read_b128 a[108:111], v2 offset:25344
    v_mfma_f32_16x16x32_bf16 v[160:163], a[196:199], a[132:135], v[160:163]
    buffer_load_dwordx4 v26, s[24:27], s41 offen offset:3072 lds
    ds_read_b128 a[120:123], v1 offset:25472
    v_mfma_f32_16x16x32_bf16 v[160:163], a[200:203], a[136:139], v[160:163]
    v_exp_f32 v240, v182
    v_mfma_f32_16x16x32_bf16 v[160:163], a[204:207], a[140:143], v[160:163]
    v_exp_f32_e64 v241, v183
    v_mfma_f32_16x16x32_bf16 v[164:167], a[208:211], a[128:131], v[192:195]
    v_exp_f32_e64 v242, v184
    v_mfma_f32_16x16x32_bf16 v[164:167], a[212:215], a[132:135], v[164:167]
    v_exp_f32_e64 v243, v185
    v_mfma_f32_16x16x32_bf16 v[164:167], a[216:219], a[136:139], v[164:167]
    v_exp_f32_e64 v244, v186
    v_mfma_f32_16x16x32_bf16 v[164:167], a[220:223], a[140:143], v[164:167]
    v_exp_f32_e64 v245, v187
    v_mfma_f32_16x16x32_bf16 v[172:175], a[208:211], a[144:147], v[196:199]
    v_cvt_pk_bf16_f32 v235, v240, v241
    v_cvt_pk_bf16_f32 v236, v242, v243
    v_mfma_f32_16x16x32_bf16 v[172:175], a[212:215], a[148:151], v[172:175]
    v_exp_f32_e64 v240, v188
    v_mfma_f32_16x16x32_bf16 v[172:175], a[216:219], a[152:155], v[172:175]
    v_exp_f32_e64 v241, v189
    v_mfma_f32_16x16x32_bf16 v[172:175], a[220:223], a[156:159], v[172:175]
    v_exp_f32_e64 v242, v190
    v_mfma_f32_16x16x32_bf16 v[168:171], a[192:195], a[144:147], v[196:199]
    v_exp_f32_e64 v243, v191
    v_mfma_f32_16x16x32_bf16 v[168:171], a[196:199], a[148:151], v[168:171]
    v_or3_b32 v254, v254, v235, v236
    v_cvt_pk_bf16_f32 v237, v244, v245
    v_mfma_f32_16x16x32_bf16 v[168:171], a[200:203], a[152:155], v[168:171]
    buffer_store_dwordx2 a[96:97], v29, s[8:11], s44 offen sc1
    v_cvt_pk_bf16_f32 v238, v240, v241
    v_mfma_f32_16x16x32_bf16 v[168:171], a[204:207], a[156:159], v[168:171]
    ds_read_b128 a[124:127], v2 offset:25472
    v_or3_b32 v254, v254, v237, v238
    v_cvt_pk_bf16_f32 v239, v242, v243
    v_bitop3_b32 v254, v254, v239, s54 bitop3:0xa8
    v_cmp_ne_u32 vcc, 0, v254
    s_cbranch_vccnz L_slow1_7
L_slow1_7_ret:
    v_mfma_f32_16x16x32_bf16 v[40:43], a[224:227], v[232:235], v[40:43]
    buffer_store_dwordx2 a[100:101], v29, s[8:11], s45 offen sc1
    s_add_u32 s41, s41, 8192
    v_mfma_f32_16x16x32_bf16 v[44:47], a[224:227], v[236:239], v[44:47]
    ds_read_b64_tr_b16 a[224:225], v3 offset:0
    s_add_u32 s42, s42, 16896
    v_mfma_f32_16x16x32_bf16 v[60:63], a[228:231], v[236:239], v[60:63]
    ds_read_b64_tr_b16 a[226:227], v3 offset:8448
    s_cmp_eq_u32 s42, 135168
    v_mfma_f32_16x16x32_bf16 v[56:59], a[228:231], v[232:235], v[56:59]
    ds_read_b64_tr_b16 a[228:229], v6 offset:0
    s_cselect_b32 s42, 0, s42
    v_mfma_f32_16x16x32_bf16 v[72:75], a[232:235], v[232:235], v[72:75]
    v_exp_f32 v240, v160
    v_mfma_f32_16x16x32_bf16 v[76:79], a[232:235], v[236:239], v[76:79]
    v_exp_f32_e64 v241, v161
    v_mfma_f32_16x16x32_bf16 v[216:219], v[246:249], v[232:235], v[216:219]
    v_exp_f32_e64 v242, v162
    v_mfma_f32_16x16x32_bf16 v[92:95], a[236:239], v[236:239], v[92:95]
    ds_read_b64_tr_b16 a[230:231], v6 offset:8448
    v_cvt_pk_bf16_f32 v224, v240, v241
    v_mfma_f32_16x16x32_bf16 v[88:91], a[236:239], v[232:235], v[88:91]
    v_exp_f32_e64 v243, v163
    v_mfma_f32_16x16x32_bf16 v[104:107], a[240:243], v[232:235], v[104:107]
    v_exp_f32_e64 v244, v164
    v_mfma_f32_16x16x32_bf16 v[108:111], a[240:243], v[236:239], v[108:111]
    ds_read_b64_tr_b16 a[232:233], v3 offset:256
    v_cvt_pk_bf16_f32 v225, v242, v243
    v_mfma_f32_16x16x32_bf16 v[124:127], a[244:247], v[236:239], v[124:127]
    v_exp_f32_e64 v245, v165
    v_mfma_f32_16x16x32_bf16 v[120:123], a[244:247], v[232:235], v[120:123]
    v_exp_f32_e64 v240, v166
    v_mfma_f32_16x16x32_bf16 v[220:223], v[246:249], v[236:239], v[220:223]
    ds_read_b64_tr_b16 a[234:235], v3 offset:8704
    v_cvt_pk_bf16_f32 v226, v244, v245
    v_mfma_f32_16x16x32_bf16 v[136:139], a[248:251], v[232:235], v[136:139]
    ds_read_b64_tr_b16 a[236:237], v6 offset:256
    v_or3_b32 v254, v224, v225, v226
    v_mfma_f32_16x16x32_bf16 v[140:143], a[248:251], v[236:239], v[140:143]
    v_exp_f32_e64 v241, v167
    v_mfma_f32_16x16x32_bf16 v[156:159], a[252:255], v[236:239], v[156:159]
    v_exp_f32_e64 v242, v168
    v_mfma_f32_16x16x32_bf16 v[152:155], a[252:255], v[232:235], v[152:155]
    ds_read_b64_tr_b16 a[238:239], v6 offset:8704
    v_cvt_pk_bf16_f32 v227, v240, v241
    v_mfma_f32_16x16x32_bf16 v[176:179], a[192:195], a[160:163], v[200:203]
    ds_read_b64_tr_b16 a[240:241], v3 offset:512
    s_add_u32 s58, s58, 33792
    v_mfma_f32_16x16x32_bf16 v[176:179], a[196:199], a[164:167], v[176:179]
    v_exp_f32_e64 v243, v169
    v_mfma_f32_16x16x32_bf16 v[176:179], a[200:203], a[168:171], v[176:179]
    v_exp_f32_e64 v244, v170
    v_mfma_f32_16x16x32_bf16 v[176:179], a[204:207], a[172:175], v[176:179]
    v_exp_f32_e64 v245, v171
    v_mfma_f32_16x16x32_bf16 v[180:183], a[208:211], a[160:163], v[200:203]
    v_exp_f32_e64 v240, v172
    v_mfma_f32_16x16x32_bf16 v[180:183], a[212:215], a[164:167], v[180:183]
    v_exp_f32_e64 v241, v173
    v_mfma_f32_16x16x32_bf16 v[180:183], a[216:219], a[168:171], v[180:183]
    v_cvt_pk_bf16_f32 v228, v242, v243
    v_or3_b32 v254, v254, v227, v228
    v_mfma_f32_16x16x32_bf16 v[180:183], a[220:223], a[172:175], v[180:183]
    ds_read_b64_tr_b16 a[242:243], v3 offset:8960
    v_cvt_pk_bf16_f32 v229, v244, v245
    v_mfma_f32_16x16x32_bf16 v[188:191], a[208:211], a[176:179], v[204:207]
    ds_read_b64_tr_b16 a[244:245], v6 offset:512
    v_cvt_pk_bf16_f32 v230, v240, v241
    v_mfma_f32_16x16x32_bf16 v[188:191], a[212:215], a[180:183], v[188:191]
    ds_read_b64_tr_b16 a[246:247], v6 offset:8960
    v_or3_b32 v254, v254, v229, v230
    v_mfma_f32_16x16x32_bf16 v[188:191], a[216:219], a[184:187], v[188:191]
    v_exp_f32_e64 v242, v174
    v_mfma_f32_16x16x32_bf16 v[188:191], a[220:223], a[188:191], v[188:191]
    v_exp_f32_e64 v243, v175
    v_mfma_f32_16x16x32_bf16 v[184:187], a[192:195], a[176:179], v[204:207]
    s_cmp_eq_u32 s58, 135168
    s_cselect_b32 s58, 0, s58
    v_mfma_f32_16x16x32_bf16 v[184:187], a[196:199], a[180:183], v[184:187]
    v_add_u32 v1, s58, v24
    v_cvt_pk_bf16_f32 v231, v242, v243
    v_mfma_f32_16x16x32_bf16 v[184:187], a[200:203], a[184:187], v[184:187]
    v_add_u32_e64 v2, s58, v25
    v_bitop3_b32 v254, v254, v231, s54 bitop3:0xa8
    v_mfma_f32_16x16x32_bf16 v[184:187], a[204:207], a[188:191], v[184:187]
    buffer_store_dwordx2 a[112:113], v29, s[8:11], s46 offen sc1
    v_cmp_ne_u32 vcc, 0, v254
    s_cbranch_vccnz L_slow0_7
L_slow0_7_ret:
    s_waitcnt lgkmcnt(0)
    v_mfma_f32_16x16x32_bf16 v[32:35], a[224:227], v[224:227], v[32:35]
    ds_read_b64_tr_b16 a[248:249], v3 offset:768
    buffer_store_dwordx2 a[116:117], v29, s[8:11], s47 offen sc1
    v_mfma_f32_16x16x32_bf16 v[36:39], a[224:227], v[228:231], v[36:39]
    ds_read_b64_tr_b16 a[250:251], v3 offset:9216
    s_add_u32 m0, s42, s43
    v_mfma_f32_16x16x32_bf16 v[52:55], a[228:231], v[228:231], v[52:55]
    ds_read_b64_tr_b16 a[252:253], v6 offset:768
    buffer_load_dwordx4 v21, s[20:23], s41 offen lds
    v_mfma_f32_16x16x32_bf16 v[48:51], a[228:231], v[224:227], v[48:51]
    ds_read_b64_tr_b16 a[254:255], v6 offset:9216
    buffer_load_dwordx4 v22, s[20:23], s41 offen offset:1024 lds
    v_mfma_f32_16x16x32_bf16 v[64:67], a[232:235], v[224:227], v[64:67]
    v_exp_f32_e64 v240, v176
    v_mfma_f32_16x16x32_bf16 v[68:71], a[232:235], v[228:231], v[68:71]
    v_exp_f32_e64 v241, v177
    v_mfma_f32_16x16x32_bf16 v[208:211], v[246:249], v[224:227], v[208:211]
    v_exp_f32_e64 v242, v178
    v_mfma_f32_16x16x32_bf16 v[84:87], a[236:239], v[228:231], v[84:87]
    v_exp_f32_e64 v243, v179
    v_mfma_f32_16x16x32_bf16 v[80:83], a[236:239], v[224:227], v[80:83]
    v_exp_f32_e64 v244, v180
    v_mfma_f32_16x16x32_bf16 v[96:99], a[240:243], v[224:227], v[96:99]
    ds_read_b128 a[192:195], v1 offset:0
    buffer_load_dwordx4 v23, s[24:27], s41 offen offset:2048 lds
    v_mfma_f32_16x16x32_bf16 v[100:103], a[240:243], v[228:231], v[100:103]
    ds_read_b128 a[196:199], v2 offset:0
    v_cvt_pk_bf16_f32 v232, v240, v241
    v_mfma_f32_16x16x32_bf16 v[116:119], a[244:247], v[228:231], v[116:119]
    ds_read_b128 a[200:203], v1 offset:128
    v_cvt_pk_bf16_f32 v233, v242, v243
    v_mfma_f32_16x16x32_bf16 v[112:115], a[244:247], v[224:227], v[112:115]
    v_exp_f32_e64 v245, v181
    v_mfma_f32_16x16x32_bf16 v[212:215], v[246:249], v[228:231], v[212:215]
    ds_read_b128 a[204:207], v2 offset:128
    buffer_load_dwordx4 v26, s[24:27], s41 offen offset:3072 lds
    s_waitcnt lgkmcnt(4)
    v_mfma_f32_16x16x32_bf16 v[128:131], a[248:251], v[224:227], v[128:131]
    v_exp_f32 v240, v182
    v_mfma_f32_16x16x32_bf16 v[132:135], a[248:251], v[228:231], v[132:135]
    v_exp_f32_e64 v241, v183
    v_mfma_f32_16x16x32_bf16 v[148:151], a[252:255], v[228:231], v[148:151]
    v_exp_f32_e64 v242, v184
    v_mfma_f32_16x16x32_bf16 v[144:147], a[252:255], v[224:227], v[144:147]
    v_exp_f32 v243, v185
    s_mov_b32 s37, 5
L_at:
    v_mfma_f32_16x16x32_bf16 v[160:163], a[72:75], a[128:131], v[192:195]
    v_cvt_pk_bf16_f32 v234, v244, v245
    v_or3_b32 v254, v232, v233, v234
    v_mfma_f32_16x16x32_bf16 v[160:163], a[76:79], a[132:135], v[160:163]
    v_exp_f32_e64 v244, v186
    v_mfma_f32_16x16x32_bf16 v[160:163], a[88:91], a[136:139], v[160:163]
    v_exp_f32_e64 v245, v187
    v_mfma_f32_16x16x32_bf16 v[160:163], a[92:95], a[140:143], v[160:163]
    v_cvt_pk_bf16_f32 v235, v240, v241
    v_cvt_pk_bf16_f32 v236, v242, v243
    v_mfma_f32_16x16x32_bf16 v[164:167], a[104:107], a[128:131], v[192:195]
    v_exp_f32_e64 v240, v188
    v_mfma_f32_16x16x32_bf16 v[164:167], a[108:111], a[132:135], v[164:167]
    v_exp_f32_e64 v241, v189
    v_mfma_f32_16x16x32_bf16 v[164:167], a[120:123], a[136:139], v[164:167]
    v_exp_f32_e64 v242, v190
    v_mfma_f32_16x16x32_bf16 v[164:167], a[124:127], a[140:143], v[164:167]
    v_exp_f32_e64 v243, v191
    v_mfma_f32_16x16x32_bf16 v[172:175], a[104:107], a[144:147], v[196:199]
    ds_read_b128 a[208:211], v1 offset:8448
    s_add_u32 s41, s41, 8192
    v_mfma_f32_16x16x32_bf16 v[172:175], a[108:111], a[148:151], v[172:175]
    ds_read_b128 a[212:215], v2 offset:8448
    s_add_u32 s42, s42, 16896
    v_mfma_f32_16x16x32_bf16 v[172:175], a[120:123], a[152:155], v[172:175]
    v_or3_b32 v254, v254, v235, v236
    v_cvt_pk_bf16_f32 v237, v244, v245
    v_mfma_f32_16x16x32_bf16 v[172:175], a[124:127], a[156:159], v[172:175]
    v_cvt_pk_bf16_f32 v238, v240, v241
    v_or3_b32 v254, v254, v237, v238
    v_mfma_f32_16x16x32_bf16 v[168:171], a[72:75], a[144:147], v[196:199]
    v_cvt_pk_bf16_f32 v239, v242, v243
    v_bitop3_b32 v254, v254, v239, s54 bitop3:0xa8
    v_mfma_f32_16x16x32_bf16 v[168:171], a[76:79], a[148:151], v[168:171]
    v_cmp_ne_u32 vcc, 0, v254
    ds_read_b128 a[216:219], v1 offset:8576
    v_mfma_f32_16x16x32_bf16 v[168:171], a[88:91], a[152:155], v[168:171]
    s_cmp_eq_u32 s42, 135168
    ds_read_b128 a[220:223], v2 offset:8576
    v_mfma_f32_16x16x32_bf16 v[168:171], a[92:95], a[156:159], v[168:171]
    s_cselect_b32 s42, 0, s42
    s_cbranch_vccnz L_slow1_1
L_slow1_1_ret:
    v_mfma_f32_16x16x32_bf16 v[40:43], a[224:227], v[232:235], v[40:43]
    buffer_load_dword v31, v8, s[12:15], s30 offen
    s_add_u32 s30, s30, 1408
    v_mfma_f32_16x16x32_bf16 v[44:47], a[224:227], v[236:239], v[44:47]
    v_exp_f32 v240, v160
    v_mfma_f32_16x16x32_bf16 v[60:63], a[228:231], v[236:239], v[60:63]
    v_exp_f32_e64 v241, v161
    v_mfma_f32_16x16x32_bf16 v[56:59], a[228:231], v[232:235], v[56:59]
    v_exp_f32_e64 v242, v162
    v_mfma_f32_16x16x32_bf16 v[72:75], a[232:235], v[232:235], v[72:75]
    ds_read_b64_tr_b16 a[224:225], v3 offset:16896
    v_cvt_pk_bf16_f32 v224, v240, v241
    v_mfma_f32_16x16x32_bf16 v[76:79], a[232:235], v[236:239], v[76:79]
    v_exp_f32_e64 v243, v163
    v_mfma_f32_16x16x32_bf16 v[216:219], v[246:249], v[232:235], v[216:219]
    v_exp_f32_e64 v244, v164
    v_mfma_f32_16x16x32_bf16 v[92:95], a[236:239], v[236:239], v[92:95]
    ds_read_b64_tr_b16 a[226:227], v3 offset:25344
    v_cvt_pk_bf16_f32 v225, v242, v243
    v_mfma_f32_16x16x32_bf16 v[88:91], a[236:239], v[232:235], v[88:91]
    v_exp_f32_e64 v245, v165
    v_mfma_f32_16x16x32_bf16 v[104:107], a[240:243], v[232:235], v[104:107]
    v_exp_f32_e64 v240, v166
    v_mfma_f32_16x16x32_bf16 v[108:111], a[240:243], v[236:239], v[108:111]
    ds_read_b64_tr_b16 a[228:229], v6 offset:16896
    v_cvt_pk_bf16_f32 v226, v244, v245
    v_mfma_f32_16x16x32_bf16 v[124:127], a[244:247], v[236:239], v[124:127]
    ds_read_b64_tr_b16 a[230:231], v6 offset:25344
    v_or3_b32 v254, v224, v225, v226
    v_mfma_f32_16x16x32_bf16 v[120:123], a[244:247], v[232:235], v[120:123]
    v_exp_f32_e64 v241, v167
    v_mfma_f32_16x16x32_bf16 v[220:223], v[246:249], v[236:239], v[220:223]
    v_exp_f32_e64 v242, v168
    v_mfma_f32_16x16x32_bf16 v[136:139], a[248:251], v[232:235], v[136:139]
    ds_read_b64_tr_b16 a[232:233], v3 offset:17152
    v_cvt_pk_bf16_f32 v227, v240, v241
    v_mfma_f32_16x16x32_bf16 v[140:143], a[248:251], v[236:239], v[140:143]
    v_exp_f32_e64 v243, v169
    v_mfma_f32_16x16x32_bf16 v[156:159], a[252:255], v[236:239], v[156:159]
    v_exp_f32_e64 v244, v170
    v_mfma_f32_16x16x32_bf16 v[152:155], a[252:255], v[232:235], v[152:155]
    ds_read_b64_tr_b16 a[234:235], v3 offset:25600
    v_cvt_pk_bf16_f32 v228, v242, v243
    v_mfma_f32_16x16x32_bf16 v[176:179], a[72:75], a[160:163], v[200:203]
    ds_read_b64_tr_b16 a[236:237], v6 offset:17152
    buffer_load_dword v31, v9, s[16:19], s31 offen
    v_mfma_f32_16x16x32_bf16 v[176:179], a[76:79], a[164:167], v[176:179]
    ds_read_b64_tr_b16 a[238:239], v6 offset:25600
    s_add_u32 s31, s31, 1280
    v_mfma_f32_16x16x32_bf16 v[176:179], a[88:91], a[168:171], v[176:179]
    ds_read_b64_tr_b16 a[240:241], v3 offset:17408
    v_or3_b32 v254, v254, v227, v228
    v_mfma_f32_16x16x32_bf16 v[176:179], a[92:95], a[172:175], v[176:179]
    v_exp_f32_e64 v245, v171
    v_mfma_f32_16x16x32_bf16 v[180:183], a[104:107], a[160:163], v[200:203]
    v_exp_f32_e64 v240, v172
    v_mfma_f32_16x16x32_bf16 v[180:183], a[108:111], a[164:167], v[180:183]
    ds_read_b64_tr_b16 a[242:243], v3 offset:25856
    v_cvt_pk_bf16_f32 v229, v244, v245
    v_mfma_f32_16x16x32_bf16 v[180:183], a[120:123], a[168:171], v[180:183]
    v_exp_f32_e64 v241, v173
    v_mfma_f32_16x16x32_bf16 v[180:183], a[124:127], a[172:175], v[180:183]
    v_exp_f32_e64 v242, v174
    v_mfma_f32_16x16x32_bf16 v[188:191], a[104:107], a[176:179], v[204:207]
    ds_read_b64_tr_b16 a[244:245], v6 offset:17408
    v_cvt_pk_bf16_f32 v230, v240, v241
    v_mfma_f32_16x16x32_bf16 v[188:191], a[108:111], a[180:183], v[188:191]
    ds_read_b64_tr_b16 a[246:247], v6 offset:25856
    v_or3_b32 v254, v254, v229, v230
    v_mfma_f32_16x16x32_bf16 v[188:191], a[120:123], a[184:187], v[188:191]
    v_exp_f32_e64 v243, v175
    v_mfma_f32_16x16x32_bf16 v[188:191], a[124:127], a[188:191], v[188:191]
    v_mfma_f32_16x16x32_bf16 v[184:187], a[72:75], a[176:179], v[204:207]
    v_cvt_pk_bf16_f32 v231, v242, v243
    v_bitop3_b32 v254, v254, v231, s54 bitop3:0xa8
    v_mfma_f32_16x16x32_bf16 v[184:187], a[76:79], a[180:183], v[184:187]
    v_cmp_ne_u32 vcc, 0, v254
    v_mfma_f32_16x16x32_bf16 v[184:187], a[88:91], a[184:187], v[184:187]
    v_mfma_f32_16x16x32_bf16 v[184:187], a[92:95], a[188:191], v[184:187]
    s_cbranch_vccnz L_slow0_1
L_slow0_1_ret:
    s_waitcnt lgkmcnt(0)
    v_mfma_f32_16x16x32_bf16 v[32:35], a[224:227], v[224:227], v[32:35]
    v_exp_f32 v240, v176
    v_mfma_f32_16x16x32_bf16 v[36:39], a[224:227], v[228:231], v[36:39]
    v_exp_f32_e64 v241, v177
    v_mfma_f32_16x16x32_bf16 v[52:55], a[228:231], v[228:231], v[52:55]
    v_exp_f32_e64 v242, v178
    v_mfma_f32_16x16x32_bf16 v[48:51], a[228:231], v[224:227], v[48:51]
    ds_read_b64_tr_b16 a[248:249], v3 offset:17664
    v_cvt_pk_bf16_f32 v232, v240, v241
    v_mfma_f32_16x16x32_bf16 v[64:67], a[232:235], v[224:227], v[64:67]
    v_exp_f32_e64 v243, v179
    v_mfma_f32_16x16x32_bf16 v[68:71], a[232:235], v[228:231], v[68:71]
    ds_read_b64_tr_b16 a[250:251], v3 offset:26112
    v_mfma_f32_16x16x32_bf16 v[208:211], v[246:249], v[224:227], v[208:211]
    ds_read_b64_tr_b16 a[252:253], v6 offset:17664
    v_cvt_pk_bf16_f32 v233, v242, v243
    v_mfma_f32_16x16x32_bf16 v[84:87], a[236:239], v[228:231], v[84:87]
    ds_read_b64_tr_b16 a[254:255], v6 offset:26112
    v_mfma_f32_16x16x32_bf16 v[80:83], a[236:239], v[224:227], v[80:83]
    s_waitcnt vmcnt(16) lgkmcnt(0)
    s_barrier
    v_mfma_f32_16x16x32_bf16 v[96:99], a[240:243], v[224:227], v[96:99]
    ds_read_b128 a[72:75], v1 offset:16896
    v_add_u32_e64 v3, s58, v27
    v_mfma_f32_16x16x32_bf16 v[100:103], a[240:243], v[228:231], v[100:103]
    ds_read_b128 a[76:79], v2 offset:16896
    v_add_u32_e64 v6, s58, v28
    v_mfma_f32_16x16x32_bf16 v[116:119], a[244:247], v[228:231], v[116:119]
    ds_read_b128 a[88:91], v1 offset:17024
    s_add_u32 m0, s42, s43
    v_mfma_f32_16x16x32_bf16 v[112:115], a[244:247], v[224:227], v[112:115]
    v_exp_f32 v244, v180
    v_mfma_f32_16x16x32_bf16 v[212:215], v[246:249], v[228:231], v[212:215]
    ds_read_b128 a[92:95], v2 offset:17024
    v_mfma_f32_16x16x32_bf16 v[128:131], a[248:251], v[224:227], v[128:131]
    v_exp_f32_e64 v245, v181
    v_mfma_f32_16x16x32_bf16 v[132:135], a[248:251], v[228:231], v[132:135]
    v_exp_f32_e64 v240, v182
    v_mfma_f32_16x16x32_bf16 v[148:151], a[252:255], v[228:231], v[148:151]
    buffer_load_dwordx4 v21, s[20:23], s41 offen lds
    v_cvt_pk_bf16_f32 v234, v244, v245
    v_mfma_f32_16x16x32_bf16 v[144:147], a[252:255], v[224:227], v[144:147]
    buffer_load_dwordx4 v22, s[20:23], s41 offen offset:1024 lds
    v_or3_b32 v254, v232, v233, v234
    v_mfma_f32_16x16x32_bf16 v[160:163], a[192:195], a[128:131], v[192:195]
    buffer_load_dwordx4 v23, s[24:27], s41 offen offset:2048 lds
    ds_read_b128 a[104:107], v1 offset:25344
    v_mfma_f32_16x16x32_bf16 v[160:163], a[196:199], a[132:135], v[160:163]
    buffer_load_dwordx4 v26, s[24:27], s41 offen offset:3072 lds
    ds_read_b128 a[108:111], v2 offset:25344
    v_mfma_f32_16x16x32_bf16 v[160:163], a[200:203], a[136:139], v[160:163]
    v_exp_f32_e64 v241, v183
    v_mfma_f32_16x16x32_bf16 v[160:163], a[204:207], a[140:143], v[160:163]
    v_exp_f32_e64 v242, v184
    v_mfma_f32_16x16x32_bf16 v[164:167], a[208:211], a[128:131], v[192:195]
    v_exp_f32_e64 v243, v185
    v_mfma_f32_16x16x32_bf16 v[164:167], a[212:215], a[132:135], v[164:167]
    v_exp_f32_e64 v244, v186
    v_mfma_f32_16x16x32_bf16 v[164:167], a[216:219], a[136:139], v[164:167]
    v_exp_f32_e64 v245, v187
    v_mfma_f32_16x16x32_bf16 v[164:167], a[220:223], a[140:143], v[164:167]
    v_cvt_pk_bf16_f32 v235, v240, v241
    v_cvt_pk_bf16_f32 v236, v242, v243
    v_mfma_f32_16x16x32_bf16 v[172:175], a[208:211], a[144:147], v[196:199]
    v_exp_f32_e64 v240, v188
    v_mfma_f32_16x16x32_bf16 v[172:175], a[212:215], a[148:151], v[172:175]
    v_exp_f32_e64 v241, v189
    v_mfma_f32_16x16x32_bf16 v[172:175], a[216:219], a[152:155], v[172:175]
    v_exp_f32_e64 v242, v190
    v_mfma_f32_16x16x32_bf16 v[172:175], a[220:223], a[156:159], v[172:175]
    v_exp_f32_e64 v243, v191
    v_mfma_f32_16x16x32_bf16 v[168:171], a[192:195], a[144:147], v[196:199]
    v_or3_b32 v254, v254, v235, v236
    v_cvt_pk_bf16_f32 v237, v244, v245
    v_mfma_f32_16x16x32_bf16 v[168:171], a[196:199], a[148:151], v[168:171]
    v_cvt_pk_bf16_f32 v238, v240, v241
    v_or3_b32 v254, v254, v237, v238
    v_mfma_f32_16x16x32_bf16 v[168:171], a[200:203], a[152:155], v[168:171]
    ds_read_b128 a[120:123], v1 offset:25472
    v_cvt_pk_bf16_f32 v239, v242, v243
    v_mfma_f32_16x16x32_bf16 v[168:171], a[204:207], a[156:159], v[168:171]
    ds_read_b128 a[124:127], v2 offset:25472
    v_bitop3_b32 v254, v254, v239, s54 bitop3:0xa8
    v_cmp_ne_u32 vcc, 0, v254
    s_cbranch_vccnz L_slow1_2
L_slow1_2_ret:
    v_mfma_f32_16x16x32_bf16 v[40:43], a[224:227], v[232:235], v[40:43]
    s_add_u32 s41, s41, 8192
    s_add_u32 s42, s42, 16896
    v_mfma_f32_16x16x32_bf16 v[44:47], a[224:227], v[236:239], v[44:47]
    ds_read_b64_tr_b16 a[224:225], v3 offset:0
    s_cmp_eq_u32 s42, 135168
    v_mfma_f32_16x16x32_bf16 v[60:63], a[228:231], v[236:239], v[60:63]
    ds_read_b64_tr_b16 a[226:227], v3 offset:8448
    s_cselect_b32 s42, 0, s42
    v_mfma_f32_16x16x32_bf16 v[56:59], a[228:231], v[232:235], v[56:59]
    v_exp_f32 v240, v160
    v_mfma_f32_16x16x32_bf16 v[72:75], a[232:235], v[232:235], v[72:75]
    v_exp_f32_e64 v241, v161
    v_mfma_f32_16x16x32_bf16 v[76:79], a[232:235], v[236:239], v[76:79]
    v_exp_f32_e64 v242, v162
    v_mfma_f32_16x16x32_bf16 v[216:219], v[246:249], v[232:235], v[216:219]
    ds_read_b64_tr_b16 a[228:229], v6 offset:0
    v_cvt_pk_bf16_f32 v224, v240, v241
    v_mfma_f32_16x16x32_bf16 v[92:95], a[236:239], v[236:239], v[92:95]
    v_exp_f32_e64 v243, v163
    v_mfma_f32_16x16x32_bf16 v[88:91], a[236:239], v[232:235], v[88:91]
    v_exp_f32_e64 v244, v164
    v_mfma_f32_16x16x32_bf16 v[104:107], a[240:243], v[232:235], v[104:107]
    ds_read_b64_tr_b16 a[230:231], v6 offset:8448
    v_cvt_pk_bf16_f32 v225, v242, v243
    v_mfma_f32_16x16x32_bf16 v[108:111], a[240:243], v[236:239], v[108:111]
    v_exp_f32_e64 v245, v165
    v_mfma_f32_16x16x32_bf16 v[124:127], a[244:247], v[236:239], v[124:127]
    v_exp_f32_e64 v240, v166
    v_mfma_f32_16x16x32_bf16 v[120:123], a[244:247], v[232:235], v[120:123]
    ds_read_b64_tr_b16 a[232:233], v3 offset:256
    v_cvt_pk_bf16_f32 v226, v244, v245
    v_mfma_f32_16x16x32_bf16 v[220:223], v[246:249], v[236:239], v[220:223]
    ds_read_b64_tr_b16 a[234:235], v3 offset:8704
    v_or3_b32 v254, v224, v225, v226
    v_mfma_f32_16x16x32_bf16 v[136:139], a[248:251], v[232:235], v[136:139]
    v_exp_f32_e64 v241, v167
    v_mfma_f32_16x16x32_bf16 v[140:143], a[248:251], v[236:239], v[140:143]
    v_exp_f32_e64 v242, v168
    v_mfma_f32_16x16x32_bf16 v[156:159], a[252:255], v[236:239], v[156:159]
    ds_read_b64_tr_b16 a[236:237], v6 offset:256
    v_cvt_pk_bf16_f32 v227, v240, v241
    v_mfma_f32_16x16x32_bf16 v[152:155], a[252:255], v[232:235], v[152:155]
    v_exp_f32_e64 v243, v169
    v_mfma_f32_16x16x32_bf16 v[176:179], a[192:195], a[160:163], v[200:203]
    ds_read_b64_tr_b16 a[238:239], v6 offset:8704
    s_add_u32 s58, s58, 33792
    v_mfma_f32_16x16x32_bf16 v[176:179], a[196:199], a[164:167], v[176:179]
    ds_read_b64_tr_b16 a[240:241], v3 offset:512
    s_cmp_eq_u32 s58, 135168
    v_mfma_f32_16x16x32_bf16 v[176:179], a[200:203], a[168:171], v[176:179]
    v_exp_f32_e64 v244, v170
    v_mfma_f32_16x16x32_bf16 v[176:179], a[204:207], a[172:175], v[176:179]
    v_exp_f32_e64 v245, v171
    v_mfma_f32_16x16x32_bf16 v[180:183], a[208:211], a[160:163], v[200:203]
    v_exp_f32_e64 v240, v172
    v_mfma_f32_16x16x32_bf16 v[180:183], a[212:215], a[164:167], v[180:183]
    v_exp_f32_e64 v241, v173
    v_mfma_f32_16x16x32_bf16 v[180:183], a[216:219], a[168:171], v[180:183]
    v_cvt_pk_bf16_f32 v228, v242, v243
    v_or3_b32 v254, v254, v227, v228
    v_mfma_f32_16x16x32_bf16 v[180:183], a[220:223], a[172:175], v[180:183]
    ds_read_b64_tr_b16 a[242:243], v3 offset:8960
    v_cvt_pk_bf16_f32 v229, v244, v245
    v_mfma_f32_16x16x32_bf16 v[188:191], a[208:211], a[176:179], v[204:207]
    ds_read_b64_tr_b16 a[244:245], v6 offset:512
    v_cvt_pk_bf16_f32 v230, v240, v241
    v_mfma_f32_16x16x32_bf16 v[188:191], a[212:215], a[180:183], v[188:191]
    ds_read_b64_tr_b16 a[246:247], v6 offset:8960
    v_or3_b32 v254, v254, v229, v230
    v_mfma_f32_16x16x32_bf16 v[188:191], a[216:219], a[184:187], v[188:191]
    v_exp_f32_e64 v242, v174
    v_mfma_f32_16x16x32_bf16 v[188:191], a[220:223], a[188:191], v[188:191]
    v_exp_f32_e64 v243, v175
    v_mfma_f32_16x16x32_bf16 v[184:187], a[192:195], a[176:179], v[204:207]
    s_cselect_b32 s58, 0, s58
    v_add_u32 v1, s58, v24
    v_mfma_f32_16x16x32_bf16 v[184:187], a[196:199], a[180:183], v[184:187]
    v_cvt_pk_bf16_f32 v231, v242, v243
    v_bitop3_b32 v254, v254, v231, s54 bitop3:0xa8
    v_mfma_f32_16x16x32_bf16 v[184:187], a[200:203], a[184:187], v[184:187]
    v_add_u32 v2, s58, v25
    v_cmp_ne_u32 vcc, 0, v254
    v_mfma_f32_16x16x32_bf16 v[184:187], a[204:207], a[188:191], v[184:187]
    s_cbranch_vccnz L_slow0_2
L_slow0_2_ret:
    s_waitcnt lgkmcnt(0)
    v_mfma_f32_16x16x32_bf16 v[32:35], a[224:227], v[224:227], v[32:35]
    ds_read_b64_tr_b16 a[248:249], v3 offset:768
    s_add_u32 m0, s42, s43
    v_mfma_f32_16x16x32_bf16 v[36:39], a[224:227], v[228:231], v[36:39]
    ds_read_b64_tr_b16 a[250:251], v3 offset:9216
    buffer_load_dwordx4 v21, s[20:23], s41 offen lds
    v_mfma_f32_16x16x32_bf16 v[52:55], a[228:231], v[228:231], v[52:55]
    ds_read_b64_tr_b16 a[252:253], v6 offset:768
    buffer_load_dwordx4 v22, s[20:23], s41 offen offset:1024 lds
    v_mfma_f32_16x16x32_bf16 v[48:51], a[228:231], v[224:227], v[48:51]
    ds_read_b64_tr_b16 a[254:255], v6 offset:9216
    buffer_load_dwordx4 v23, s[24:27], s41 offen offset:2048 lds
    v_mfma_f32_16x16x32_bf16 v[64:67], a[232:235], v[224:227], v[64:67]
    v_exp_f32 v240, v176
    v_mfma_f32_16x16x32_bf16 v[68:71], a[232:235], v[228:231], v[68:71]
    v_exp_f32_e64 v241, v177
    v_mfma_f32_16x16x32_bf16 v[208:211], v[246:249], v[224:227], v[208:211]
    v_exp_f32_e64 v242, v178
    v_mfma_f32_16x16x32_bf16 v[84:87], a[236:239], v[228:231], v[84:87]
    v_exp_f32_e64 v243, v179
    v_mfma_f32_16x16x32_bf16 v[80:83], a[236:239], v[224:227], v[80:83]
    v_exp_f32_e64 v244, v180
    v_mfma_f32_16x16x32_bf16 v[96:99], a[240:243], v[224:227], v[96:99]
    ds_read_b128 a[192:195], v1 offset:0
    buffer_load_dwordx4 v26, s[24:27], s41 offen offset:3072 lds
    v_mfma_f32_16x16x32_bf16 v[100:103], a[240:243], v[228:231], v[100:103]
    ds_read_b128 a[196:199], v2 offset:0
    v_cvt_pk_bf16_f32 v232, v240, v241
    v_mfma_f32_16x16x32_bf16 v[116:119], a[244:247], v[228:231], v[116:119]
    ds_read_b128 a[200:203], v1 offset:128
    v_cvt_pk_bf16_f32 v233, v242, v243
    v_mfma_f32_16x16x32_bf16 v[112:115], a[244:247], v[224:227], v[112:115]
    v_exp_f32_e64 v245, v181
    v_mfma_f32_16x16x32_bf16 v[212:215], v[246:249], v[228:231], v[212:215]
    ds_read_b128 a[204:207], v2 offset:128
    s_waitcnt lgkmcnt(4)
    v_mfma_f32_16x16x32_bf16 v[128:131], a[248:251], v[224:227], v[128:131]
    v_exp_f32 v240, v182
    v_mfma_f32_16x16x32_bf16 v[132:135], a[248:251], v[228:231], v[132:135]
    v_exp_f32_e64 v241, v183
    v_mfma_f32_16x16x32_bf16 v[148:151], a[252:255], v[228:231], v[148:151]
    v_exp_f32_e64 v242, v184
    v_mfma_f32_16x16x32_bf16 v[144:147], a[252:255], v[224:227], v[144:147]
    v_exp_f32 v243, v185
    s_cmp_eq_u32 s37, 4
    s_cbranch_scc1 L_sigh
L_sigh_ret:
    s_sub_u32 s37, s37, 1
    s_cmp_lg_u32 s37, 0
    s_cbranch_scc1 L_at
    v_mfma_f32_16x16x32_bf16 v[160:163], a[72:75], a[128:131], v[192:195]
    v_cvt_pk_bf16_f32 v234, v244, v245
    v_or3_b32 v254, v232, v233, v234
    v_mfma_f32_16x16x32_bf16 v[160:163], a[76:79], a[132:135], v[160:163]
    v_exp_f32_e64 v244, v186
    v_mfma_f32_16x16x32_bf16 v[160:163], a[88:91], a[136:139], v[160:163]
    v_exp_f32_e64 v245, v187
    v_mfma_f32_16x16x32_bf16 v[160:163], a[92:95], a[140:143], v[160:163]
    v_cvt_pk_bf16_f32 v235, v240, v241
    v_cvt_pk_bf16_f32 v236, v242, v243
    v_mfma_f32_16x16x32_bf16 v[164:167], a[104:107], a[128:131], v[192:195]
    v_exp_f32_e64 v240, v188
    v_mfma_f32_16x16x32_bf16 v[164:167], a[108:111], a[132:135], v[164:167]
    v_exp_f32_e64 v241, v189
    v_mfma_f32_16x16x32_bf16 v[164:167], a[120:123], a[136:139], v[164:167]
    v_exp_f32_e64 v242, v190
    v_mfma_f32_16x16x32_bf16 v[164:167], a[124:127], a[140:143], v[164:167]
    v_exp_f32_e64 v243, v191
    v_mfma_f32_16x16x32_bf16 v[172:175], a[104:107], a[144:147], v[196:199]
    ds_read_b128 a[208:211], v1 offset:8448
    s_add_u32 s41, s41, 8192
    v_mfma_f32_16x16x32_bf16 v[172:175], a[108:111], a[148:151], v[172:175]
    ds_read_b128 a[212:215], v2 offset:8448
    s_add_u32 s42, s42, 16896
    v_mfma_f32_16x16x32_bf16 v[172:175], a[120:123], a[152:155], v[172:175]
    v_or3_b32 v254, v254, v235, v236
    v_cvt_pk_bf16_f32 v237, v244, v245
    v_mfma_f32_16x16x32_bf16 v[172:175], a[124:127], a[156:159], v[172:175]
    v_cvt_pk_bf16_f32 v238, v240, v241
    v_or3_b32 v254, v254, v237, v238
    v_mfma_f32_16x16x32_bf16 v[168:171], a[72:75], a[144:147], v[196:199]
    v_cvt_pk_bf16_f32 v239, v242, v243
    v_bitop3_b32 v254, v254, v239, s54 bitop3:0xa8
    v_mfma_f32_16x16x32_bf16 v[168:171], a[76:79], a[148:151], v[168:171]
    v_cmp_ne_u32 vcc, 0, v254
    ds_read_b128 a[216:219], v1 offset:8576
    v_mfma_f32_16x16x32_bf16 v[168:171], a[88:91], a[152:155], v[168:171]
    ds_read_b128 a[220:223], v2 offset:8576
    s_cmp_eq_u32 s42, 135168
    s_cselect_b32 s42, 0, s42
    s_mov_b32 s20, s76
    s_and_b32 s21, s77, 0xffff
    s_mov_b32 s22, 7340032
    s_mov_b32 s23, 0x20000
    s_mul_i32 s30, s34, 1835008
    s_mov_b32 s43, 41943040
    s_mul_i32 s28, s34, 28672
    s_add_u32 s28, s28, 20971520
    s_add_u32 s52, s28, 0x40000
    v_mfma_f32_16x16x32_bf16 v[168:171], a[92:95], a[156:159], v[168:171]
    s_cbranch_vccnz L_slow1_3
L_slow1_3_ret:
    v_mfma_f32_16x16x32_bf16 v[40:43], a[224:227], v[232:235], v[40:43]
    v_exp_f32_e64 v240, v160
    v_mfma_f32_16x16x32_bf16 v[44:47], a[224:227], v[236:239], v[44:47]
    v_exp_f32_e64 v241, v161
    v_mfma_f32_16x16x32_bf16 v[60:63], a[228:231], v[236:239], v[60:63]
    v_exp_f32_e64 v242, v162
    v_mfma_f32_16x16x32_bf16 v[56:59], a[228:231], v[232:235], v[56:59]
    ds_read_b64_tr_b16 a[224:225], v3 offset:16896
    v_cvt_pk_bf16_f32 v224, v240, v241
    v_mfma_f32_16x16x32_bf16 v[72:75], a[232:235], v[232:235], v[72:75]
    v_exp_f32_e64 v243, v163
    v_mfma_f32_16x16x32_bf16 v[76:79], a[232:235], v[236:239], v[76:79]
    v_exp_f32_e64 v244, v164
    v_mfma_f32_16x16x32_bf16 v[216:219], v[246:249], v[232:235], v[216:219]
    ds_read_b64_tr_b16 a[226:227], v3 offset:25344
    v_cvt_pk_bf16_f32 v225, v242, v243
    v_mfma_f32_16x16x32_bf16 v[92:95], a[236:239], v[236:239], v[92:95]
    v_exp_f32_e64 v245, v165
    v_mfma_f32_16x16x32_bf16 v[88:91], a[236:239], v[232:235], v[88:91]
    v_exp_f32_e64 v240, v166
    v_mfma_f32_16x16x32_bf16 v[104:107], a[240:243], v[232:235], v[104:107]
    ds_read_b64_tr_b16 a[228:229], v6 offset:16896
    v_cvt_pk_bf16_f32 v226, v244, v245
    v_mfma_f32_16x16x32_bf16 v[108:111], a[240:243], v[236:239], v[108:111]
    ds_read_b64_tr_b16 a[230:231], v6 offset:25344
    v_or3_b32 v254, v224, v225, v226
    v_mfma_f32_16x16x32_bf16 v[124:127], a[244:247], v[236:239], v[124:127]
    v_exp_f32_e64 v241, v167
    v_mfma_f32_16x16x32_bf16 v[120:123], a[244:247], v[232:235], v[120:123]
    v_exp_f32_e64 v242, v168
    v_mfma_f32_16x16x32_bf16 v[220:223], v[246:249], v[236:239], v[220:223]
    ds_read_b64_tr_b16 a[232:233], v3 offset:17152
    v_cvt_pk_bf16_f32 v227, v240, v241
    v_mfma_f32_16x16x32_bf16 v[136:139], a[248:251], v[232:235], v[136:139]
    v_exp_f32_e64 v243, v169
    v_mfma_f32_16x16x32_bf16 v[140:143], a[248:251], v[236:239], v[140:143]
    v_exp_f32_e64 v244, v170
    v_mfma_f32_16x16x32_bf16 v[156:159], a[252:255], v[236:239], v[156:159]
    ds_read_b64_tr_b16 a[234:235], v3 offset:25600
    v_cvt_pk_bf16_f32 v228, v242, v243
    v_mfma_f32_16x16x32_bf16 v[152:155], a[252:255], v[232:235], v[152:155]
    ds_read_b64_tr_b16 a[236:237], v6 offset:17152
    v_or3_b32 v254, v254, v227, v228
    v_mfma_f32_16x16x32_bf16 v[176:179], a[72:75], a[160:163], v[200:203]
    ds_read_b64_tr_b16 a[238:239], v6 offset:25600
    buffer_load_dword v19, v18, s[8:11], s43 offen sc1
    v_mfma_f32_16x16x32_bf16 v[176:179], a[76:79], a[164:167], v[176:179]
    v_exp_f32_e64 v245, v171
    v_mfma_f32_16x16x32_bf16 v[176:179], a[88:91], a[168:171], v[176:179]
    v_exp_f32_e64 v240, v172
    v_mfma_f32_16x16x32_bf16 v[176:179], a[92:95], a[172:175], v[176:179]
    ds_read_b64_tr_b16 a[240:241], v3 offset:17408
    v_cvt_pk_bf16_f32 v229, v244, v245
    v_mfma_f32_16x16x32_bf16 v[180:183], a[104:107], a[160:163], v[200:203]
    v_exp_f32_e64 v241, v173
    v_mfma_f32_16x16x32_bf16 v[180:183], a[108:111], a[164:167], v[180:183]
    v_exp_f32_e64 v242, v174
    v_mfma_f32_16x16x32_bf16 v[180:183], a[120:123], a[168:171], v[180:183]
    ds_read_b64_tr_b16 a[242:243], v3 offset:25856
    v_cvt_pk_bf16_f32 v230, v240, v241
    v_mfma_f32_16x16x32_bf16 v[180:183], a[124:127], a[172:175], v[180:183]
    ds_read_b64_tr_b16 a[244:245], v6 offset:17408
    v_or3_b32 v254, v254, v229, v230
    v_mfma_f32_16x16x32_bf16 v[188:191], a[104:107], a[176:179], v[204:207]
    v_exp_f32_e64 v243, v175
    v_mfma_f32_16x16x32_bf16 v[188:191], a[108:111], a[180:183], v[188:191]
    ds_read_b64_tr_b16 a[246:247], v6 offset:25856
    v_mfma_f32_16x16x32_bf16 v[188:191], a[120:123], a[184:187], v[188:191]
    v_cvt_pk_bf16_f32 v231, v242, v243
    v_bitop3_b32 v254, v254, v231, s54 bitop3:0xa8
    v_mfma_f32_16x16x32_bf16 v[188:191], a[124:127], a[188:191], v[188:191]
    v_cmp_ne_u32 vcc, 0, v254
    v_mfma_f32_16x16x32_bf16 v[184:187], a[72:75], a[176:179], v[204:207]
    v_mfma_f32_16x16x32_bf16 v[184:187], a[76:79], a[180:183], v[184:187]
    v_mfma_f32_16x16x32_bf16 v[184:187], a[88:91], a[184:187], v[184:187]
    v_mfma_f32_16x16x32_bf16 v[184:187], a[92:95], a[188:191], v[184:187]
    s_cbranch_vccnz L_slow0_3
L_slow0_3_ret:
    s_waitcnt lgkmcnt(0)
    v_mfma_f32_16x16x32_bf16 v[32:35], a[224:227], v[224:227], v[32:35]
    v_exp_f32 v240, v176
    v_mfma_f32_16x16x32_bf16 v[36:39], a[224:227], v[228:231], v[36:39]
    v_exp_f32_e64 v241, v177
    v_mfma_f32_16x16x32_bf16 v[52:55], a[228:231], v[228:231], v[52:55]
    v_exp_f32_e64 v242, v178
    v_mfma_f32_16x16x32_bf16 v[48:51], a[228:231], v[224:227], v[48:51]
    ds_read_b64_tr_b16 a[248:249], v3 offset:17664
    v_cvt_pk_bf16_f32 v232, v240, v241
    v_mfma_f32_16x16x32_bf16 v[64:67], a[232:235], v[224:227], v[64:67]
    v_exp_f32_e64 v243, v179
    v_mfma_f32_16x16x32_bf16 v[68:71], a[232:235], v[228:231], v[68:71]
    ds_read_b64_tr_b16 a[250:251], v3 offset:26112
    v_mfma_f32_16x16x32_bf16 v[208:211], v[246:249], v[224:227], v[208:211]
    ds_read_b64_tr_b16 a[252:253], v6 offset:17664
    v_cvt_pk_bf16_f32 v233, v242, v243
    v_mfma_f32_16x16x32_bf16 v[84:87], a[236:239], v[228:231], v[84:87]
    ds_read_b64_tr_b16 a[254:255], v6 offset:26112
    v_mfma_f32_16x16x32_bf16 v[80:83], a[236:239], v[224:227], v[80:83]
    s_waitcnt vmcnt(1) lgkmcnt(0)
    s_barrier
    v_mfma_f32_16x16x32_bf16 v[96:99], a[240:243], v[224:227], v[96:99]
    ds_read_b128 a[72:75], v1 offset:16896
    v_add_u32_e64 v3, s58, v27
    v_mfma_f32_16x16x32_bf16 v[100:103], a[240:243], v[228:231], v[100:103]
    ds_read_b128 a[76:79], v2 offset:16896
    v_add_u32_e64 v6, s58, v28
    v_mfma_f32_16x16x32_bf16 v[116:119], a[244:247], v[228:231], v[116:119]
    ds_read_b128 a[88:91], v1 offset:17024
    s_add_u32 m0, s35, 0
    v_mfma_f32_16x16x32_bf16 v[112:115], a[244:247], v[224:227], v[112:115]
    v_exp_f32 v244, v180
    v_mfma_f32_16x16x32_bf16 v[212:215], v[246:249], v[228:231], v[212:215]
    ds_read_b128 a[92:95], v2 offset:17024
    v_mfma_f32_16x16x32_bf16 v[128:131], a[248:251], v[224:227], v[128:131]
    v_exp_f32_e64 v245, v181
    v_mfma_f32_16x16x32_bf16 v[132:135], a[248:251], v[228:231], v[132:135]
    v_exp_f32_e64 v240, v182
    v_mfma_f32_16x16x32_bf16 v[148:151], a[252:255], v[228:231], v[148:151]
    buffer_load_dwordx4 v10, s[20:23], s30 offen offset:0 lds
    v_cvt_pk_bf16_f32 v234, v244, v245
    v_mfma_f32_16x16x32_bf16 v[144:147], a[252:255], v[224:227], v[144:147]
    buffer_load_dwordx4 v11, s[20:23], s30 offen offset:1024 lds
    v_or3_b32 v254, v232, v233, v234
    s_waitcnt vmcnt(2)
    v_cmp_ne_u32 vcc, 1, v19
    s_cbranch_vccz L_pollh_ok
    s_mov_b32 s60, 1048576
L_pollh:
    buffer_load_dword v19, v18, s[8:11], s43 offen sc1
    s_sub_u32 s60, s60, 1
    s_cbranch_scc1 L_pollh_ok
    s_waitcnt vmcnt(0)
    v_cmp_ne_u32 vcc, 1, v19
    s_cbranch_vccnz L_pollh
L_pollh_ok:
    v_mfma_f32_16x16x32_bf16 v[160:163], a[192:195], a[128:131], v[192:195]
    buffer_load_dwordx4 v12, s[20:23], s30 offen offset:2048 lds
    ds_read_b128 a[104:107], v1 offset:25344
    v_mfma_f32_16x16x32_bf16 v[160:163], a[196:199], a[132:135], v[160:163]
    buffer_load_dwordx4 v13, s[20:23], s30 offen offset:3072 lds
    ds_read_b128 a[108:111], v2 offset:25344
    v_mfma_f32_16x16x32_bf16 v[160:163], a[200:203], a[136:139], v[160:163]
    v_exp_f32_e64 v241, v183
    v_mfma_f32_16x16x32_bf16 v[160:163], a[204:207], a[140:143], v[160:163]
    v_exp_f32_e64 v242, v184
    v_mfma_f32_16x16x32_bf16 v[164:167], a[208:211], a[128:131], v[192:195]
    v_exp_f32_e64 v243, v185
    v_mfma_f32_16x16x32_bf16 v[164:167], a[212:215], a[132:135], v[164:167]
    v_exp_f32_e64 v244, v186
    v_mfma_f32_16x16x32_bf16 v[164:167], a[216:219], a[136:139], v[164:167]
    v_exp_f32_e64 v245, v187
    v_mfma_f32_16x16x32_bf16 v[164:167], a[220:223], a[140:143], v[164:167]
    v_cvt_pk_bf16_f32 v235, v240, v241
    v_cvt_pk_bf16_f32 v236, v242, v243
    v_mfma_f32_16x16x32_bf16 v[172:175], a[208:211], a[144:147], v[196:199]
    v_exp_f32_e64 v240, v188
    v_mfma_f32_16x16x32_bf16 v[172:175], a[212:215], a[148:151], v[172:175]
    v_exp_f32_e64 v241, v189
    v_mfma_f32_16x16x32_bf16 v[172:175], a[216:219], a[152:155], v[172:175]
    v_exp_f32_e64 v242, v190
    v_mfma_f32_16x16x32_bf16 v[172:175], a[220:223], a[156:159], v[172:175]
    s_add_u32 s30, s30, 131072
    v_or3_b32 v254, v254, v235, v236
    v_mfma_f32_16x16x32_bf16 v[168:171], a[192:195], a[144:147], v[196:199]
    s_add_u32 m0, s35, 16384
    v_cvt_pk_bf16_f32 v237, v244, v245
    v_mfma_f32_16x16x32_bf16 v[168:171], a[196:199], a[148:151], v[168:171]
    buffer_load_dwordx4 v10, s[20:23], s30 offen offset:0 lds
    v_cvt_pk_bf16_f32 v238, v240, v241
    v_mfma_f32_16x16x32_bf16 v[168:171], a[200:203], a[152:155], v[168:171]
    ds_read_b128 a[120:123], v1 offset:25472
    buffer_load_dwordx4 v11, s[20:23], s30 offen offset:1024 lds
    v_mfma_f32_16x16x32_bf16 v[168:171], a[204:207], a[156:159], v[168:171]
    ds_read_b128 a[124:127], v2 offset:25472
    v_exp_f32_e64 v243, v191
    v_or3_b32 v254, v254, v237, v238
    v_cvt_pk_bf16_f32 v239, v242, v243
    v_bitop3_b32 v254, v254, v239, s54 bitop3:0xa8
    v_cmp_ne_u32 vcc, 0, v254
    s_nop 0
    buffer_load_dwordx4 v12, s[20:23], s30 offen offset:2048 lds
    buffer_load_dwordx4 v13, s[20:23], s30 offen offset:3072 lds
    s_add_u32 s30, s30, 131072
    s_cbranch_vccnz L_slow1_4
L_slow1_4_ret:
    v_mfma_f32_16x16x32_bf16 v[40:43], a[224:227], v[232:235], v[40:43]
    v_exp_f32 v240, v160
    v_mfma_f32_16x16x32_bf16 v[44:47], a[224:227], v[236:239], v[44:47]
    v_exp_f32_e64 v241, v161
    v_mfma_f32_16x16x32_bf16 v[60:63], a[228:231], v[236:239], v[60:63]
    v_exp_f32_e64 v242, v162
    v_mfma_f32_16x16x32_bf16 v[56:59], a[228:231], v[232:235], v[56:59]
    ds_read_b64_tr_b16 a[224:225], v3 offset:0
    v_cvt_pk_bf16_f32 v224, v240, v241
    v_mfma_f32_16x16x32_bf16 v[72:75], a[232:235], v[232:235], v[72:75]
    v_exp_f32_e64 v243, v163
    v_mfma_f32_16x16x32_bf16 v[76:79], a[232:235], v[236:239], v[76:79]
    v_exp_f32_e64 v244, v164
    v_mfma_f32_16x16x32_bf16 v[216:219], v[246:249], v[232:235], v[216:219]
    ds_read_b64_tr_b16 a[226:227], v3 offset:8448
    v_cvt_pk_bf16_f32 v225, v242, v243
    v_mfma_f32_16x16x32_bf16 v[92:95], a[236:239], v[236:239], v[92:95]
    v_exp_f32_e64 v245, v165
    v_mfma_f32_16x16x32_bf16 v[88:91], a[236:239], v[232:235], v[88:91]
    v_exp_f32_e64 v240, v166
    v_mfma_f32_16x16x32_bf16 v[104:107], a[240:243], v[232:235], v[104:107]
    ds_read_b64_tr_b16 a[228:229], v6 offset:0
    v_cvt_pk_bf16_f32 v226, v244, v245
    v_mfma_f32_16x16x32_bf16 v[108:111], a[240:243], v[236:239], v[108:111]
    ds_read_b64_tr_b16 a[230:231], v6 offset:8448
    v_or3_b32 v254, v224, v225, v226
    v_mfma_f32_16x16x32_bf16 v[124:127], a[244:247], v[236:239], v[124:127]
    v_exp_f32_e64 v241, v167
    v_mfma_f32_16x16x32_bf16 v[120:123], a[244:247], v[232:235], v[120:123]
    v_exp_f32_e64 v242, v168
    v_mfma_f32_16x16x32_bf16 v[220:223], v[246:249], v[236:239], v[220:223]
    ds_read_b64_tr_b16 a[232:233], v3 offset:256
    v_cvt_pk_bf16_f32 v227, v240, v241
    v_mfma_f32_16x16x32_bf16 v[136:139], a[248:251], v[232:235], v[136:139]
    v_exp_f32_e64 v243, v169
    v_mfma_f32_16x16x32_bf16 v[140:143], a[248:251], v[236:239], v[140:143]
    v_exp_f32_e64 v244, v170
    v_mfma_f32_16x16x32_bf16 v[156:159], a[252:255], v[236:239], v[156:159]
    ds_read_b64_tr_b16 a[234:235], v3 offset:8704
    v_cvt_pk_bf16_f32 v228, v242, v243
    v_mfma_f32_16x16x32_bf16 v[152:155], a[252:255], v[232:235], v[152:155]
    ds_read_b64_tr_b16 a[236:237], v6 offset:256
    v_or3_b32 v254, v254, v227, v228
    v_mfma_f32_16x16x32_bf16 v[176:179], a[192:195], a[160:163], v[200:203]
    ds_read_b64_tr_b16 a[238:239], v6 offset:8704
    buffer_load_dwordx4 a[0:3], v14, s[8:11], s28 offen offset:0 sc1
    v_mfma_f32_16x16x32_bf16 v[176:179], a[196:199], a[164:167], v[176:179]
    ds_read_b64_tr_b16 a[240:241], v3 offset:512
    buffer_load_dwordx4 a[4:7], v15, s[8:11], s28 offen offset:0 sc1
    v_mfma_f32_16x16x32_bf16 v[176:179], a[200:203], a[168:171], v[176:179]
    ds_read_b64_tr_b16 a[242:243], v3 offset:8960
    buffer_load_dwordx4 a[8:11], v14, s[8:11], s52 offen offset:0 sc1
    v_mfma_f32_16x16x32_bf16 v[176:179], a[204:207], a[172:175], v[176:179]
    ds_read_b64_tr_b16 a[244:245], v6 offset:512
    buffer_load_dwordx4 a[12:15], v15, s[8:11], s52 offen offset:0 sc1
    v_mfma_f32_16x16x32_bf16 v[180:183], a[208:211], a[160:163], v[200:203]
    v_exp_f32_e64 v245, v171
    v_mfma_f32_16x16x32_bf16 v[180:183], a[212:215], a[164:167], v[180:183]
    v_exp_f32_e64 v240, v172
    v_mfma_f32_16x16x32_bf16 v[180:183], a[216:219], a[168:171], v[180:183]
    v_exp_f32_e64 v241, v173
    v_mfma_f32_16x16x32_bf16 v[180:183], a[220:223], a[172:175], v[180:183]
    v_exp_f32_e64 v242, v174
    v_mfma_f32_16x16x32_bf16 v[188:191], a[208:211], a[176:179], v[204:207]
    v_exp_f32_e64 v243, v175
    v_mfma_f32_16x16x32_bf16 v[188:191], a[212:215], a[180:183], v[188:191]
    ds_read_b64_tr_b16 a[246:247], v6 offset:8960
    v_cvt_pk_bf16_f32 v229, v244, v245
    v_mfma_f32_16x16x32_bf16 v[188:191], a[216:219], a[184:187], v[188:191]
    v_cvt_pk_bf16_f32 v230, v240, v241
    v_or3_b32 v254, v254, v229, v230
    v_mfma_f32_16x16x32_bf16 v[188:191], a[220:223], a[188:191], v[188:191]
    v_cvt_pk_bf16_f32 v231, v242, v243
    v_bitop3_b32 v254, v254, v231, s54 bitop3:0xa8
    v_mfma_f32_16x16x32_bf16 v[184:187], a[192:195], a[176:179], v[204:207]
    v_cmp_ne_u32 vcc, 0, v254
    v_mfma_f32_16x16x32_bf16 v[184:187], a[196:199], a[180:183], v[184:187]
    v_mfma_f32_16x16x32_bf16 v[184:187], a[200:203], a[184:187], v[184:187]
    v_mfma_f32_16x16x32_bf16 v[184:187], a[204:207], a[188:191], v[184:187]
    s_cbranch_vccnz L_slow0_4
L_slow0_4_ret:
    s_waitcnt lgkmcnt(0)
    v_mfma_f32_16x16x32_bf16 v[32:35], a[224:227], v[224:227], v[32:35]
    ds_read_b64_tr_b16 a[248:249], v3 offset:768
    buffer_load_dwordx4 a[16:19], v14, s[8:11], s28 offen offset:1024 sc1
    v_mfma_f32_16x16x32_bf16 v[36:39], a[224:227], v[228:231], v[36:39]
    ds_read_b64_tr_b16 a[250:251], v3 offset:9216
    buffer_load_dwordx4 a[20:23], v15, s[8:11], s28 offen offset:1024 sc1
    v_mfma_f32_16x16x32_bf16 v[52:55], a[228:231], v[228:231], v[52:55]
    ds_read_b64_tr_b16 a[252:253], v6 offset:768
    buffer_load_dwordx4 a[24:27], v14, s[8:11], s52 offen offset:1024 sc1
    v_mfma_f32_16x16x32_bf16 v[48:51], a[228:231], v[224:227], v[48:51]
    ds_read_b64_tr_b16 a[254:255], v6 offset:9216
    buffer_load_dwordx4 a[28:31], v15, s[8:11], s52 offen offset:1024 sc1
    v_mfma_f32_16x16x32_bf16 v[64:67], a[232:235], v[224:227], v[64:67]
    s_add_u32 s28, s28, 2048
    s_add_u32 s52, s52, 2048
    v_mfma_f32_16x16x32_bf16 v[68:71], a[232:235], v[228:231], v[68:71]
    v_exp_f32 v240, v176
    v_mfma_f32_16x16x32_bf16 v[208:211], v[246:249], v[224:227], v[208:211]
    v_exp_f32_e64 v241, v177
    v_mfma_f32_16x16x32_bf16 v[84:87], a[236:239], v[228:231], v[84:87]
    v_exp_f32_e64 v242, v178
    v_mfma_f32_16x16x32_bf16 v[80:83], a[236:239], v[224:227], v[80:83]
    v_exp_f32_e64 v243, v179
    v_mfma_f32_16x16x32_bf16 v[96:99], a[240:243], v[224:227], v[96:99]
    v_exp_f32_e64 v244, v180
    v_mfma_f32_16x16x32_bf16 v[100:103], a[240:243], v[228:231], v[100:103]
    v_exp_f32_e64 v245, v181
    v_mfma_f32_16x16x32_bf16 v[116:119], a[244:247], v[228:231], v[116:119]
    v_cvt_pk_bf16_f32 v232, v240, v241
    v_cvt_pk_bf16_f32 v233, v242, v243
    v_mfma_f32_16x16x32_bf16 v[112:115], a[244:247], v[224:227], v[112:115]
    v_exp_f32_e64 v240, v182
    v_mfma_f32_16x16x32_bf16 v[212:215], v[246:249], v[228:231], v[212:215]
    v_cvt_pk_bf16_f32 v234, v244, v245
    s_waitcnt lgkmcnt(0)
    v_mfma_f32_16x16x32_bf16 v[128:131], a[248:251], v[224:227], v[128:131]
    v_exp_f32 v241, v183
    v_mfma_f32_16x16x32_bf16 v[132:135], a[248:251], v[228:231], v[132:135]
    v_exp_f32_e64 v242, v184
    v_mfma_f32_16x16x32_bf16 v[148:151], a[252:255], v[228:231], v[148:151]
    v_exp_f32_e64 v243, v185
    v_mfma_f32_16x16x32_bf16 v[144:147], a[252:255], v[224:227], v[144:147]
    v_exp_f32_e64 v244, v186
    v_mfma_f32_16x16x32_bf16 v[160:163], a[72:75], a[128:131], v[192:195]
    s_add_u32 m0, s35, 32768
    v_or3_b32 v254, v232, v233, v234
    v_mfma_f32_16x16x32_bf16 v[160:163], a[76:79], a[132:135], v[160:163]
    buffer_load_dwordx4 v10, s[20:23], s30 offen offset:0 lds
    v_cvt_pk_bf16_f32 v235, v240, v241
    v_mfma_f32_16x16x32_bf16 v[160:163], a[88:91], a[136:139], v[160:163]
    buffer_load_dwordx4 v11, s[20:23], s30 offen offset:1024 lds
    v_cvt_pk_bf16_f32 v236, v242, v243
    v_mfma_f32_16x16x32_bf16 v[160:163], a[92:95], a[140:143], v[160:163]
    v_exp_f32_e64 v245, v187
    v_mfma_f32_16x16x32_bf16 v[164:167], a[104:107], a[128:131], v[192:195]
    v_exp_f32_e64 v240, v188
    v_mfma_f32_16x16x32_bf16 v[164:167], a[108:111], a[132:135], v[164:167]
    v_exp_f32_e64 v241, v189
    v_mfma_f32_16x16x32_bf16 v[164:167], a[120:123], a[136:139], v[164:167]
    v_exp_f32_e64 v242, v190
    v_mfma_f32_16x16x32_bf16 v[164:167], a[124:127], a[140:143], v[164:167]
    v_exp_f32_e64 v243, v191
    v_mfma_f32_16x16x32_bf16 v[172:175], a[104:107], a[144:147], v[196:199]
    buffer_load_dwordx4 v12, s[20:23], s30 offen offset:2048 lds
    v_or3_b32 v254, v254, v235, v236
    v_mfma_f32_16x16x32_bf16 v[172:175], a[108:111], a[148:151], v[172:175]
    buffer_load_dwordx4 v13, s[20:23], s30 offen offset:3072 lds
    v_cvt_pk_bf16_f32 v237, v244, v245
    v_mfma_f32_16x16x32_bf16 v[172:175], a[120:123], a[152:155], v[172:175]
    s_add_u32 s30, s30, 131072
    v_cvt_pk_bf16_f32 v238, v240, v241
    v_mfma_f32_16x16x32_bf16 v[172:175], a[124:127], a[156:159], v[172:175]
    v_or3_b32 v254, v254, v237, v238
    v_cvt_pk_bf16_f32 v239, v242, v243
    v_mfma_f32_16x16x32_bf16 v[168:171], a[72:75], a[144:147], v[196:199]
    v_bitop3_b32 v254, v254, v239, s54 bitop3:0xa8
    v_cmp_ne_u32 vcc, 0, v254
    v_mfma_f32_16x16x32_bf16 v[168:171], a[76:79], a[148:151], v[168:171]
    v_mfma_f32_16x16x32_bf16 v[168:171], a[88:91], a[152:155], v[168:171]
    v_mfma_f32_16x16x32_bf16 v[168:171], a[92:95], a[156:159], v[168:171]
    s_cbranch_vccnz L_slow1_5
L_slow1_5_ret:
    v_mfma_f32_16x16x32_bf16 v[40:43], a[224:227], v[232:235], v[40:43]
    v_exp_f32_e64 v240, v160
    v_mfma_f32_16x16x32_bf16 v[44:47], a[224:227], v[236:239], v[44:47]
    v_exp_f32_e64 v241, v161
    v_mfma_f32_16x16x32_bf16 v[60:63], a[228:231], v[236:239], v[60:63]
    v_exp_f32_e64 v242, v162
    v_mfma_f32_16x16x32_bf16 v[56:59], a[228:231], v[232:235], v[56:59]
    ds_read_b64_tr_b16 a[224:225], v3 offset:16896
    v_cvt_pk_bf16_f32 v224, v240, v241
    v_mfma_f32_16x16x32_bf16 v[72:75], a[232:235], v[232:235], v[72:75]
    v_exp_f32_e64 v243, v163
    v_mfma_f32_16x16x32_bf16 v[76:79], a[232:235], v[236:239], v[76:79]
    v_exp_f32_e64 v244, v164
    v_mfma_f32_16x16x32_bf16 v[216:219], v[246:249], v[232:235], v[216:219]
    ds_read_b64_tr_b16 a[226:227], v3 offset:25344
    v_cvt_pk_bf16_f32 v225, v242, v243
    v_mfma_f32_16x16x32_bf16 v[92:95], a[236:239], v[236:239], v[92:95]
    v_exp_f32_e64 v245, v165
    v_mfma_f32_16x16x32_bf16 v[88:91], a[236:239], v[232:235], v[88:91]
    v_exp_f32_e64 v240, v166
    v_mfma_f32_16x16x32_bf16 v[104:107], a[240:243], v[232:235], v[104:107]
    ds_read_b64_tr_b16 a[228:229], v6 offset:16896
    v_cvt_pk_bf16_f32 v226, v244, v245
    v_mfma_f32_16x16x32_bf16 v[108:111], a[240:243], v[236:239], v[108:111]
    ds_read_b64_tr_b16 a[230:231], v6 offset:25344
    v_or3_b32 v254, v224, v225, v226
    v_mfma_f32_16x16x32_bf16 v[124:127], a[244:247], v[236:239], v[124:127]
    v_exp_f32_e64 v241, v167
    v_mfma_f32_16x16x32_bf16 v[120:123], a[244:247], v[232:235], v[120:123]
    v_exp_f32_e64 v242, v168
    v_mfma_f32_16x16x32_bf16 v[220:223], v[246:249], v[236:239], v[220:223]
    ds_read_b64_tr_b16 a[232:233], v3 offset:17152
    v_cvt_pk_bf16_f32 v227, v240, v241
    v_mfma_f32_16x16x32_bf16 v[136:139], a[248:251], v[232:235], v[136:139]
    v_exp_f32_e64 v243, v169
    v_mfma_f32_16x16x32_bf16 v[140:143], a[248:251], v[236:239], v[140:143]
    v_exp_f32_e64 v244, v170
    v_mfma_f32_16x16x32_bf16 v[156:159], a[252:255], v[236:239], v[156:159]
    ds_read_b64_tr_b16 a[234:235], v3 offset:25600
    v_cvt_pk_bf16_f32 v228, v242, v243
    v_mfma_f32_16x16x32_bf16 v[152:155], a[252:255], v[232:235], v[152:155]
    ds_read_b64_tr_b16 a[236:237], v6 offset:17152
    v_or3_b32 v254, v254, v227, v228
    v_mfma_f32_16x16x32_bf16 v[176:179], a[72:75], a[160:163], v[200:203]
    ds_read_b64_tr_b16 a[238:239], v6 offset:25600
    buffer_load_dwordx4 a[32:35], v14, s[8:11], s28 offen offset:0 sc1
    v_mfma_f32_16x16x32_bf16 v[176:179], a[76:79], a[164:167], v[176:179]
    ds_read_b64_tr_b16 a[240:241], v3 offset:17408
    buffer_load_dwordx4 a[36:39], v15, s[8:11], s28 offen offset:0 sc1
    v_mfma_f32_16x16x32_bf16 v[176:179], a[88:91], a[168:171], v[176:179]
    ds_read_b64_tr_b16 a[242:243], v3 offset:25856
    buffer_load_dwordx4 a[40:43], v14, s[8:11], s52 offen offset:0 sc1
    v_mfma_f32_16x16x32_bf16 v[176:179], a[92:95], a[172:175], v[176:179]
    ds_read_b64_tr_b16 a[244:245], v6 offset:17408
    buffer_load_dwordx4 a[44:47], v15, s[8:11], s52 offen offset:0 sc1
    v_mfma_f32_16x16x32_bf16 v[180:183], a[104:107], a[160:163], v[200:203]
    v_exp_f32_e64 v245, v171
    v_mfma_f32_16x16x32_bf16 v[180:183], a[108:111], a[164:167], v[180:183]
    v_exp_f32_e64 v240, v172
    v_mfma_f32_16x16x32_bf16 v[180:183], a[120:123], a[168:171], v[180:183]
    v_exp_f32_e64 v241, v173
    v_mfma_f32_16x16x32_bf16 v[180:183], a[124:127], a[172:175], v[180:183]
    v_exp_f32_e64 v242, v174
    v_mfma_f32_16x16x32_bf16 v[188:191], a[104:107], a[176:179], v[204:207]
    v_exp_f32_e64 v243, v175
    v_mfma_f32_16x16x32_bf16 v[188:191], a[108:111], a[180:183], v[188:191]
    ds_read_b64_tr_b16 a[246:247], v6 offset:25856
    v_cvt_pk_bf16_f32 v229, v244, v245
    v_mfma_f32_16x16x32_bf16 v[188:191], a[120:123], a[184:187], v[188:191]
    v_cvt_pk_bf16_f32 v230, v240, v241
    v_or3_b32 v254, v254, v229, v230
    v_mfma_f32_16x16x32_bf16 v[188:191], a[124:127], a[188:191], v[188:191]
    v_cvt_pk_bf16_f32 v231, v242, v243
    v_bitop3_b32 v254, v254, v231, s54 bitop3:0xa8
    v_mfma_f32_16x16x32_bf16 v[184:187], a[72:75], a[176:179], v[204:207]
    v_cmp_ne_u32 vcc, 0, v254
    v_mfma_f32_16x16x32_bf16 v[184:187], a[76:79], a[180:183], v[184:187]
    v_mfma_f32_16x16x32_bf16 v[184:187], a[88:91], a[184:187], v[184:187]
    v_mfma_f32_16x16x32_bf16 v[184:187], a[92:95], a[188:191], v[184:187]
    s_cbranch_vccnz L_slow0_5
L_slow0_5_ret:
    s_waitcnt lgkmcnt(0)
    v_mfma_f32_16x16x32_bf16 v[32:35], a[224:227], v[224:227], v[32:35]
    v_exp_f32 v240, v176
    v_mfma_f32_16x16x32_bf16 v[36:39], a[224:227], v[228:231], v[36:39]
    v_exp_f32_e64 v241, v177
    v_mfma_f32_16x16x32_bf16 v[52:55], a[228:231], v[228:231], v[52:55]
    v_exp_f32_e64 v242, v178
    v_mfma_f32_16x16x32_bf16 v[48:51], a[228:231], v[224:227], v[48:51]
    ds_read_b64_tr_b16 a[248:249], v3 offset:17664
    v_cvt_pk_bf16_f32 v232, v240, v241
    v_mfma_f32_16x16x32_bf16 v[64:67], a[232:235], v[224:227], v[64:67]
    v_exp_f32_e64 v243, v179
    v_mfma_f32_16x16x32_bf16 v[68:71], a[232:235], v[228:231], v[68:71]
    ds_read_b64_tr_b16 a[250:251], v3 offset:26112
    v_mfma_f32_16x16x32_bf16 v[208:211], v[246:249], v[224:227], v[208:211]
    ds_read_b64_tr_b16 a[252:253], v6 offset:17664
    v_cvt_pk_bf16_f32 v233, v242, v243
    v_mfma_f32_16x16x32_bf16 v[84:87], a[236:239], v[228:231], v[84:87]
    ds_read_b64_tr_b16 a[254:255], v6 offset:26112
    v_mfma_f32_16x16x32_bf16 v[80:83], a[236:239], v[224:227], v[80:83]
    v_mfma_f32_16x16x32_bf16 v[96:99], a[240:243], v[224:227], v[96:99]
    buffer_load_dwordx4 a[48:51], v14, s[8:11], s28 offen offset:1024 sc1
    buffer_load_dwordx4 a[52:55], v15, s[8:11], s28 offen offset:1024 sc1
    v_mfma_f32_16x16x32_bf16 v[100:103], a[240:243], v[228:231], v[100:103]
    buffer_load_dwordx4 a[56:59], v14, s[8:11], s52 offen offset:1024 sc1
    buffer_load_dwordx4 a[60:63], v15, s[8:11], s52 offen offset:1024 sc1
    v_mfma_f32_16x16x32_bf16 v[116:119], a[244:247], v[228:231], v[116:119]
    s_add_u32 s28, s28, 2048
    s_add_u32 s52, s52, 2048
    v_mfma_f32_16x16x32_bf16 v[112:115], a[244:247], v[224:227], v[112:115]
    v_exp_f32_e64 v244, v180
    v_mfma_f32_16x16x32_bf16 v[212:215], v[246:249], v[228:231], v[212:215]
    s_waitcnt lgkmcnt(0)
    v_mfma_f32_16x16x32_bf16 v[128:131], a[248:251], v[224:227], v[128:131]
    v_exp_f32 v245, v181
    v_mfma_f32_16x16x32_bf16 v[132:135], a[248:251], v[228:231], v[132:135]
    v_exp_f32_e64 v240, v182
    v_mfma_f32_16x16x32_bf16 v[148:151], a[252:255], v[228:231], v[148:151]
    v_exp_f32_e64 v241, v183
    v_mfma_f32_16x16x32_bf16 v[144:147], a[252:255], v[224:227], v[144:147]
    v_exp_f32 v242, v184
    v_exp_f32 v243, v185
    v_cvt_pk_bf16_f32 v234, v244, v245
    v_or3_b32 v254, v232, v233, v234
    v_exp_f32 v244, v186
    v_exp_f32 v245, v187
    v_cvt_pk_bf16_f32 v235, v240, v241
    v_cvt_pk_bf16_f32 v236, v242, v243
    v_exp_f32 v240, v188
    v_exp_f32 v241, v189
    v_exp_f32 v242, v190
    v_exp_f32 v243, v191
    v_or3_b32 v254, v254, v235, v236
    v_cvt_pk_bf16_f32 v237, v244, v245
    v_cvt_pk_bf16_f32 v238, v240, v241
    v_or3_b32 v254, v254, v237, v238
    v_cvt_pk_bf16_f32 v239, v242, v243
    v_bitop3_b32 v254, v254, v239, s54 bitop3:0xa8
    v_cmp_ne_u32 vcc, 0, v254
    s_cbranch_vccnz L_slow1_99
L_slow1_99_ret:
    v_mfma_f32_16x16x32_bf16 v[40:43], a[224:227], v[232:235], v[40:43]
    buffer_load_dwordx4 a[64:67], v14, s[8:11], s28 offen offset:0 sc1
    v_mfma_f32_16x16x32_bf16 v[44:47], a[224:227], v[236:239], v[44:47]
    v_mfma_f32_16x16x32_bf16 v[60:63], a[228:231], v[236:239], v[60:63]
    buffer_load_dwordx4 a[68:71], v15, s[8:11], s28 offen offset:0 sc1
    v_mfma_f32_16x16x32_bf16 v[56:59], a[228:231], v[232:235], v[56:59]
    v_mfma_f32_16x16x32_bf16 v[72:75], a[232:235], v[232:235], v[72:75]
    buffer_load_dwordx4 a[72:75], v14, s[8:11], s52 offen offset:0 sc1
    v_mfma_f32_16x16x32_bf16 v[76:79], a[232:235], v[236:239], v[76:79]
    v_mfma_f32_16x16x32_bf16 v[216:219], v[246:249], v[232:235], v[216:219]
    buffer_load_dwordx4 a[76:79], v15, s[8:11], s52 offen offset:0 sc1
    v_mfma_f32_16x16x32_bf16 v[92:95], a[236:239], v[236:239], v[92:95]
    v_mfma_f32_16x16x32_bf16 v[88:91], a[236:239], v[232:235], v[88:91]
    buffer_load_dwordx4 a[80:83], v14, s[8:11], s28 offen offset:1024 sc1
    v_mfma_f32_16x16x32_bf16 v[104:107], a[240:243], v[232:235], v[104:107]
    v_mfma_f32_16x16x32_bf16 v[108:111], a[240:243], v[236:239], v[108:111]
    buffer_load_dwordx4 a[84:87], v15, s[8:11], s28 offen offset:1024 sc1
    v_mfma_f32_16x16x32_bf16 v[124:127], a[244:247], v[236:239], v[124:127]
    v_mfma_f32_16x16x32_bf16 v[120:123], a[244:247], v[232:235], v[120:123]
    buffer_load_dwordx4 a[88:91], v14, s[8:11], s52 offen offset:1024 sc1
    v_mfma_f32_16x16x32_bf16 v[220:223], v[246:249], v[236:239], v[220:223]
    v_mfma_f32_16x16x32_bf16 v[136:139], a[248:251], v[232:235], v[136:139]
    buffer_load_dwordx4 a[92:95], v15, s[8:11], s52 offen offset:1024 sc1
    v_mfma_f32_16x16x32_bf16 v[140:143], a[248:251], v[236:239], v[140:143]
    v_mfma_f32_16x16x32_bf16 v[156:159], a[252:255], v[236:239], v[156:159]
    v_mfma_f32_16x16x32_bf16 v[152:155], a[252:255], v[232:235], v[152:155]
    v_rcp_f32 v240, v208
    v_rcp_f32 v242, v212
    v_rcp_f32 v244, v216
    v_rcp_f32 v246, v220
    v_mov_b32 v241, v240
    v_mov_b32 v243, v242
    v_mov_b32 v245, v244
    v_mov_b32 v247, v246
    v_pk_mul_f32 v[32:33], v[32:33], v[240:241]
    v_pk_mul_f32 v[34:35], v[34:35], v[240:241]
    v_pk_mul_f32 v[48:49], v[48:49], v[240:241]
    v_pk_mul_f32 v[50:51], v[50:51], v[240:241]
    s_add_u32 s28, s28, 2048
    s_add_u32 s52, s52, 2048
    s_add_u32 m0, s35, 49152
    v_cvt_pk_bf16_f32 v160, v32, v33
    v_cvt_pk_bf16_f32 v161, v34, v35
    v_mov_b64 v[32:33], 0
    v_mov_b64 v[34:35], 0
    v_cvt_pk_bf16_f32 v162, v48, v49
    v_cvt_pk_bf16_f32 v163, v50, v51
    v_mov_b64 v[48:49], 0
    v_mov_b64 v[50:51], 0
    v_pk_mul_f32 v[36:37], v[36:37], v[242:243]
    v_pk_mul_f32 v[38:39], v[38:39], v[242:243]
    v_pk_mul_f32 v[52:53], v[52:53], v[242:243]
    v_pk_mul_f32 v[54:55], v[54:55], v[242:243]
    v_cvt_pk_bf16_f32 v164, v36, v37
    v_cvt_pk_bf16_f32 v165, v38, v39
    v_mov_b64 v[36:37], 0
    v_mov_b64 v[38:39], 0
    v_cvt_pk_bf16_f32 v166, v52, v53
    v_cvt_pk_bf16_f32 v167, v54, v55
    v_mov_b64 v[52:53], 0
    v_mov_b64 v[54:55], 0
    v_pk_mul_f32 v[40:41], v[40:41], v[244:245]
    v_pk_mul_f32 v[42:43], v[42:43], v[244:245]
    v_pk_mul_f32 v[56:57], v[56:57], v[244:245]
    v_pk_mul_f32 v[58:59], v[58:59], v[244:245]
    buffer_load_dwordx4 v10, s[20:23], s30 offen offset:0 lds
    buffer_load_dwordx4 v11, s[20:23], s30 offen offset:1024 lds
    buffer_load_dwordx4 v12, s[20:23], s30 offen offset:2048 lds
    v_cvt_pk_bf16_f32 v168, v40, v41
    v_cvt_pk_bf16_f32 v169, v42, v43
    v_mov_b64 v[40:41], 0
    v_mov_b64 v[42:43], 0
    v_cvt_pk_bf16_f32 v170, v56, v57
    v_cvt_pk_bf16_f32 v171, v58, v59
    v_mov_b64 v[56:57], 0
    v_mov_b64 v[58:59], 0
    v_pk_mul_f32 v[44:45], v[44:45], v[246:247]
    v_pk_mul_f32 v[46:47], v[46:47], v[246:247]
    v_pk_mul_f32 v[60:61], v[60:61], v[246:247]
    v_pk_mul_f32 v[62:63], v[62:63], v[246:247]
    v_cvt_pk_bf16_f32 v172, v44, v45
    v_cvt_pk_bf16_f32 v173, v46, v47
    v_mov_b64 v[44:45], 0
    v_mov_b64 v[46:47], 0
    v_cvt_pk_bf16_f32 v174, v60, v61
    v_cvt_pk_bf16_f32 v175, v62, v63
    v_mov_b64 v[60:61], 0
    v_mov_b64 v[62:63], 0
    v_pk_mul_f32 v[64:65], v[64:65], v[240:241]
    v_pk_mul_f32 v[66:67], v[66:67], v[240:241]
    v_pk_mul_f32 v[80:81], v[80:81], v[240:241]
    v_pk_mul_f32 v[82:83], v[82:83], v[240:241]
    buffer_load_dwordx4 v13, s[20:23], s30 offen offset:3072 lds
    s_add_u32 s30, s30, 131072
    s_add_u32 m0, s29, 0
    v_cvt_pk_bf16_f32 v176, v64, v65
    v_cvt_pk_bf16_f32 v177, v66, v67
    v_mov_b64 v[64:65], 0
    v_mov_b64_e64 v[66:67], 0
    v_cvt_pk_bf16_f32 v178, v80, v81
    v_cvt_pk_bf16_f32 v179, v82, v83
    v_mov_b64 v[80:81], 0
    v_mov_b64 v[82:83], 0
    v_pk_mul_f32 v[68:69], v[68:69], v[242:243]
    v_pk_mul_f32 v[70:71], v[70:71], v[242:243]
    v_pk_mul_f32 v[84:85], v[84:85], v[242:243]
    v_pk_mul_f32 v[86:87], v[86:87], v[242:243]
    v_cvt_pk_bf16_f32 v180, v68, v69
    v_cvt_pk_bf16_f32 v181, v70, v71
    v_mov_b64 v[68:69], 0
    v_mov_b64 v[70:71], 0
    v_cvt_pk_bf16_f32 v182, v84, v85
    v_cvt_pk_bf16_f32 v183, v86, v87
    v_mov_b64 v[84:85], 0
    v_mov_b64 v[86:87], 0
    v_pk_mul_f32 v[72:73], v[72:73], v[244:245]
    v_pk_mul_f32 v[74:75], v[74:75], v[244:245]
    v_pk_mul_f32 v[88:89], v[88:89], v[244:245]
    v_pk_mul_f32 v[90:91], v[90:91], v[244:245]
    buffer_load_dwordx4 v10, s[20:23], s30 offen offset:0 lds
    buffer_load_dwordx4 v11, s[20:23], s30 offen offset:1024 lds
    buffer_load_dwordx4 v12, s[20:23], s30 offen offset:2048 lds
    v_cvt_pk_bf16_f32 v184, v72, v73
    v_cvt_pk_bf16_f32 v185, v74, v75
    v_mov_b64 v[72:73], 0
    v_mov_b64 v[74:75], 0
    v_cvt_pk_bf16_f32 v186, v88, v89
    v_cvt_pk_bf16_f32 v187, v90, v91
    v_mov_b64 v[88:89], 0
    v_mov_b64 v[90:91], 0
    v_pk_mul_f32 v[76:77], v[76:77], v[246:247]
    v_pk_mul_f32 v[78:79], v[78:79], v[246:247]
    v_pk_mul_f32 v[92:93], v[92:93], v[246:247]
    v_pk_mul_f32 v[94:95], v[94:95], v[246:247]
    v_cvt_pk_bf16_f32 v188, v76, v77
    v_cvt_pk_bf16_f32 v189, v78, v79
    v_mov_b64 v[76:77], 0
    v_mov_b64 v[78:79], 0
    v_cvt_pk_bf16_f32 v190, v92, v93
    v_cvt_pk_bf16_f32 v191, v94, v95
    v_mov_b64 v[92:93], 0
    v_mov_b64 v[94:95], 0
    v_pk_mul_f32 v[96:97], v[96:97], v[240:241]
    v_pk_mul_f32 v[98:99], v[98:99], v[240:241]
    v_pk_mul_f32 v[112:113], v[112:113], v[240:241]
    v_pk_mul_f32 v[114:115], v[114:115], v[240:241]
    buffer_load_dwordx4 v13, s[20:23], s30 offen offset:3072 lds
    s_add_u32 s30, s30, 131072
    s_add_u32 m0, s29, 16384
    v_cvt_pk_bf16_f32 v192, v96, v97
    v_cvt_pk_bf16_f32 v193, v98, v99
    v_mov_b64 v[96:97], 0
    v_mov_b64 v[98:99], 0
    v_cvt_pk_bf16_f32 v194, v112, v113
    v_cvt_pk_bf16_f32 v195, v114, v115
    v_mov_b64 v[112:113], 0
    v_mov_b64 v[114:115], 0
    v_pk_mul_f32 v[100:101], v[100:101], v[242:243]
    v_pk_mul_f32 v[102:103], v[102:103], v[242:243]
    v_pk_mul_f32 v[116:117], v[116:117], v[242:243]
    v_pk_mul_f32 v[118:119], v[118:119], v[242:243]
    v_cvt_pk_bf16_f32 v196, v100, v101
    v_cvt_pk_bf16_f32 v197, v102, v103
    v_mov_b64 v[100:101], 0
    v_mov_b64 v[102:103], 0
    v_cvt_pk_bf16_f32 v198, v116, v117
    v_cvt_pk_bf16_f32 v199, v118, v119
    v_mov_b64 v[116:117], 0
    v_mov_b64 v[118:119], 0
    v_pk_mul_f32 v[104:105], v[104:105], v[244:245]
    v_pk_mul_f32 v[106:107], v[106:107], v[244:245]
    v_pk_mul_f32 v[120:121], v[120:121], v[244:245]
    v_pk_mul_f32 v[122:123], v[122:123], v[244:245]
    buffer_load_dwordx4 v10, s[20:23], s30 offen offset:0 lds
    buffer_load_dwordx4 v11, s[20:23], s30 offen offset:1024 lds
    buffer_load_dwordx4 v12, s[20:23], s30 offen offset:2048 lds
    v_cvt_pk_bf16_f32 v200, v104, v105
    v_cvt_pk_bf16_f32 v201, v106, v107
    v_mov_b64 v[104:105], 0
    v_mov_b64 v[106:107], 0
    v_cvt_pk_bf16_f32 v202, v120, v121
    v_cvt_pk_bf16_f32 v203, v122, v123
    v_mov_b64 v[120:121], 0
    v_mov_b64 v[122:123], 0
    v_pk_mul_f32 v[108:109], v[108:109], v[246:247]
    v_pk_mul_f32 v[110:111], v[110:111], v[246:247]
    v_pk_mul_f32 v[124:125], v[124:125], v[246:247]
    v_pk_mul_f32 v[126:127], v[126:127], v[246:247]
    v_cvt_pk_bf16_f32 v204, v108, v109
    v_cvt_pk_bf16_f32 v205, v110, v111
    v_mov_b64 v[108:109], 0
    v_mov_b64 v[110:111], 0
    v_cvt_pk_bf16_f32 v206, v124, v125
    v_cvt_pk_bf16_f32 v207, v126, v127
    v_mov_b64 v[124:125], 0
    v_mov_b64 v[126:127], 0
    v_pk_mul_f32 v[128:129], v[128:129], v[240:241]
    v_pk_mul_f32 v[130:131], v[130:131], v[240:241]
    v_pk_mul_f32 v[144:145], v[144:145], v[240:241]
    v_pk_mul_f32 v[146:147], v[146:147], v[240:241]
    buffer_load_dwordx4 v13, s[20:23], s30 offen offset:3072 lds
    s_add_u32 s30, s30, 131072
    v_cvt_pk_bf16_f32 v208, v128, v129
    v_cvt_pk_bf16_f32 v209, v130, v131
    v_mov_b64 v[128:129], 0
    v_mov_b64 v[130:131], 0
    v_cvt_pk_bf16_f32 v210, v144, v145
    v_cvt_pk_bf16_f32 v211, v146, v147
    v_mov_b64 v[144:145], 0
    v_mov_b64 v[146:147], 0
    v_pk_mul_f32 v[132:133], v[132:133], v[242:243]
    v_pk_mul_f32 v[134:135], v[134:135], v[242:243]
    v_pk_mul_f32 v[148:149], v[148:149], v[242:243]
    v_pk_mul_f32 v[150:151], v[150:151], v[242:243]
    v_cvt_pk_bf16_f32 v212, v132, v133
    v_cvt_pk_bf16_f32 v213, v134, v135
    v_mov_b64 v[132:133], 0
    v_mov_b64 v[134:135], 0
    v_cvt_pk_bf16_f32 v214, v148, v149
    v_cvt_pk_bf16_f32 v215, v150, v151
    v_mov_b64 v[148:149], 0
    v_mov_b64 v[150:151], 0
    v_pk_mul_f32 v[136:137], v[136:137], v[244:245]
    v_pk_mul_f32 v[138:139], v[138:139], v[244:245]
    v_pk_mul_f32 v[152:153], v[152:153], v[244:245]
    v_pk_mul_f32 v[154:155], v[154:155], v[244:245]
    v_cvt_pk_bf16_f32 v216, v136, v137
    v_cvt_pk_bf16_f32 v217, v138, v139
    v_mov_b64 v[136:137], 0
    v_mov_b64 v[138:139], 0
    v_cvt_pk_bf16_f32 v218, v152, v153
    v_cvt_pk_bf16_f32 v219, v154, v155
    v_mov_b64 v[152:153], 0
    v_mov_b64 v[154:155], 0
    v_pk_mul_f32 v[140:141], v[140:141], v[246:247]
    v_pk_mul_f32 v[142:143], v[142:143], v[246:247]
    v_pk_mul_f32 v[156:157], v[156:157], v[246:247]
    v_pk_mul_f32 v[158:159], v[158:159], v[246:247]
    v_cvt_pk_bf16_f32 v220, v140, v141
    v_cvt_pk_bf16_f32 v221, v142, v143
    v_mov_b64 v[140:141], 0
    v_mov_b64 v[142:143], 0
    v_cvt_pk_bf16_f32 v222, v156, v157
    v_cvt_pk_bf16_f32 v223, v158, v159
    v_mov_b64 v[156:157], 0
    v_mov_b64 v[158:159], 0
    s_waitcnt vmcnt(40)
    s_barrier
    ds_read_b64_tr_b16 a[128:129], v4 offset:0
    ds_read_b64_tr_b16 a[130:131], v4 offset:4096
    ds_read_b64_tr_b16 a[132:133], v4 offset:8192
    ds_read_b64_tr_b16 a[134:135], v4 offset:12288
    ds_read_b64_tr_b16 a[136:137], v5 offset:0
    ds_read_b64_tr_b16 a[138:139], v5 offset:4096
    ds_read_b64_tr_b16 a[140:141], v5 offset:8192
    ds_read_b64_tr_b16 a[142:143], v5 offset:12288
    ds_read_b64_tr_b16 a[144:145], v4 offset:256
    ds_read_b64_tr_b16 a[146:147], v4 offset:4352
    s_mov_b32 s32, s48
    s_mov_b32 s33, s49
    s_mov_b64 vcc, -1
    s_mov_b32 s24, s56
    s_and_b32 s25, s57, 0xffff
    s_mov_b32 s26, 4194304
    s_mov_b32 s27, 0x20000
    s_mov_b32 s12, s50
    s_nop 0
    s_and_b32 s13, s51, 0xffff
    s_mov_b32 s14, 4194304
    s_mov_b32 s15, 0x20000
    s_lshl_b32 s46, s59, 15
    s_lshl_b32 s62, s36, 8
    s_add_u32 s46, s46, s62
    s_lshl_b32 s62, s34, 6
    s_add_u32 s46, s46, s62
    s_nop 0
    s_add_u32 s47, s46, 32768
    s_add_u32 s48, s47, 32768
    s_add_u32 s49, s48, 32768
    v_and_b32 v22, 15, v0
    v_lshlrev_b32 v22, 11, v22
    v_lshrrev_b32_e64 v23, 4, v0
    v_lshl_add_u32 v21, v23, 3, v22
    v_lshl_add_u32 v22, v23, 4, v22
    s_lshl_b32 s62, s39, 3
    s_add_u32 s62, s62, s36
    s_lshl_b32 s62, s62, 2
    s_add_u32 s62, s62, s38
    s_lshl_b32 s45, s62, 8
    s_add_u32 s45, s45, 42008576
    s_lshl_b32 s44, s62, 18
    s_add_u32 s44, s44, 67108864
    s_lshl_b32 s62, s34, 2
    v_mov_b32_e64 v24, s62
    s_mov_b32 s41, 0
    s_mov_b32 s43, 41947136
    s_mov_b32 s53, 65365
L_g2:
    s_waitcnt vmcnt(25) lgkmcnt(6)
    v_mfma_f32_16x16x32_bf16 v[32:35], a[128:131], a[0:3], v[32:35]
    ds_read_b64_tr_b16 a[148:149], v4 offset:8448
    v_mfma_f32_16x16x32_bf16 v[32:35], a[132:135], a[16:19], v[32:35]
    ds_read_b64_tr_b16 a[150:151], v4 offset:12544
    v_mfma_f32_16x16x32_bf16 v[36:39], a[132:135], a[20:23], v[36:39]
    buffer_load_dwordx4 a[96:99], v14, s[8:11], s28 offen offset:0 sc1
    v_mfma_f32_16x16x32_bf16 v[36:39], a[128:131], a[4:7], v[36:39]
    v_mfma_f32_16x16x32_bf16 v[40:43], a[128:131], a[8:11], v[40:43]
    ds_read_b64_tr_b16 a[152:153], v5 offset:256
    v_mfma_f32_16x16x32_bf16 v[40:43], a[132:135], a[24:27], v[40:43]
    ds_read_b64_tr_b16 a[154:155], v5 offset:4352
    v_mfma_f32_16x16x32_bf16 v[44:47], a[132:135], a[28:31], v[44:47]
    buffer_load_dwordx4 a[100:103], v15, s[8:11], s28 offen offset:0 sc1
    v_mfma_f32_16x16x32_bf16 v[44:47], a[128:131], a[12:15], v[44:47]
    s_cmp_eq_u32 s41, 2
    s_cbranch_scc1 L_spw
L_spw_ret:
    s_waitcnt lgkmcnt(6)
    v_mfma_f32_16x16x32_bf16 v[48:51], a[136:139], a[0:3], v[48:51]
    ds_read_b64_tr_b16 a[156:157], v5 offset:8448
    v_mfma_f32_16x16x32_bf16 v[48:51], a[140:143], a[16:19], v[48:51]
    ds_read_b64_tr_b16 a[158:159], v5 offset:12544
    v_mfma_f32_16x16x32_bf16 v[52:55], a[140:143], a[20:23], v[52:55]
    buffer_load_dwordx4 a[104:107], v14, s[8:11], s52 offen offset:0 sc1
    v_mfma_f32_16x16x32_bf16 v[52:55], a[136:139], a[4:7], v[52:55]
    v_mfma_f32_16x16x32_bf16 v[56:59], a[136:139], a[8:11], v[56:59]
    ds_read_b64_tr_b16 a[128:129], v4 offset:512
    v_mfma_f32_16x16x32_bf16 v[56:59], a[140:143], a[24:27], v[56:59]
    ds_read_b64_tr_b16 a[130:131], v4 offset:4608
    v_mfma_f32_16x16x32_bf16 v[60:63], a[140:143], a[28:31], v[60:63]
    buffer_load_dwordx4 a[108:111], v15, s[8:11], s52 offen offset:0 sc1
    v_mfma_f32_16x16x32_bf16 v[60:63], a[136:139], a[12:15], v[60:63]
    s_add_u32 m0, s29, 32768
    s_barrier
    s_waitcnt lgkmcnt(6)
    v_mfma_f32_16x16x32_bf16 v[64:67], a[144:147], a[0:3], v[64:67]
    ds_read_b64_tr_b16 a[132:133], v4 offset:8704
    v_mfma_f32_16x16x32_bf16 v[64:67], a[148:151], a[16:19], v[64:67]
    ds_read_b64_tr_b16 a[134:135], v4 offset:12800
    v_mfma_f32_16x16x32_bf16 v[68:71], a[148:151], a[20:23], v[68:71]
    buffer_load_dwordx4 v10, s[20:23], s30 offen offset:0 lds
    v_mfma_f32_16x16x32_bf16 v[68:71], a[144:147], a[4:7], v[68:71]
    v_mfma_f32_16x16x32_bf16 v[72:75], a[144:147], a[8:11], v[72:75]
    ds_read_b64_tr_b16 a[136:137], v5 offset:512
    v_mfma_f32_16x16x32_bf16 v[72:75], a[148:151], a[24:27], v[72:75]
    ds_read_b64_tr_b16 a[138:139], v5 offset:4608
    v_mfma_f32_16x16x32_bf16 v[76:79], a[148:151], a[28:31], v[76:79]
    s_bitcmp1_b32 s53, 0
    s_cbranch_scc1 L_st00
L_st00_ret:
    v_mfma_f32_16x16x32_bf16 v[76:79], a[144:147], a[12:15], v[76:79]
    s_waitcnt lgkmcnt(6)
    v_mfma_f32_16x16x32_bf16 v[80:83], a[152:155], a[0:3], v[80:83]
    ds_read_b64_tr_b16 a[140:141], v5 offset:8704
    v_mfma_f32_16x16x32_bf16 v[80:83], a[156:159], a[16:19], v[80:83]
    ds_read_b64_tr_b16 a[142:143], v5 offset:12800
    v_mfma_f32_16x16x32_bf16 v[84:87], a[156:159], a[20:23], v[84:87]
    buffer_load_dwordx4 a[112:115], v14, s[8:11], s28 offen offset:1024 sc1
    v_mfma_f32_16x16x32_bf16 v[84:87], a[152:155], a[4:7], v[84:87]
    v_mfma_f32_16x16x32_bf16 v[88:91], a[152:155], a[8:11], v[88:91]
    ds_read_b64_tr_b16 a[144:145], v4 offset:768
    v_mfma_f32_16x16x32_bf16 v[88:91], a[156:159], a[24:27], v[88:91]
    ds_read_b64_tr_b16 a[146:147], v4 offset:4864
    v_mfma_f32_16x16x32_bf16 v[92:95], a[156:159], a[28:31], v[92:95]
    buffer_load_dwordx4 v11, s[20:23], s30 offen offset:1024 lds
    v_mfma_f32_16x16x32_bf16 v[92:95], a[152:155], a[12:15], v[92:95]
    s_waitcnt lgkmcnt(6)
    v_mfma_f32_16x16x32_bf16 v[96:99], a[128:131], a[0:3], v[96:99]
    ds_read_b64_tr_b16 a[148:149], v4 offset:8960
    v_mfma_f32_16x16x32_bf16 v[96:99], a[132:135], a[16:19], v[96:99]
    ds_read_b64_tr_b16 a[150:151], v4 offset:13056
    v_mfma_f32_16x16x32_bf16 v[100:103], a[132:135], a[20:23], v[100:103]
    s_bitcmp1_b32 s53, 1
    s_cbranch_scc1 L_st01
L_st01_ret:
    v_mfma_f32_16x16x32_bf16 v[100:103], a[128:131], a[4:7], v[100:103]
    v_mfma_f32_16x16x32_bf16 v[104:107], a[128:131], a[8:11], v[104:107]
    ds_read_b64_tr_b16 a[152:153], v5 offset:768
    v_mfma_f32_16x16x32_bf16 v[104:107], a[132:135], a[24:27], v[104:107]
    ds_read_b64_tr_b16 a[154:155], v5 offset:4864
    v_mfma_f32_16x16x32_bf16 v[108:111], a[132:135], a[28:31], v[108:111]
    buffer_load_dwordx4 a[116:119], v15, s[8:11], s28 offen offset:1024 sc1
    v_mfma_f32_16x16x32_bf16 v[108:111], a[128:131], a[12:15], v[108:111]
    s_waitcnt lgkmcnt(6)
    v_mfma_f32_16x16x32_bf16 v[112:115], a[136:139], a[0:3], v[112:115]
    ds_read_b64_tr_b16 a[156:157], v5 offset:8960
    v_mfma_f32_16x16x32_bf16 v[112:115], a[140:143], a[16:19], v[112:115]
    ds_read_b64_tr_b16 a[158:159], v5 offset:13056
    v_mfma_f32_16x16x32_bf16 v[116:119], a[140:143], a[20:23], v[116:119]
    buffer_load_dwordx4 v12, s[20:23], s30 offen offset:2048 lds
    v_mfma_f32_16x16x32_bf16 v[116:119], a[136:139], a[4:7], v[116:119]
    v_mfma_f32_16x16x32_bf16 v[120:123], a[136:139], a[8:11], v[120:123]
    ds_read_b64_tr_b16 a[128:129], v4 offset:16384
    v_mfma_f32_16x16x32_bf16 v[120:123], a[140:143], a[24:27], v[120:123]
    ds_read_b64_tr_b16 a[130:131], v4 offset:20480
    v_mfma_f32_16x16x32_bf16 v[124:127], a[140:143], a[28:31], v[124:127]
    s_bitcmp1_b32 s53, 2
    s_cbranch_scc1 L_st02
L_st02_ret:
    v_mfma_f32_16x16x32_bf16 v[124:127], a[136:139], a[12:15], v[124:127]
    s_waitcnt lgkmcnt(6)
    v_mfma_f32_16x16x32_bf16 v[128:131], a[144:147], a[0:3], v[128:131]
    ds_read_b64_tr_b16 a[132:133], v4 offset:24576
    v_mfma_f32_16x16x32_bf16 v[128:131], a[148:151], a[16:19], v[128:131]
    ds_read_b64_tr_b16 a[134:135], v4 offset:28672
    v_mfma_f32_16x16x32_bf16 v[132:135], a[148:151], a[20:23], v[132:135]
    buffer_load_dwordx4 a[120:123], v14, s[8:11], s52 offen offset:1024 sc1
    v_mfma_f32_16x16x32_bf16 v[132:135], a[144:147], a[4:7], v[132:135]
    v_mfma_f32_16x16x32_bf16 v[136:139], a[144:147], a[8:11], v[136:139]
    ds_read_b64_tr_b16 a[136:137], v5 offset:16384
    v_mfma_f32_16x16x32_bf16 v[136:139], a[148:151], a[24:27], v[136:139]
    ds_read_b64_tr_b16 a[138:139], v5 offset:20480
    v_mfma_f32_16x16x32_bf16 v[140:143], a[148:151], a[28:31], v[140:143]
    buffer_load_dwordx4 v13, s[20:23], s30 offen offset:3072 lds
    v_mfma_f32_16x16x32_bf16 v[140:143], a[144:147], a[12:15], v[140:143]
    s_waitcnt lgkmcnt(6)
    v_mfma_f32_16x16x32_bf16 v[144:147], a[152:155], a[0:3], v[144:147]
    ds_read_b64_tr_b16 a[140:141], v5 offset:24576
    v_mfma_f32_16x16x32_bf16 v[144:147], a[156:159], a[16:19], v[144:147]
    ds_read_b64_tr_b16 a[142:143], v5 offset:28672
    v_mfma_f32_16x16x32_bf16 v[148:151], a[156:159], a[20:23], v[148:151]
    s_add_u32 s30, s30, 131072
    s_bitcmp1_b32 s53, 3
    s_cbranch_scc1 L_st03
L_st03_ret:
    v_mfma_f32_16x16x32_bf16 v[148:151], a[152:155], a[4:7], v[148:151]
    v_mfma_f32_16x16x32_bf16 v[152:155], a[152:155], a[8:11], v[152:155]
    ds_read_b64_tr_b16 a[144:145], v4 offset:16640
    v_mfma_f32_16x16x32_bf16 v[152:155], a[156:159], a[24:27], v[152:155]
    ds_read_b64_tr_b16 a[146:147], v4 offset:20736
    v_mfma_f32_16x16x32_bf16 v[156:159], a[156:159], a[28:31], v[156:159]
    buffer_load_dwordx4 a[124:127], v15, s[8:11], s52 offen offset:1024 sc1
    v_mfma_f32_16x16x32_bf16 v[156:159], a[152:155], a[12:15], v[156:159]
    s_add_u32 s28, s28, 2048
    s_add_u32 s52, s52, 2048
    s_cmp_eq_u32 s41, 9
    s_cbranch_scc1 L_sp1
L_sp1_ret:
    s_waitcnt vmcnt(24) lgkmcnt(6)
    v_mfma_f32_16x16x32_bf16 v[32:35], a[128:131], a[32:35], v[32:35]
    ds_read_b64_tr_b16 a[148:149], v4 offset:24832
    v_mfma_f32_16x16x32_bf16 v[32:35], a[132:135], a[48:51], v[32:35]
    ds_read_b64_tr_b16 a[150:151], v4 offset:28928
    v_mfma_f32_16x16x32_bf16 v[36:39], a[132:135], a[52:55], v[36:39]
    buffer_load_dwordx4 a[0:3], v14, s[8:11], s28 offen offset:0 sc1
    v_mfma_f32_16x16x32_bf16 v[36:39], a[128:131], a[36:39], v[36:39]
    v_mfma_f32_16x16x32_bf16 v[40:43], a[128:131], a[40:43], v[40:43]
    ds_read_b64_tr_b16 a[152:153], v5 offset:16640
    v_mfma_f32_16x16x32_bf16 v[40:43], a[132:135], a[56:59], v[40:43]
    ds_read_b64_tr_b16 a[154:155], v5 offset:20736
    v_mfma_f32_16x16x32_bf16 v[44:47], a[132:135], a[60:63], v[44:47]
    buffer_load_dwordx4 a[4:7], v15, s[8:11], s28 offen offset:0 sc1
    v_mfma_f32_16x16x32_bf16 v[44:47], a[128:131], a[44:47], v[44:47]
    s_waitcnt lgkmcnt(6)
    v_mfma_f32_16x16x32_bf16 v[48:51], a[136:139], a[32:35], v[48:51]
    ds_read_b64_tr_b16 a[156:157], v5 offset:24832
    v_mfma_f32_16x16x32_bf16 v[48:51], a[140:143], a[48:51], v[48:51]
    ds_read_b64_tr_b16 a[158:159], v5 offset:28928
    v_mfma_f32_16x16x32_bf16 v[52:55], a[140:143], a[52:55], v[52:55]
    buffer_load_dwordx4 a[8:11], v14, s[8:11], s52 offen offset:0 sc1
    v_mfma_f32_16x16x32_bf16 v[52:55], a[136:139], a[36:39], v[52:55]
    v_mfma_f32_16x16x32_bf16 v[56:59], a[136:139], a[40:43], v[56:59]
    ds_read_b64_tr_b16 a[128:129], v4 offset:16896
    v_mfma_f32_16x16x32_bf16 v[56:59], a[140:143], a[56:59], v[56:59]
    ds_read_b64_tr_b16 a[130:131], v4 offset:20992
    v_mfma_f32_16x16x32_bf16 v[60:63], a[140:143], a[60:63], v[60:63]
    buffer_load_dwordx4 a[12:15], v15, s[8:11], s52 offen offset:0 sc1
    v_mfma_f32_16x16x32_bf16 v[60:63], a[136:139], a[44:47], v[60:63]
    s_add_u32 m0, s29, 49152
    s_waitcnt lgkmcnt(6)
    v_mfma_f32_16x16x32_bf16 v[64:67], a[144:147], a[32:35], v[64:67]
    ds_read_b64_tr_b16 a[132:133], v4 offset:25088
    v_mfma_f32_16x16x32_bf16 v[64:67], a[148:151], a[48:51], v[64:67]
    ds_read_b64_tr_b16 a[134:135], v4 offset:29184
    v_mfma_f32_16x16x32_bf16 v[68:71], a[148:151], a[52:55], v[68:71]
    buffer_load_dwordx4 v10, s[20:23], s30 offen offset:0 lds
    v_mfma_f32_16x16x32_bf16 v[68:71], a[144:147], a[36:39], v[68:71]
    v_mfma_f32_16x16x32_bf16 v[72:75], a[144:147], a[40:43], v[72:75]
    ds_read_b64_tr_b16 a[136:137], v5 offset:16896
    v_mfma_f32_16x16x32_bf16 v[72:75], a[148:151], a[56:59], v[72:75]
    ds_read_b64_tr_b16 a[138:139], v5 offset:20992
    v_mfma_f32_16x16x32_bf16 v[76:79], a[148:151], a[60:63], v[76:79]
    s_bitcmp1_b32 s53, 4
    s_cbranch_scc1 L_st10
L_st10_ret:
    v_mfma_f32_16x16x32_bf16 v[76:79], a[144:147], a[44:47], v[76:79]
    s_waitcnt lgkmcnt(6)
    v_mfma_f32_16x16x32_bf16 v[80:83], a[152:155], a[32:35], v[80:83]
    ds_read_b64_tr_b16 a[140:141], v5 offset:25088
    v_mfma_f32_16x16x32_bf16 v[80:83], a[156:159], a[48:51], v[80:83]
    ds_read_b64_tr_b16 a[142:143], v5 offset:29184
    v_mfma_f32_16x16x32_bf16 v[84:87], a[156:159], a[52:55], v[84:87]
    buffer_load_dwordx4 a[16:19], v14, s[8:11], s28 offen offset:1024 sc1
    v_mfma_f32_16x16x32_bf16 v[84:87], a[152:155], a[36:39], v[84:87]
    v_mfma_f32_16x16x32_bf16 v[88:91], a[152:155], a[40:43], v[88:91]
    ds_read_b64_tr_b16 a[144:145], v4 offset:17152
    v_mfma_f32_16x16x32_bf16 v[88:91], a[156:159], a[56:59], v[88:91]
    ds_read_b64_tr_b16 a[146:147], v4 offset:21248
    v_mfma_f32_16x16x32_bf16 v[92:95], a[156:159], a[60:63], v[92:95]
    buffer_load_dwordx4 v11, s[20:23], s30 offen offset:1024 lds
    v_mfma_f32_16x16x32_bf16 v[92:95], a[152:155], a[44:47], v[92:95]
    s_waitcnt lgkmcnt(6)
    v_mfma_f32_16x16x32_bf16 v[96:99], a[128:131], a[32:35], v[96:99]
    ds_read_b64_tr_b16 a[148:149], v4 offset:25344
    v_mfma_f32_16x16x32_bf16 v[96:99], a[132:135], a[48:51], v[96:99]
    ds_read_b64_tr_b16 a[150:151], v4 offset:29440
    v_mfma_f32_16x16x32_bf16 v[100:103], a[132:135], a[52:55], v[100:103]
    s_bitcmp1_b32 s53, 5
    s_cbranch_scc1 L_st11
L_st11_ret:
    v_mfma_f32_16x16x32_bf16 v[100:103], a[128:131], a[36:39], v[100:103]
    v_mfma_f32_16x16x32_bf16 v[104:107], a[128:131], a[40:43], v[104:107]
    ds_read_b64_tr_b16 a[152:153], v5 offset:17152
    v_mfma_f32_16x16x32_bf16 v[104:107], a[132:135], a[56:59], v[104:107]
    ds_read_b64_tr_b16 a[154:155], v5 offset:21248
    v_mfma_f32_16x16x32_bf16 v[108:111], a[132:135], a[60:63], v[108:111]
    buffer_load_dwordx4 a[20:23], v15, s[8:11], s28 offen offset:1024 sc1
    v_mfma_f32_16x16x32_bf16 v[108:111], a[128:131], a[44:47], v[108:111]
    s_waitcnt lgkmcnt(6)
    v_mfma_f32_16x16x32_bf16 v[112:115], a[136:139], a[32:35], v[112:115]
    ds_read_b64_tr_b16 a[156:157], v5 offset:25344
    v_mfma_f32_16x16x32_bf16 v[112:115], a[140:143], a[48:51], v[112:115]
    ds_read_b64_tr_b16 a[158:159], v5 offset:29440
    v_mfma_f32_16x16x32_bf16 v[116:119], a[140:143], a[52:55], v[116:119]
    buffer_load_dwordx4 v12, s[20:23], s30 offen offset:2048 lds
    v_mfma_f32_16x16x32_bf16 v[116:119], a[136:139], a[36:39], v[116:119]
    v_mfma_f32_16x16x32_bf16 v[120:123], a[136:139], a[40:43], v[120:123]
    ds_read_b64_tr_b16 a[128:129], v4 offset:32768
    v_mfma_f32_16x16x32_bf16 v[120:123], a[140:143], a[56:59], v[120:123]
    ds_read_b64_tr_b16 a[130:131], v4 offset:36864
    v_mfma_f32_16x16x32_bf16 v[124:127], a[140:143], a[60:63], v[124:127]
    s_bitcmp1_b32 s53, 6
    s_cbranch_scc1 L_st12
L_st12_ret:
    v_mfma_f32_16x16x32_bf16 v[124:127], a[136:139], a[44:47], v[124:127]
    s_waitcnt lgkmcnt(6)
    v_mfma_f32_16x16x32_bf16 v[128:131], a[144:147], a[32:35], v[128:131]
    ds_read_b64_tr_b16 a[132:133], v4 offset:40960
    v_mfma_f32_16x16x32_bf16 v[128:131], a[148:151], a[48:51], v[128:131]
    ds_read_b64_tr_b16 a[134:135], v4 offset:45056
    v_mfma_f32_16x16x32_bf16 v[132:135], a[148:151], a[52:55], v[132:135]
    buffer_load_dwordx4 a[24:27], v14, s[8:11], s52 offen offset:1024 sc1
    v_mfma_f32_16x16x32_bf16 v[132:135], a[144:147], a[36:39], v[132:135]
    v_mfma_f32_16x16x32_bf16 v[136:139], a[144:147], a[40:43], v[136:139]
    ds_read_b64_tr_b16 a[136:137], v5 offset:32768
    v_mfma_f32_16x16x32_bf16 v[136:139], a[148:151], a[56:59], v[136:139]
    ds_read_b64_tr_b16 a[138:139], v5 offset:36864
    v_mfma_f32_16x16x32_bf16 v[140:143], a[148:151], a[60:63], v[140:143]
    buffer_load_dwordx4 v13, s[20:23], s30 offen offset:3072 lds
    v_mfma_f32_16x16x32_bf16 v[140:143], a[144:147], a[44:47], v[140:143]
    s_waitcnt lgkmcnt(6)
    v_mfma_f32_16x16x32_bf16 v[144:147], a[152:155], a[32:35], v[144:147]
    ds_read_b64_tr_b16 a[140:141], v5 offset:40960
    v_mfma_f32_16x16x32_bf16 v[144:147], a[156:159], a[48:51], v[144:147]
    ds_read_b64_tr_b16 a[142:143], v5 offset:45056
    v_mfma_f32_16x16x32_bf16 v[148:151], a[156:159], a[52:55], v[148:151]
    s_add_u32 s30, s30, 131072
    s_bitcmp1_b32 s53, 7
    s_cbranch_scc1 L_st13
L_st13_ret:
    v_mfma_f32_16x16x32_bf16 v[148:151], a[152:155], a[36:39], v[148:151]
    v_mfma_f32_16x16x32_bf16 v[152:155], a[152:155], a[40:43], v[152:155]
    ds_read_b64_tr_b16 a[144:145], v4 offset:33024
    v_mfma_f32_16x16x32_bf16 v[152:155], a[156:159], a[56:59], v[152:155]
    ds_read_b64_tr_b16 a[146:147], v4 offset:37120
    v_mfma_f32_16x16x32_bf16 v[156:159], a[156:159], a[60:63], v[156:159]
    buffer_load_dwordx4 a[28:31], v15, s[8:11], s52 offen offset:1024 sc1
    v_mfma_f32_16x16x32_bf16 v[156:159], a[152:155], a[44:47], v[156:159]
    s_add_u32 s28, s28, 2048
    s_add_u32 s52, s52, 2048
    s_cmp_eq_u32 s41, 3
    s_cbranch_scc1 L_switch
L_switch_ret:
    s_waitcnt vmcnt(24) lgkmcnt(6)
    v_mfma_f32_16x16x32_bf16 v[32:35], a[128:131], a[64:67], v[32:35]
    ds_read_b64_tr_b16 a[148:149], v4 offset:41216
    v_mfma_f32_16x16x32_bf16 v[32:35], a[132:135], a[80:83], v[32:35]
    ds_read_b64_tr_b16 a[150:151], v4 offset:45312
    v_mfma_f32_16x16x32_bf16 v[36:39], a[132:135], a[84:87], v[36:39]
    buffer_load_dwordx4 a[32:35], v14, s[8:11], s28 offen offset:0 sc1
    buffer_load_dword v19, v18, s[8:11], s43 offen sc1
    v_mfma_f32_16x16x32_bf16 v[36:39], a[128:131], a[68:71], v[36:39]
    v_mfma_f32_16x16x32_bf16 v[40:43], a[128:131], a[72:75], v[40:43]
    ds_read_b64_tr_b16 a[152:153], v5 offset:33024
    v_mfma_f32_16x16x32_bf16 v[40:43], a[132:135], a[88:91], v[40:43]
    ds_read_b64_tr_b16 a[154:155], v5 offset:37120
    v_mfma_f32_16x16x32_bf16 v[44:47], a[132:135], a[92:95], v[44:47]
    buffer_load_dwordx4 a[36:39], v15, s[8:11], s28 offen offset:0 sc1
    v_mfma_f32_16x16x32_bf16 v[44:47], a[128:131], a[76:79], v[44:47]
    s_waitcnt lgkmcnt(6)
    v_mfma_f32_16x16x32_bf16 v[48:51], a[136:139], a[64:67], v[48:51]
    ds_read_b64_tr_b16 a[156:157], v5 offset:41216
    v_mfma_f32_16x16x32_bf16 v[48:51], a[140:143], a[80:83], v[48:51]
    ds_read_b64_tr_b16 a[158:159], v5 offset:45312
    v_mfma_f32_16x16x32_bf16 v[52:55], a[140:143], a[84:87], v[52:55]
    buffer_load_dwordx4 a[40:43], v14, s[8:11], s52 offen offset:0 sc1
    v_mfma_f32_16x16x32_bf16 v[52:55], a[136:139], a[68:71], v[52:55]
    v_mfma_f32_16x16x32_bf16 v[56:59], a[136:139], a[72:75], v[56:59]
    ds_read_b64_tr_b16 a[128:129], v4 offset:33280
    v_mfma_f32_16x16x32_bf16 v[56:59], a[140:143], a[88:91], v[56:59]
    ds_read_b64_tr_b16 a[130:131], v4 offset:37376
    v_mfma_f32_16x16x32_bf16 v[60:63], a[140:143], a[92:95], v[60:63]
    buffer_load_dwordx4 a[44:47], v15, s[8:11], s52 offen offset:0 sc1
    v_mfma_f32_16x16x32_bf16 v[60:63], a[136:139], a[76:79], v[60:63]
    s_add_u32 m0, s35, 0
    s_waitcnt vmcnt(33)
    s_barrier
    s_waitcnt lgkmcnt(6)
    v_mfma_f32_16x16x32_bf16 v[64:67], a[144:147], a[64:67], v[64:67]
    ds_read_b64_tr_b16 a[132:133], v4 offset:41472
    v_mfma_f32_16x16x32_bf16 v[64:67], a[148:151], a[80:83], v[64:67]
    ds_read_b64_tr_b16 a[134:135], v4 offset:45568
    v_mfma_f32_16x16x32_bf16 v[68:71], a[148:151], a[84:87], v[68:71]
    buffer_load_dwordx4 v10, s[20:23], s30 offen offset:0 lds
    v_mfma_f32_16x16x32_bf16 v[68:71], a[144:147], a[68:71], v[68:71]
    v_mfma_f32_16x16x32_bf16 v[72:75], a[144:147], a[72:75], v[72:75]
    ds_read_b64_tr_b16 a[136:137], v5 offset:33280
    v_mfma_f32_16x16x32_bf16 v[72:75], a[148:151], a[88:91], v[72:75]
    ds_read_b64_tr_b16 a[138:139], v5 offset:37376
    v_mfma_f32_16x16x32_bf16 v[76:79], a[148:151], a[92:95], v[76:79]
    s_bitcmp1_b32 s53, 8
    s_cbranch_scc1 L_st20
L_st20_ret:
    v_mfma_f32_16x16x32_bf16 v[76:79], a[144:147], a[76:79], v[76:79]
    s_waitcnt lgkmcnt(6)
    v_mfma_f32_16x16x32_bf16 v[80:83], a[152:155], a[64:67], v[80:83]
    ds_read_b64_tr_b16 a[140:141], v5 offset:41472
    v_mfma_f32_16x16x32_bf16 v[80:83], a[156:159], a[80:83], v[80:83]
    ds_read_b64_tr_b16 a[142:143], v5 offset:45568
    v_mfma_f32_16x16x32_bf16 v[84:87], a[156:159], a[84:87], v[84:87]
    buffer_load_dwordx4 a[48:51], v14, s[8:11], s28 offen offset:1024 sc1
    v_mfma_f32_16x16x32_bf16 v[84:87], a[152:155], a[68:71], v[84:87]
    v_mfma_f32_16x16x32_bf16 v[88:91], a[152:155], a[72:75], v[88:91]
    ds_read_b64_tr_b16 a[144:145], v4 offset:33536
    v_mfma_f32_16x16x32_bf16 v[88:91], a[156:159], a[88:91], v[88:91]
    ds_read_b64_tr_b16 a[146:147], v4 offset:37632
    v_mfma_f32_16x16x32_bf16 v[92:95], a[156:159], a[92:95], v[92:95]
    buffer_load_dwordx4 v11, s[20:23], s30 offen offset:1024 lds
    v_mfma_f32_16x16x32_bf16 v[92:95], a[152:155], a[76:79], v[92:95]
    s_waitcnt lgkmcnt(6)
    v_mfma_f32_16x16x32_bf16 v[96:99], a[128:131], a[64:67], v[96:99]
    ds_read_b64_tr_b16 a[148:149], v4 offset:41728
    v_mfma_f32_16x16x32_bf16 v[96:99], a[132:135], a[80:83], v[96:99]
    ds_read_b64_tr_b16 a[150:151], v4 offset:45824
    v_mfma_f32_16x16x32_bf16 v[100:103], a[132:135], a[84:87], v[100:103]
    s_bitcmp1_b32 s53, 9
    s_cbranch_scc1 L_st21
L_st21_ret:
    v_mfma_f32_16x16x32_bf16 v[100:103], a[128:131], a[68:71], v[100:103]
    v_mfma_f32_16x16x32_bf16 v[104:107], a[128:131], a[72:75], v[104:107]
    ds_read_b64_tr_b16 a[152:153], v5 offset:33536
    v_mfma_f32_16x16x32_bf16 v[104:107], a[132:135], a[88:91], v[104:107]
    ds_read_b64_tr_b16 a[154:155], v5 offset:37632
    v_mfma_f32_16x16x32_bf16 v[108:111], a[132:135], a[92:95], v[108:111]
    buffer_load_dwordx4 a[52:55], v15, s[8:11], s28 offen offset:1024 sc1
    v_mfma_f32_16x16x32_bf16 v[108:111], a[128:131], a[76:79], v[108:111]
    s_waitcnt lgkmcnt(6)
    v_mfma_f32_16x16x32_bf16 v[112:115], a[136:139], a[64:67], v[112:115]
    ds_read_b64_tr_b16 a[156:157], v5 offset:41728
    v_mfma_f32_16x16x32_bf16 v[112:115], a[140:143], a[80:83], v[112:115]
    ds_read_b64_tr_b16 a[158:159], v5 offset:45824
    v_mfma_f32_16x16x32_bf16 v[116:119], a[140:143], a[84:87], v[116:119]
    buffer_load_dwordx4 v12, s[20:23], s30 offen offset:2048 lds
    v_mfma_f32_16x16x32_bf16 v[116:119], a[136:139], a[68:71], v[116:119]
    v_mfma_f32_16x16x32_bf16 v[120:123], a[136:139], a[72:75], v[120:123]
    ds_read_b64_tr_b16 a[128:129], v4 offset:49152
    v_mfma_f32_16x16x32_bf16 v[120:123], a[140:143], a[88:91], v[120:123]
    ds_read_b64_tr_b16 a[130:131], v4 offset:53248
    v_mfma_f32_16x16x32_bf16 v[124:127], a[140:143], a[92:95], v[124:127]
    s_bitcmp1_b32 s53, 10
    s_cbranch_scc1 L_st22
L_st22_ret:
    v_mfma_f32_16x16x32_bf16 v[124:127], a[136:139], a[76:79], v[124:127]
    s_waitcnt lgkmcnt(6)
    v_mfma_f32_16x16x32_bf16 v[128:131], a[144:147], a[64:67], v[128:131]
    ds_read_b64_tr_b16 a[132:133], v4 offset:57344
    v_mfma_f32_16x16x32_bf16 v[128:131], a[148:151], a[80:83], v[128:131]
    ds_read_b64_tr_b16 a[134:135], v4 offset:61440
    v_mfma_f32_16x16x32_bf16 v[132:135], a[148:151], a[84:87], v[132:135]
    buffer_load_dwordx4 a[56:59], v14, s[8:11], s52 offen offset:1024 sc1
    v_mfma_f32_16x16x32_bf16 v[132:135], a[144:147], a[68:71], v[132:135]
    v_mfma_f32_16x16x32_bf16 v[136:139], a[144:147], a[72:75], v[136:139]
    ds_read_b64_tr_b16 a[136:137], v5 offset:49152
    v_mfma_f32_16x16x32_bf16 v[136:139], a[148:151], a[88:91], v[136:139]
    ds_read_b64_tr_b16 a[138:139], v5 offset:53248
    v_mfma_f32_16x16x32_bf16 v[140:143], a[148:151], a[92:95], v[140:143]
    buffer_load_dwordx4 v13, s[20:23], s30 offen offset:3072 lds
    v_mfma_f32_16x16x32_bf16 v[140:143], a[144:147], a[76:79], v[140:143]
    s_waitcnt lgkmcnt(6)
    v_mfma_f32_16x16x32_bf16 v[144:147], a[152:155], a[64:67], v[144:147]
    ds_read_b64_tr_b16 a[140:141], v5 offset:57344
    v_mfma_f32_16x16x32_bf16 v[144:147], a[156:159], a[80:83], v[144:147]
    ds_read_b64_tr_b16 a[142:143], v5 offset:61440
    v_mfma_f32_16x16x32_bf16 v[148:151], a[156:159], a[84:87], v[148:151]
    s_add_u32 s30, s30, 131072
    s_bitcmp1_b32 s53, 11
    s_cbranch_scc1 L_st23
L_st23_ret:
    v_mfma_f32_16x16x32_bf16 v[148:151], a[152:155], a[68:71], v[148:151]
    v_mfma_f32_16x16x32_bf16 v[152:155], a[152:155], a[72:75], v[152:155]
    ds_read_b64_tr_b16 a[144:145], v4 offset:49408
    v_mfma_f32_16x16x32_bf16 v[152:155], a[156:159], a[88:91], v[152:155]
    ds_read_b64_tr_b16 a[146:147], v4 offset:53504
    v_mfma_f32_16x16x32_bf16 v[156:159], a[156:159], a[92:95], v[156:159]
    buffer_load_dwordx4 a[60:63], v15, s[8:11], s52 offen offset:1024 sc1
    v_mfma_f32_16x16x32_bf16 v[156:159], a[152:155], a[76:79], v[156:159]
    s_add_u32 s28, s28, 2048
    s_add_u32 s52, s52, 2048
    s_waitcnt vmcnt(11)
    s_cmp_lt_u32 s41, 5
    s_cbranch_scc1 L_special
L_special_ret:
    s_waitcnt lgkmcnt(6)
    v_mfma_f32_16x16x32_bf16 v[32:35], a[128:131], a[96:99], v[32:35]
    ds_read_b64_tr_b16 a[148:149], v4 offset:57600
    v_mfma_f32_16x16x32_bf16 v[32:35], a[132:135], a[112:115], v[32:35]
    ds_read_b64_tr_b16 a[150:151], v4 offset:61696
    v_mfma_f32_16x16x32_bf16 v[36:39], a[132:135], a[116:119], v[36:39]
    buffer_load_dwordx4 a[64:67], v14, s[8:11], s28 offen offset:0 sc1
    v_mfma_f32_16x16x32_bf16 v[36:39], a[128:131], a[100:103], v[36:39]
    v_mfma_f32_16x16x32_bf16 v[40:43], a[128:131], a[104:107], v[40:43]
    ds_read_b64_tr_b16 a[152:153], v5 offset:49408
    v_mfma_f32_16x16x32_bf16 v[40:43], a[132:135], a[120:123], v[40:43]
    ds_read_b64_tr_b16 a[154:155], v5 offset:53504
    v_mfma_f32_16x16x32_bf16 v[44:47], a[132:135], a[124:127], v[44:47]
    buffer_load_dwordx4 a[68:71], v15, s[8:11], s28 offen offset:0 sc1
    v_mfma_f32_16x16x32_bf16 v[44:47], a[128:131], a[108:111], v[44:47]
    s_waitcnt lgkmcnt(6)
    v_mfma_f32_16x16x32_bf16 v[48:51], a[136:139], a[96:99], v[48:51]
    ds_read_b64_tr_b16 a[156:157], v5 offset:57600
    v_mfma_f32_16x16x32_bf16 v[48:51], a[140:143], a[112:115], v[48:51]
    ds_read_b64_tr_b16 a[158:159], v5 offset:61696
    v_mfma_f32_16x16x32_bf16 v[52:55], a[140:143], a[116:119], v[52:55]
    buffer_load_dwordx4 a[72:75], v14, s[8:11], s52 offen offset:0 sc1
    v_mfma_f32_16x16x32_bf16 v[52:55], a[136:139], a[100:103], v[52:55]
    v_mfma_f32_16x16x32_bf16 v[56:59], a[136:139], a[104:107], v[56:59]
    ds_read_b64_tr_b16 a[128:129], v4 offset:49664
    v_mfma_f32_16x16x32_bf16 v[56:59], a[140:143], a[120:123], v[56:59]
    ds_read_b64_tr_b16 a[130:131], v4 offset:53760
    v_mfma_f32_16x16x32_bf16 v[60:63], a[140:143], a[124:127], v[60:63]
    buffer_load_dwordx4 a[76:79], v15, s[8:11], s52 offen offset:0 sc1
    v_mfma_f32_16x16x32_bf16 v[60:63], a[136:139], a[108:111], v[60:63]
    s_add_u32 m0, s35, 16384
    s_waitcnt lgkmcnt(6)
    v_mfma_f32_16x16x32_bf16 v[64:67], a[144:147], a[96:99], v[64:67]
    ds_read_b64_tr_b16 a[132:133], v4 offset:57856
    v_mfma_f32_16x16x32_bf16 v[64:67], a[148:151], a[112:115], v[64:67]
    ds_read_b64_tr_b16 a[134:135], v4 offset:61952
    v_mfma_f32_16x16x32_bf16 v[68:71], a[148:151], a[116:119], v[68:71]
    buffer_load_dwordx4 v10, s[20:23], s30 offen offset:0 lds
    v_mfma_f32_16x16x32_bf16 v[68:71], a[144:147], a[100:103], v[68:71]
    v_mfma_f32_16x16x32_bf16 v[72:75], a[144:147], a[104:107], v[72:75]
    ds_read_b64_tr_b16 a[136:137], v5 offset:49664
    v_mfma_f32_16x16x32_bf16 v[72:75], a[148:151], a[120:123], v[72:75]
    ds_read_b64_tr_b16 a[138:139], v5 offset:53760
    v_mfma_f32_16x16x32_bf16 v[76:79], a[148:151], a[124:127], v[76:79]
    s_bitcmp1_b32 s53, 12
    s_cbranch_scc1 L_st30
L_st30_ret:
    v_mfma_f32_16x16x32_bf16 v[76:79], a[144:147], a[108:111], v[76:79]
    s_waitcnt lgkmcnt(6)
    v_mfma_f32_16x16x32_bf16 v[80:83], a[152:155], a[96:99], v[80:83]
    ds_read_b64_tr_b16 a[140:141], v5 offset:57856
    v_mfma_f32_16x16x32_bf16 v[80:83], a[156:159], a[112:115], v[80:83]
    ds_read_b64_tr_b16 a[142:143], v5 offset:61952
    v_mfma_f32_16x16x32_bf16 v[84:87], a[156:159], a[116:119], v[84:87]
    buffer_load_dwordx4 a[80:83], v14, s[8:11], s28 offen offset:1024 sc1
    v_mfma_f32_16x16x32_bf16 v[84:87], a[152:155], a[100:103], v[84:87]
    v_mfma_f32_16x16x32_bf16 v[88:91], a[152:155], a[104:107], v[88:91]
    ds_read_b64_tr_b16 a[144:145], v4 offset:49920
    v_mfma_f32_16x16x32_bf16 v[88:91], a[156:159], a[120:123], v[88:91]
    ds_read_b64_tr_b16 a[146:147], v4 offset:54016
    v_mfma_f32_16x16x32_bf16 v[92:95], a[156:159], a[124:127], v[92:95]
    buffer_load_dwordx4 v11, s[20:23], s30 offen offset:1024 lds
    v_mfma_f32_16x16x32_bf16 v[92:95], a[152:155], a[108:111], v[92:95]
    s_waitcnt lgkmcnt(6)
    v_mfma_f32_16x16x32_bf16 v[96:99], a[128:131], a[96:99], v[96:99]
    ds_read_b64_tr_b16 a[148:149], v4 offset:58112
    v_mfma_f32_16x16x32_bf16 v[96:99], a[132:135], a[112:115], v[96:99]
    ds_read_b64_tr_b16 a[150:151], v4 offset:62208
    v_mfma_f32_16x16x32_bf16 v[100:103], a[132:135], a[116:119], v[100:103]
    s_bitcmp1_b32 s53, 13
    s_cbranch_scc1 L_st31
L_st31_ret:
    v_mfma_f32_16x16x32_bf16 v[100:103], a[128:131], a[100:103], v[100:103]
    v_mfma_f32_16x16x32_bf16 v[104:107], a[128:131], a[104:107], v[104:107]
    ds_read_b64_tr_b16 a[152:153], v5 offset:49920
    v_mfma_f32_16x16x32_bf16 v[104:107], a[132:135], a[120:123], v[104:107]
    ds_read_b64_tr_b16 a[154:155], v5 offset:54016
    v_mfma_f32_16x16x32_bf16 v[108:111], a[132:135], a[124:127], v[108:111]
    buffer_load_dwordx4 a[84:87], v15, s[8:11], s28 offen offset:1024 sc1
    v_xor_b32 v4, 0x10000, v4
    v_mfma_f32_16x16x32_bf16 v[108:111], a[128:131], a[108:111], v[108:111]
    s_waitcnt lgkmcnt(6)
    v_mfma_f32_16x16x32_bf16 v[112:115], a[136:139], a[96:99], v[112:115]
    ds_read_b64_tr_b16 a[156:157], v5 offset:58112
    v_mfma_f32_16x16x32_bf16 v[112:115], a[140:143], a[112:115], v[112:115]
    ds_read_b64_tr_b16 a[158:159], v5 offset:62208
    v_mfma_f32_16x16x32_bf16 v[116:119], a[140:143], a[116:119], v[116:119]
    buffer_load_dwordx4 v12, s[20:23], s30 offen offset:2048 lds
    v_mfma_f32_16x16x32_bf16 v[116:119], a[136:139], a[100:103], v[116:119]
    v_mfma_f32_16x16x32_bf16 v[120:123], a[136:139], a[104:107], v[120:123]
    ds_read_b64_tr_b16 a[128:129], v4 offset:0
    v_mfma_f32_16x16x32_bf16 v[120:123], a[140:143], a[120:123], v[120:123]
    ds_read_b64_tr_b16 a[130:131], v4 offset:4096
    v_mfma_f32_16x16x32_bf16 v[124:127], a[140:143], a[124:127], v[124:127]
    s_bitcmp1_b32 s53, 14
    s_cbranch_scc1 L_st32
L_st32_ret:
    v_xor_b32 v5, 0x10000, v5
    v_mfma_f32_16x16x32_bf16 v[124:127], a[136:139], a[108:111], v[124:127]
    s_waitcnt lgkmcnt(6)
    v_mfma_f32_16x16x32_bf16 v[128:131], a[144:147], a[96:99], v[128:131]
    ds_read_b64_tr_b16 a[132:133], v4 offset:8192
    v_mfma_f32_16x16x32_bf16 v[128:131], a[148:151], a[112:115], v[128:131]
    ds_read_b64_tr_b16 a[134:135], v4 offset:12288
    v_mfma_f32_16x16x32_bf16 v[132:135], a[148:151], a[116:119], v[132:135]
    buffer_load_dwordx4 a[88:91], v14, s[8:11], s52 offen offset:1024 sc1
    v_mfma_f32_16x16x32_bf16 v[132:135], a[144:147], a[100:103], v[132:135]
    v_mfma_f32_16x16x32_bf16 v[136:139], a[144:147], a[104:107], v[136:139]
    ds_read_b64_tr_b16 a[136:137], v5 offset:0
    v_mfma_f32_16x16x32_bf16 v[136:139], a[148:151], a[120:123], v[136:139]
    ds_read_b64_tr_b16 a[138:139], v5 offset:4096
    v_mfma_f32_16x16x32_bf16 v[140:143], a[148:151], a[124:127], v[140:143]
    buffer_load_dwordx4 v13, s[20:23], s30 offen offset:3072 lds
    v_mfma_f32_16x16x32_bf16 v[140:143], a[144:147], a[108:111], v[140:143]
    s_waitcnt lgkmcnt(6)
    v_mfma_f32_16x16x32_bf16 v[144:147], a[152:155], a[96:99], v[144:147]
    ds_read_b64_tr_b16 a[140:141], v5 offset:8192
    v_mfma_f32_16x16x32_bf16 v[144:147], a[156:159], a[112:115], v[144:147]
    ds_read_b64_tr_b16 a[142:143], v5 offset:12288
    v_mfma_f32_16x16x32_bf16 v[148:151], a[156:159], a[116:119], v[148:151]
    s_add_u32 s30, s30, 131072
    s_bitcmp1_b32 s53, 15
    s_cbranch_scc1 L_st33
L_st33_ret:
    s_xor_b32 s35, s35, 0x10000
    s_xor_b32 s29, s29, 0x10000
    v_mfma_f32_16x16x32_bf16 v[148:151], a[152:155], a[100:103], v[148:151]
    v_mfma_f32_16x16x32_bf16 v[152:155], a[152:155], a[104:107], v[152:155]
    ds_read_b64_tr_b16 a[144:145], v4 offset:256
    v_mfma_f32_16x16x32_bf16 v[152:155], a[156:159], a[120:123], v[152:155]
    ds_read_b64_tr_b16 a[146:147], v4 offset:4352
    v_mfma_f32_16x16x32_bf16 v[156:159], a[156:159], a[124:127], v[156:159]
    buffer_load_dwordx4 a[92:95], v15, s[8:11], s52 offen offset:1024 sc1
    v_mfma_f32_16x16x32_bf16 v[156:159], a[152:155], a[108:111], v[156:159]
    s_add_u32 s28, s28, 2048
    s_add_u32 s52, s52, 2048
    s_cmp_eq_u32 s41, 3
    s_cselect_b32 s53, 15, 0
    s_cmp_eq_u32 s41, 0
    s_cselect_b32 s53, 170, s53
    s_add_u32 s41, s41, 1
    s_cmp_lg_u32 s41, 6
    s_cbranch_scc1 L_g2
    v_cmp_ne_u32 vcc, 1, v19
    s_cbranch_vccz L_pollg_ok
    s_mov_b32 s60, 1048576
L_pollg:
    buffer_load_dword v19, v18, s[8:11], s43 offen sc1
    s_sub_u32 s60, s60, 1
    s_cbranch_scc1 L_pollg_ok
    s_waitcnt vmcnt(0)
    v_cmp_ne_u32 vcc, 1, v19
    s_cbranch_vccnz L_pollg
L_pollg_ok:
    v_xor_b32 v1, 0x10000, v4
    v_xor_b32 v2, 0x10000, v5
    s_waitcnt lgkmcnt(6)
    v_mfma_f32_16x16x32_bf16 v[32:35], a[128:131], a[0:3], v[32:35]
    ds_read_b64_tr_b16 a[148:149], v4 offset:8448
    s_xor_b32 s32, s34, 1
    v_mfma_f32_16x16x32_bf16 v[32:35], a[132:135], a[16:19], v[32:35]
    ds_read_b64_tr_b16 a[150:151], v4 offset:12544
    v_mfma_f32_16x16x32_bf16 v[36:39], a[132:135], a[20:23], v[36:39]
    buffer_load_dwordx4 a[96:99], v14, s[8:11], s28 offen offset:0 sc1
    s_lshl_b32 s32, s32, 14
    v_mfma_f32_16x16x32_bf16 v[36:39], a[128:131], a[4:7], v[36:39]
    v_mfma_f32_16x16x32_bf16 v[40:43], a[128:131], a[8:11], v[40:43]
    ds_read_b64_tr_b16 a[152:153], v5 offset:256
    s_add_u32 s32, s32, s44
    v_mfma_f32_16x16x32_bf16 v[40:43], a[132:135], a[24:27], v[40:43]
    ds_read_b64_tr_b16 a[154:155], v5 offset:4352
    v_mfma_f32_16x16x32_bf16 v[44:47], a[132:135], a[28:31], v[44:47]
    buffer_load_dwordx4 a[100:103], v15, s[8:11], s28 offen offset:0 sc1
    s_add_u32 s33, s32, 4096
    v_mfma_f32_16x16x32_bf16 v[44:47], a[128:131], a[12:15], v[44:47]
    s_waitcnt lgkmcnt(6)
    v_mfma_f32_16x16x32_bf16 v[48:51], a[136:139], a[0:3], v[48:51]
    ds_read_b64_tr_b16 a[156:157], v5 offset:8448
    buffer_load_dwordx4 v[192:195], v20, s[8:11], s32 offen offset:2048 sc1
    v_mfma_f32_16x16x32_bf16 v[48:51], a[140:143], a[16:19], v[48:51]
    ds_read_b64_tr_b16 a[158:159], v5 offset:12544
    v_mfma_f32_16x16x32_bf16 v[52:55], a[140:143], a[20:23], v[52:55]
    buffer_load_dwordx4 a[104:107], v14, s[8:11], s52 offen offset:0 sc1
    buffer_load_dwordx4 v[196:199], v30, s[8:11], s32 offen offset:2048 sc1
    v_mfma_f32_16x16x32_bf16 v[52:55], a[136:139], a[4:7], v[52:55]
    v_mfma_f32_16x16x32_bf16 v[56:59], a[136:139], a[8:11], v[56:59]
    ds_read_b64_tr_b16 a[128:129], v4 offset:512
    buffer_load_dwordx4 v[200:203], v20, s[8:11], s33 offen offset:2048 sc1
    v_mfma_f32_16x16x32_bf16 v[56:59], a[140:143], a[24:27], v[56:59]
    ds_read_b64_tr_b16 a[130:131], v4 offset:4608
    v_mfma_f32_16x16x32_bf16 v[60:63], a[140:143], a[28:31], v[60:63]
    buffer_load_dwordx4 a[108:111], v15, s[8:11], s52 offen offset:0 sc1
    buffer_load_dwordx4 v[204:207], v30, s[8:11], s33 offen offset:2048 sc1
    v_mfma_f32_16x16x32_bf16 v[60:63], a[136:139], a[12:15], v[60:63]
    s_barrier
    s_waitcnt lgkmcnt(6)
    v_mfma_f32_16x16x32_bf16 v[64:67], a[144:147], a[0:3], v[64:67]
    ds_read_b64_tr_b16 a[132:133], v4 offset:8704
    s_xor_b32 s32, s34, 2
    v_mfma_f32_16x16x32_bf16 v[64:67], a[148:151], a[16:19], v[64:67]
    ds_read_b64_tr_b16 a[134:135], v4 offset:12800
    v_mfma_f32_16x16x32_bf16 v[68:71], a[148:151], a[20:23], v[68:71]
    s_lshl_b32 s32, s32, 14
    v_mfma_f32_16x16x32_bf16 v[68:71], a[144:147], a[4:7], v[68:71]
    v_mfma_f32_16x16x32_bf16 v[72:75], a[144:147], a[8:11], v[72:75]
    ds_read_b64_tr_b16 a[136:137], v5 offset:512
    s_add_u32 s32, s32, s44
    v_mfma_f32_16x16x32_bf16 v[72:75], a[148:151], a[24:27], v[72:75]
    ds_read_b64_tr_b16 a[138:139], v5 offset:4608
    v_mfma_f32_16x16x32_bf16 v[76:79], a[148:151], a[28:31], v[76:79]
    s_add_u32 s33, s32, 4096
    v_mfma_f32_16x16x32_bf16 v[76:79], a[144:147], a[12:15], v[76:79]
    s_waitcnt lgkmcnt(6)
    v_mfma_f32_16x16x32_bf16 v[80:83], a[152:155], a[0:3], v[80:83]
    ds_read_b64_tr_b16 a[140:141], v5 offset:8704
    buffer_load_dwordx4 v[208:211], v20, s[8:11], s32 offen offset:3072 sc1
    v_mfma_f32_16x16x32_bf16 v[80:83], a[156:159], a[16:19], v[80:83]
    ds_read_b64_tr_b16 a[142:143], v5 offset:12800
    v_mfma_f32_16x16x32_bf16 v[84:87], a[156:159], a[20:23], v[84:87]
    buffer_load_dwordx4 a[112:115], v14, s[8:11], s28 offen offset:1024 sc1
    buffer_load_dwordx4 v[212:215], v30, s[8:11], s32 offen offset:3072 sc1
    v_mfma_f32_16x16x32_bf16 v[84:87], a[152:155], a[4:7], v[84:87]
    v_mfma_f32_16x16x32_bf16 v[88:91], a[152:155], a[8:11], v[88:91]
    ds_read_b64_tr_b16 a[144:145], v4 offset:768
    buffer_load_dwordx4 v[216:219], v20, s[8:11], s33 offen offset:3072 sc1
    v_mfma_f32_16x16x32_bf16 v[88:91], a[156:159], a[24:27], v[88:91]
    ds_read_b64_tr_b16 a[146:147], v4 offset:4864
    v_mfma_f32_16x16x32_bf16 v[92:95], a[156:159], a[28:31], v[92:95]
    buffer_load_dwordx4 v[220:223], v30, s[8:11], s33 offen offset:3072 sc1
    v_mfma_f32_16x16x32_bf16 v[92:95], a[152:155], a[12:15], v[92:95]
    s_waitcnt lgkmcnt(6)
    v_mfma_f32_16x16x32_bf16 v[96:99], a[128:131], a[0:3], v[96:99]
    ds_read_b64_tr_b16 a[148:149], v4 offset:8960
    s_xor_b32 s32, s34, 3
    v_mfma_f32_16x16x32_bf16 v[96:99], a[132:135], a[16:19], v[96:99]
    ds_read_b64_tr_b16 a[150:151], v4 offset:13056
    v_mfma_f32_16x16x32_bf16 v[100:103], a[132:135], a[20:23], v[100:103]
    s_lshl_b32 s32, s32, 14
    v_mfma_f32_16x16x32_bf16 v[100:103], a[128:131], a[4:7], v[100:103]
    v_mfma_f32_16x16x32_bf16 v[104:107], a[128:131], a[8:11], v[104:107]
    ds_read_b64_tr_b16 a[152:153], v5 offset:768
    s_add_u32 s32, s32, s44
    v_mfma_f32_16x16x32_bf16 v[104:107], a[132:135], a[24:27], v[104:107]
    ds_read_b64_tr_b16 a[154:155], v5 offset:4864
    v_mfma_f32_16x16x32_bf16 v[108:111], a[132:135], a[28:31], v[108:111]
    buffer_load_dwordx4 a[116:119], v15, s[8:11], s28 offen offset:1024 sc1
    s_add_u32 s33, s32, 4096
    v_mfma_f32_16x16x32_bf16 v[108:111], a[128:131], a[12:15], v[108:111]
    s_waitcnt lgkmcnt(6)
    v_mfma_f32_16x16x32_bf16 v[112:115], a[136:139], a[0:3], v[112:115]
    ds_read_b64_tr_b16 a[156:157], v5 offset:8960
    buffer_load_dwordx4 v[160:163], v20, s[8:11], s32 offen offset:0 sc1
    v_mfma_f32_16x16x32_bf16 v[112:115], a[140:143], a[16:19], v[112:115]
    ds_read_b64_tr_b16 a[158:159], v5 offset:13056
    v_mfma_f32_16x16x32_bf16 v[116:119], a[140:143], a[20:23], v[116:119]
    buffer_load_dwordx4 v[164:167], v30, s[8:11], s32 offen offset:0 sc1
    v_mfma_f32_16x16x32_bf16 v[116:119], a[136:139], a[4:7], v[116:119]
    v_mfma_f32_16x16x32_bf16 v[120:123], a[136:139], a[8:11], v[120:123]
    ds_read_b64_tr_b16 a[128:129], v4 offset:16384
    buffer_load_dwordx4 v[168:171], v20, s[8:11], s33 offen offset:0 sc1
    v_mfma_f32_16x16x32_bf16 v[120:123], a[140:143], a[24:27], v[120:123]
    ds_read_b64_tr_b16 a[130:131], v4 offset:20480
    v_mfma_f32_16x16x32_bf16 v[124:127], a[140:143], a[28:31], v[124:127]
    buffer_load_dwordx4 v[172:175], v30, s[8:11], s33 offen offset:0 sc1
    v_mfma_f32_16x16x32_bf16 v[124:127], a[136:139], a[12:15], v[124:127]
    s_waitcnt lgkmcnt(6)
    v_mfma_f32_16x16x32_bf16 v[128:131], a[144:147], a[0:3], v[128:131]
    ds_read_b64_tr_b16 a[132:133], v4 offset:24576
    v_mfma_f32_16x16x32_bf16 v[128:131], a[148:151], a[16:19], v[128:131]
    ds_read_b64_tr_b16 a[134:135], v4 offset:28672
    v_mfma_f32_16x16x32_bf16 v[132:135], a[148:151], a[20:23], v[132:135]
    buffer_load_dwordx4 a[120:123], v14, s[8:11], s52 offen offset:1024 sc1
    v_mfma_f32_16x16x32_bf16 v[132:135], a[144:147], a[4:7], v[132:135]
    v_mfma_f32_16x16x32_bf16 v[136:139], a[144:147], a[8:11], v[136:139]
    ds_read_b64_tr_b16 a[136:137], v5 offset:16384
    v_mfma_f32_16x16x32_bf16 v[136:139], a[148:151], a[24:27], v[136:139]
    ds_read_b64_tr_b16 a[138:139], v5 offset:20480
    v_mfma_f32_16x16x32_bf16 v[140:143], a[148:151], a[28:31], v[140:143]
    v_mfma_f32_16x16x32_bf16 v[140:143], a[144:147], a[12:15], v[140:143]
    s_waitcnt lgkmcnt(6)
    v_mfma_f32_16x16x32_bf16 v[144:147], a[152:155], a[0:3], v[144:147]
    ds_read_b64_tr_b16 a[140:141], v5 offset:24576
    v_mfma_f32_16x16x32_bf16 v[144:147], a[156:159], a[16:19], v[144:147]
    ds_read_b64_tr_b16 a[142:143], v5 offset:28672
    v_mfma_f32_16x16x32_bf16 v[148:151], a[156:159], a[20:23], v[148:151]
    v_mfma_f32_16x16x32_bf16 v[148:151], a[152:155], a[4:7], v[148:151]
    v_mfma_f32_16x16x32_bf16 v[152:155], a[152:155], a[8:11], v[152:155]
    ds_read_b64_tr_b16 a[144:145], v4 offset:16640
    v_mfma_f32_16x16x32_bf16 v[152:155], a[156:159], a[24:27], v[152:155]
    ds_read_b64_tr_b16 a[146:147], v4 offset:20736
    v_mfma_f32_16x16x32_bf16 v[156:159], a[156:159], a[28:31], v[156:159]
    buffer_load_dwordx4 a[124:127], v15, s[8:11], s52 offen offset:1024 sc1
    v_mfma_f32_16x16x32_bf16 v[156:159], a[152:155], a[12:15], v[156:159]
    s_add_u32 s28, s28, 2048
    s_add_u32 s52, s52, 2048
    s_waitcnt vmcnt(32) lgkmcnt(6)
    v_mfma_f32_16x16x32_bf16 v[32:35], a[128:131], a[32:35], v[32:35]
    ds_read_b64_tr_b16 a[148:149], v4 offset:24832
    v_mfma_f32_16x16x32_bf16 v[32:35], a[132:135], a[48:51], v[32:35]
    ds_read_b64_tr_b16 a[150:151], v4 offset:28928
    v_mfma_f32_16x16x32_bf16 v[36:39], a[132:135], a[52:55], v[36:39]
    buffer_load_dwordx4 a[0:3], v14, s[8:11], s28 offen offset:0 sc1
    v_mfma_f32_16x16x32_bf16 v[36:39], a[128:131], a[36:39], v[36:39]
    v_mfma_f32_16x16x32_bf16 v[40:43], a[128:131], a[40:43], v[40:43]
    ds_read_b64_tr_b16 a[152:153], v5 offset:16640
    v_mfma_f32_16x16x32_bf16 v[40:43], a[132:135], a[56:59], v[40:43]
    ds_read_b64_tr_b16 a[154:155], v5 offset:20736
    v_mfma_f32_16x16x32_bf16 v[44:47], a[132:135], a[60:63], v[44:47]
    buffer_load_dwordx4 a[4:7], v15, s[8:11], s28 offen offset:0 sc1
    v_mfma_f32_16x16x32_bf16 v[44:47], a[128:131], a[44:47], v[44:47]
    s_waitcnt lgkmcnt(6)
    v_mfma_f32_16x16x32_bf16 v[48:51], a[136:139], a[32:35], v[48:51]
    ds_read_b64_tr_b16 a[156:157], v5 offset:24832
    v_mfma_f32_16x16x32_bf16 v[48:51], a[140:143], a[48:51], v[48:51]
    ds_read_b64_tr_b16 a[158:159], v5 offset:28928
    v_mfma_f32_16x16x32_bf16 v[52:55], a[140:143], a[52:55], v[52:55]
    buffer_load_dwordx4 a[8:11], v14, s[8:11], s52 offen offset:0 sc1
    v_mfma_f32_16x16x32_bf16 v[52:55], a[136:139], a[36:39], v[52:55]
    v_mfma_f32_16x16x32_bf16 v[56:59], a[136:139], a[40:43], v[56:59]
    ds_read_b64_tr_b16 a[128:129], v4 offset:16896
    v_mfma_f32_16x16x32_bf16 v[56:59], a[140:143], a[56:59], v[56:59]
    ds_read_b64_tr_b16 a[130:131], v4 offset:20992
    v_mfma_f32_16x16x32_bf16 v[60:63], a[140:143], a[60:63], v[60:63]
    buffer_load_dwordx4 a[12:15], v15, s[8:11], s52 offen offset:0 sc1
    v_mfma_f32_16x16x32_bf16 v[60:63], a[136:139], a[44:47], v[60:63]
    s_waitcnt vmcnt(25)
    s_barrier
    s_waitcnt vmcnt(6)
    s_waitcnt lgkmcnt(6)
    v_mfma_f32_16x16x32_bf16 v[64:67], a[144:147], a[32:35], v[64:67]
    ds_read_b64_tr_b16 a[132:133], v4 offset:25088
    v_lshlrev_b32_e64 v9, 16, v192
    v_mfma_f32_16x16x32_bf16 v[64:67], a[148:151], a[48:51], v[64:67]
    ds_read_b64_tr_b16 a[134:135], v4 offset:29184
    v_and_b32 v192, 0xffff0000, v192
    v_mfma_f32_16x16x32_bf16 v[68:71], a[148:151], a[52:55], v[68:71]
    v_add_f32 v224, v224, v9
    v_add_f32 v225, v225, v192
    v_lshlrev_b32_e64 v23, 16, v193
    v_mfma_f32_16x16x32_bf16 v[68:71], a[144:147], a[36:39], v[68:71]
    v_and_b32 v193, 0xffff0000, v193
    v_add_f32_e64 v226, v226, v23
    v_mfma_f32_16x16x32_bf16 v[72:75], a[144:147], a[40:43], v[72:75]
    ds_read_b64_tr_b16 a[136:137], v5 offset:16896
    v_add_f32_e64 v227, v227, v193
    v_mfma_f32_16x16x32_bf16 v[72:75], a[148:151], a[56:59], v[72:75]
    ds_read_b64_tr_b16 a[138:139], v5 offset:20992
    v_lshlrev_b32_e64 v9, 16, v194
    v_mfma_f32_16x16x32_bf16 v[76:79], a[148:151], a[60:63], v[76:79]
    v_and_b32 v194, 0xffff0000, v194
    v_add_f32_e64 v228, v228, v9
    v_mfma_f32_16x16x32_bf16 v[76:79], a[144:147], a[44:47], v[76:79]
    v_add_f32 v229, v229, v194
    v_lshlrev_b32_e64 v23, 16, v195
    s_waitcnt lgkmcnt(6)
    v_mfma_f32_16x16x32_bf16 v[80:83], a[152:155], a[32:35], v[80:83]
    ds_read_b64_tr_b16 a[140:141], v5 offset:25088
    v_and_b32 v195, 0xffff0000, v195
    v_mfma_f32_16x16x32_bf16 v[80:83], a[156:159], a[48:51], v[80:83]
    ds_read_b64_tr_b16 a[142:143], v5 offset:29184
    v_add_f32_e64 v230, v230, v23
    v_mfma_f32_16x16x32_bf16 v[84:87], a[156:159], a[52:55], v[84:87]
    buffer_load_dwordx4 a[16:19], v14, s[8:11], s28 offen offset:1024 sc1
    v_add_f32_e64 v231, v231, v195
    v_mfma_f32_16x16x32_bf16 v[84:87], a[152:155], a[36:39], v[84:87]
    v_lshlrev_b32_e64 v9, 16, v196
    v_and_b32 v196, 0xffff0000, v196
    v_mfma_f32_16x16x32_bf16 v[88:91], a[152:155], a[40:43], v[88:91]
    ds_read_b64_tr_b16 a[144:145], v4 offset:17152
    v_add_f32 v232, v232, v9
    v_add_f32 v233, v233, v196
    v_mfma_f32_16x16x32_bf16 v[88:91], a[156:159], a[56:59], v[88:91]
    ds_read_b64_tr_b16 a[146:147], v4 offset:21248
    v_lshlrev_b32_e64 v23, 16, v197
    v_mfma_f32_16x16x32_bf16 v[92:95], a[156:159], a[60:63], v[92:95]
    v_and_b32 v197, 0xffff0000, v197
    v_add_f32_e64 v234, v234, v23
    v_mfma_f32_16x16x32_bf16 v[92:95], a[152:155], a[44:47], v[92:95]
    v_add_f32 v235, v235, v197
    s_waitcnt lgkmcnt(6)
    v_mfma_f32_16x16x32_bf16 v[96:99], a[128:131], a[32:35], v[96:99]
    ds_read_b64_tr_b16 a[148:149], v4 offset:25344
    v_lshlrev_b32_e64 v9, 16, v198
    v_mfma_f32_16x16x32_bf16 v[96:99], a[132:135], a[48:51], v[96:99]
    ds_read_b64_tr_b16 a[150:151], v4 offset:29440
    v_and_b32 v198, 0xffff0000, v198
    v_mfma_f32_16x16x32_bf16 v[100:103], a[132:135], a[52:55], v[100:103]
    v_add_f32 v236, v236, v9
    v_add_f32 v237, v237, v198
    v_lshlrev_b32_e64 v23, 16, v199
    v_mfma_f32_16x16x32_bf16 v[100:103], a[128:131], a[36:39], v[100:103]
    v_and_b32 v199, 0xffff0000, v199
    v_add_f32_e64 v238, v238, v23
    v_mfma_f32_16x16x32_bf16 v[104:107], a[128:131], a[40:43], v[104:107]
    ds_read_b64_tr_b16 a[152:153], v5 offset:17152
    v_add_f32_e64 v239, v239, v199
    v_mfma_f32_16x16x32_bf16 v[104:107], a[132:135], a[56:59], v[104:107]
    ds_read_b64_tr_b16 a[154:155], v5 offset:21248
    v_lshlrev_b32_e64 v9, 16, v200
    v_mfma_f32_16x16x32_bf16 v[108:111], a[132:135], a[60:63], v[108:111]
    buffer_load_dwordx4 a[20:23], v15, s[8:11], s28 offen offset:1024 sc1
    v_and_b32 v200, 0xffff0000, v200
    v_mfma_f32_16x16x32_bf16 v[108:111], a[128:131], a[44:47], v[108:111]
    v_add_f32 v240, v240, v9
    v_add_f32_e64 v241, v241, v200
    s_waitcnt lgkmcnt(6)
    v_mfma_f32_16x16x32_bf16 v[112:115], a[136:139], a[32:35], v[112:115]
    ds_read_b64_tr_b16 a[156:157], v5 offset:25344
    v_lshlrev_b32_e64 v23, 16, v201
    v_mfma_f32_16x16x32_bf16 v[112:115], a[140:143], a[48:51], v[112:115]
    ds_read_b64_tr_b16 a[158:159], v5 offset:29440
    v_and_b32 v201, 0xffff0000, v201
    v_mfma_f32_16x16x32_bf16 v[116:119], a[140:143], a[52:55], v[116:119]
    v_add_f32 v242, v242, v23
    v_add_f32 v243, v243, v201
    v_mfma_f32_16x16x32_bf16 v[116:119], a[136:139], a[36:39], v[116:119]
    v_lshlrev_b32_e64 v9, 16, v202
    v_and_b32 v202, 0xffff0000, v202
    v_mfma_f32_16x16x32_bf16 v[120:123], a[136:139], a[40:43], v[120:123]
    ds_read_b64_tr_b16 a[128:129], v4 offset:33536
    v_add_f32 v244, v244, v9
    v_add_f32 v245, v245, v202
    v_mfma_f32_16x16x32_bf16 v[120:123], a[140:143], a[56:59], v[120:123]
    ds_read_b64_tr_b16 a[130:131], v4 offset:37632
    v_lshlrev_b32_e64 v23, 16, v203
    v_mfma_f32_16x16x32_bf16 v[124:127], a[140:143], a[60:63], v[124:127]
    v_and_b32 v203, 0xffff0000, v203
    v_add_f32_e64 v246, v246, v23
    v_mfma_f32_16x16x32_bf16 v[124:127], a[136:139], a[44:47], v[124:127]
    v_add_f32 v247, v247, v203
    s_waitcnt lgkmcnt(6)
    v_mfma_f32_16x16x32_bf16 v[128:131], a[144:147], a[32:35], v[128:131]
    ds_read_b64_tr_b16 a[132:133], v4 offset:41728
    v_lshlrev_b32_e64 v9, 16, v204
    v_mfma_f32_16x16x32_bf16 v[128:131], a[148:151], a[48:51], v[128:131]
    ds_read_b64_tr_b16 a[134:135], v4 offset:45824
    v_and_b32 v204, 0xffff0000, v204
    v_mfma_f32_16x16x32_bf16 v[132:135], a[148:151], a[52:55], v[132:135]
    buffer_load_dwordx4 a[24:27], v14, s[8:11], s52 offen offset:1024 sc1
    v_add_f32 v248, v248, v9
    v_add_f32 v249, v249, v204
    v_mfma_f32_16x16x32_bf16 v[132:135], a[144:147], a[36:39], v[132:135]
    v_lshlrev_b32_e64 v23, 16, v205
    v_and_b32 v205, 0xffff0000, v205
    v_mfma_f32_16x16x32_bf16 v[136:139], a[144:147], a[40:43], v[136:139]
    ds_read_b64_tr_b16 a[136:137], v5 offset:33536
    v_add_f32_e64 v250, v250, v23
    v_mfma_f32_16x16x32_bf16 v[136:139], a[148:151], a[56:59], v[136:139]
    ds_read_b64_tr_b16 a[138:139], v5 offset:37632
    v_add_f32_e64 v251, v251, v205
    v_mfma_f32_16x16x32_bf16 v[140:143], a[148:151], a[60:63], v[140:143]
    v_lshlrev_b32_e64 v9, 16, v206
    v_and_b32 v206, 0xffff0000, v206
    v_add_f32_e64 v252, v252, v9
    v_mfma_f32_16x16x32_bf16 v[140:143], a[144:147], a[44:47], v[140:143]
    v_add_f32 v253, v253, v206
    s_waitcnt lgkmcnt(6)
    v_mfma_f32_16x16x32_bf16 v[144:147], a[152:155], a[32:35], v[144:147]
    ds_read_b64_tr_b16 a[140:141], v5 offset:41728
    v_lshlrev_b32_e64 v23, 16, v207
    v_mfma_f32_16x16x32_bf16 v[144:147], a[156:159], a[48:51], v[144:147]
    ds_read_b64_tr_b16 a[142:143], v5 offset:45824
    v_and_b32 v207, 0xffff0000, v207
    v_mfma_f32_16x16x32_bf16 v[148:151], a[156:159], a[52:55], v[148:151]
    v_add_f32 v254, v254, v23
    v_add_f32 v255, v255, v207
    v_mfma_f32_16x16x32_bf16 v[148:151], a[152:155], a[36:39], v[148:151]
    v_lshlrev_b32_e64 v9, 16, v208
    v_and_b32 v208, 0xffff0000, v208
    v_add_f32_e64 v224, v224, v9
    v_mfma_f32_16x16x32_bf16 v[152:155], a[152:155], a[40:43], v[152:155]
    ds_read_b64_tr_b16 a[144:145], v4 offset:49920
    v_add_f32_e64 v225, v225, v208
    v_mfma_f32_16x16x32_bf16 v[152:155], a[156:159], a[56:59], v[152:155]
    ds_read_b64_tr_b16 a[146:147], v4 offset:54016
    v_lshlrev_b32_e64 v23, 16, v209
    v_mfma_f32_16x16x32_bf16 v[156:159], a[156:159], a[60:63], v[156:159]
    buffer_load_dwordx4 a[28:31], v15, s[8:11], s52 offen offset:1024 sc1
    v_and_b32 v209, 0xffff0000, v209
    v_mfma_f32_16x16x32_bf16 v[156:159], a[152:155], a[44:47], v[156:159]
    s_add_u32 s28, s28, 2048
    s_add_u32 s52, s52, 2048
    s_waitcnt lgkmcnt(6)
    v_mfma_f32_16x16x32_bf16 v[128:131], a[128:131], a[64:67], v[128:131]
    ds_read_b64_tr_b16 a[148:149], v4 offset:58112
    v_add_f32 v226, v226, v23
    v_mfma_f32_16x16x32_bf16 v[128:131], a[132:135], a[80:83], v[128:131]
    ds_read_b64_tr_b16 a[150:151], v4 offset:62208
    v_add_f32 v227, v227, v209
    v_lshlrev_b32 v9, 16, v210
    v_mfma_f32_16x16x32_bf16 v[132:135], a[132:135], a[84:87], v[132:135]
    buffer_load_dwordx4 a[32:35], v14, s[8:11], s28 offen offset:0 sc1
    buffer_load_dwordx4 a[36:39], v15, s[8:11], s28 offen offset:0 sc1
    v_mfma_f32_16x16x32_bf16 v[132:135], a[128:131], a[68:71], v[132:135]
    v_and_b32 v210, 0xffff0000, v210
    v_add_f32_e64 v228, v228, v9
    v_mfma_f32_16x16x32_bf16 v[136:139], a[128:131], a[72:75], v[136:139]
    ds_read_b64_tr_b16 a[152:153], v5 offset:49920
    v_add_f32_e64 v229, v229, v210
    v_mfma_f32_16x16x32_bf16 v[136:139], a[132:135], a[88:91], v[136:139]
    ds_read_b64_tr_b16 a[154:155], v5 offset:54016
    v_lshlrev_b32_e64 v23, 16, v211
    v_mfma_f32_16x16x32_bf16 v[140:143], a[132:135], a[92:95], v[140:143]
    buffer_load_dwordx4 a[40:43], v14, s[8:11], s52 offen offset:0 sc1
    buffer_load_dwordx4 a[44:47], v15, s[8:11], s52 offen offset:0 sc1
    v_and_b32 v211, 0xffff0000, v211
    v_mfma_f32_16x16x32_bf16 v[140:143], a[128:131], a[76:79], v[140:143]
    v_add_f32 v230, v230, v23
    s_waitcnt lgkmcnt(6)
    v_mfma_f32_16x16x32_bf16 v[144:147], a[136:139], a[64:67], v[144:147]
    ds_read_b64_tr_b16 a[156:157], v5 offset:58112
    v_add_f32_e64 v231, v231, v211
    v_mfma_f32_16x16x32_bf16 v[144:147], a[140:143], a[80:83], v[144:147]
    ds_read_b64_tr_b16 a[158:159], v5 offset:62208
    v_lshlrev_b32_e64 v9, 16, v212
    v_mfma_f32_16x16x32_bf16 v[148:151], a[140:143], a[84:87], v[148:151]
    buffer_load_dwordx4 a[48:51], v14, s[8:11], s28 offen offset:1024 sc1
    buffer_load_dwordx4 a[52:55], v15, s[8:11], s28 offen offset:1024 sc1
    v_mfma_f32_16x16x32_bf16 v[148:151], a[136:139], a[68:71], v[148:151]
    v_and_b32 v212, 0xffff0000, v212
    v_add_f32 v232, v232, v9
    v_add_f32 v233, v233, v212
    v_mfma_f32_16x16x32_bf16 v[152:155], a[136:139], a[72:75], v[152:155]
    ds_read_b64_tr_b16 a[128:129], v1 offset:768
    v_lshlrev_b32_e64 v23, 16, v213
    v_mfma_f32_16x16x32_bf16 v[152:155], a[140:143], a[88:91], v[152:155]
    ds_read_b64_tr_b16 a[130:131], v1 offset:4864
    v_and_b32 v213, 0xffff0000, v213
    v_mfma_f32_16x16x32_bf16 v[156:159], a[140:143], a[92:95], v[156:159]
    buffer_load_dwordx4 a[56:59], v14, s[8:11], s52 offen offset:1024 sc1
    buffer_load_dwordx4 a[60:63], v15, s[8:11], s52 offen offset:1024 sc1
    v_mfma_f32_16x16x32_bf16 v[156:159], a[136:139], a[76:79], v[156:159]
    s_add_u32 s28, s28, 2048
    s_add_u32 s52, s52, 2048
    v_add_f32 v234, v234, v23
    s_waitcnt vmcnt(16) lgkmcnt(6)
    v_mfma_f32_16x16x32_bf16 v[128:131], a[144:147], a[96:99], v[128:131]
    ds_read_b64_tr_b16 a[132:133], v1 offset:8960
    v_add_f32_e64 v235, v235, v213
    v_mfma_f32_16x16x32_bf16 v[128:131], a[148:151], a[112:115], v[128:131]
    ds_read_b64_tr_b16 a[134:135], v1 offset:13056
    v_lshlrev_b32_e64 v9, 16, v214
    v_mfma_f32_16x16x32_bf16 v[132:135], a[148:151], a[116:119], v[132:135]
    s_xor_b32 s32, s34, 0
    v_and_b32 v214, 0xffff0000, v214
    v_mfma_f32_16x16x32_bf16 v[132:135], a[144:147], a[100:103], v[132:135]
    v_add_f32 v236, v236, v9
    v_add_f32_e64 v237, v237, v214
    v_mfma_f32_16x16x32_bf16 v[136:139], a[144:147], a[104:107], v[136:139]
    ds_read_b64_tr_b16 a[136:137], v2 offset:768
    v_lshlrev_b32_e64 v23, 16, v215
    v_mfma_f32_16x16x32_bf16 v[136:139], a[148:151], a[120:123], v[136:139]
    ds_read_b64_tr_b16 a[138:139], v2 offset:4864
    v_and_b32 v215, 0xffff0000, v215
    v_add_f32_e64 v238, v238, v23
    v_mfma_f32_16x16x32_bf16 v[140:143], a[148:151], a[124:127], v[140:143]
    s_lshl_b32 s32, s32, 14
    v_add_f32 v239, v239, v215
    v_mfma_f32_16x16x32_bf16 v[140:143], a[144:147], a[108:111], v[140:143]
    v_lshlrev_b32 v9, 16, v216
    s_waitcnt lgkmcnt(6)
    v_mfma_f32_16x16x32_bf16 v[144:147], a[152:155], a[96:99], v[144:147]
    ds_read_b64_tr_b16 a[140:141], v2 offset:8960
    v_and_b32 v216, 0xffff0000, v216
    v_mfma_f32_16x16x32_bf16 v[144:147], a[156:159], a[112:115], v[144:147]
    ds_read_b64_tr_b16 a[142:143], v2 offset:13056
    v_add_f32_e64 v240, v240, v9
    v_mfma_f32_16x16x32_bf16 v[148:151], a[156:159], a[116:119], v[148:151]
    s_add_u32 s32, s32, s44
    v_add_f32 v241, v241, v216
    v_mfma_f32_16x16x32_bf16 v[148:151], a[152:155], a[100:103], v[148:151]
    buffer_load_dwordx2 v[176:177], v21, s[24:27], s46 offen offset:0
    v_lshlrev_b32_e64 v23, 16, v217
    v_and_b32 v217, 0xffff0000, v217
    v_mfma_f32_16x16x32_bf16 v[152:155], a[152:155], a[104:107], v[152:155]
    ds_read_b64_tr_b16 a[144:145], v4 offset:33280
    v_add_f32_e64 v242, v242, v23
    v_mfma_f32_16x16x32_bf16 v[152:155], a[156:159], a[120:123], v[152:155]
    ds_read_b64_tr_b16 a[146:147], v4 offset:37376
    v_add_f32_e64 v243, v243, v217
    v_mfma_f32_16x16x32_bf16 v[156:159], a[156:159], a[124:127], v[156:159]
    s_add_u32 s32, s32, 8192
    v_lshlrev_b32_e64 v9, 16, v218
    v_mfma_f32_16x16x32_bf16 v[156:159], a[152:155], a[108:111], v[156:159]
    v_and_b32 v218, 0xffff0000, v218
    s_waitcnt vmcnt(9) lgkmcnt(6)
    v_mfma_f32_16x16x32_bf16 v[128:131], a[128:131], a[0:3], v[128:131]
    ds_read_b64_tr_b16 a[148:149], v4 offset:41472
    v_add_f32 v244, v244, v9
    v_mfma_f32_16x16x32_bf16 v[128:131], a[132:135], a[16:19], v[128:131]
    ds_read_b64_tr_b16 a[150:151], v4 offset:45568
    v_add_f32_e64 v245, v245, v218
    v_mfma_f32_16x16x32_bf16 v[132:135], a[132:135], a[20:23], v[132:135]
    s_add_u32 s33, s32, 4096
    v_lshlrev_b32_e64 v23, 16, v219
    v_and_b32 v219, 0xffff0000, v219
    v_mfma_f32_16x16x32_bf16 v[132:135], a[128:131], a[4:7], v[132:135]
    buffer_load_dwordx2 v[178:179], v21, s[24:27], s47 offen offset:0
    v_add_f32_e64 v246, v246, v23
    v_mfma_f32_16x16x32_bf16 v[136:139], a[128:131], a[8:11], v[136:139]
    ds_read_b64_tr_b16 a[152:153], v5 offset:33280
    v_add_f32_e64 v247, v247, v219
    v_mfma_f32_16x16x32_bf16 v[136:139], a[132:135], a[24:27], v[136:139]
    ds_read_b64_tr_b16 a[154:155], v5 offset:37376
    v_lshlrev_b32_e64 v9, 16, v220
    v_mfma_f32_16x16x32_bf16 v[140:143], a[132:135], a[28:31], v[140:143]
    v_and_b32 v220, 0xffff0000, v220
    v_add_f32_e64 v248, v248, v9
    v_mfma_f32_16x16x32_bf16 v[140:143], a[128:131], a[12:15], v[140:143]
    v_add_f32 v249, v249, v220
    s_waitcnt lgkmcnt(6)
    v_mfma_f32_16x16x32_bf16 v[144:147], a[136:139], a[0:3], v[144:147]
    ds_read_b64_tr_b16 a[156:157], v5 offset:41472
    v_lshlrev_b32_e64 v23, 16, v221
    v_and_b32 v221, 0xffff0000, v221
    v_mfma_f32_16x16x32_bf16 v[144:147], a[140:143], a[16:19], v[144:147]
    ds_read_b64_tr_b16 a[158:159], v5 offset:45568
    v_add_f32_e64 v250, v250, v23
    v_mfma_f32_16x16x32_bf16 v[148:151], a[140:143], a[20:23], v[148:151]
    v_add_f32 v251, v251, v221
    v_lshlrev_b32 v9, 16, v222
    v_mfma_f32_16x16x32_bf16 v[148:151], a[136:139], a[4:7], v[148:151]
    buffer_load_dwordx2 v[180:181], v21, s[24:27], s48 offen offset:0
    v_and_b32 v222, 0xffff0000, v222
    v_mfma_f32_16x16x32_bf16 v[152:155], a[136:139], a[8:11], v[152:155]
    ds_read_b64_tr_b16 a[128:129], v4 offset:49664
    v_add_f32_e64 v252, v252, v9
    v_mfma_f32_16x16x32_bf16 v[152:155], a[140:143], a[24:27], v[152:155]
    ds_read_b64_tr_b16 a[130:131], v4 offset:53760
    v_add_f32_e64 v253, v253, v222
    v_mfma_f32_16x16x32_bf16 v[156:159], a[140:143], a[28:31], v[156:159]
    v_lshlrev_b32_e64 v23, 16, v223
    v_and_b32 v223, 0xffff0000, v223
    v_add_f32_e64 v254, v254, v23
    v_mfma_f32_16x16x32_bf16 v[156:159], a[136:139], a[12:15], v[156:159]
    v_add_f32 v255, v255, v223
    s_waitcnt lgkmcnt(6)
    v_mfma_f32_16x16x32_bf16 v[96:99], a[144:147], a[64:67], v[96:99]
    ds_read_b64_tr_b16 a[132:133], v4 offset:57856
    v_lshlrev_b32_e64 v9, 16, v160
    v_mfma_f32_16x16x32_bf16 v[96:99], a[148:151], a[80:83], v[96:99]
    ds_read_b64_tr_b16 a[134:135], v4 offset:61952
    v_and_b32 v160, 0xffff0000, v160
    v_mfma_f32_16x16x32_bf16 v[100:103], a[148:151], a[84:87], v[100:103]
    v_add_f32 v224, v224, v9
    v_add_f32 v225, v225, v160
    v_mfma_f32_16x16x32_bf16 v[100:103], a[144:147], a[68:71], v[100:103]
    buffer_load_dwordx2 v[182:183], v21, s[24:27], s49 offen offset:0
    v_lshlrev_b32_e64 v23, 16, v161
    v_and_b32 v161, 0xffff0000, v161
    v_mfma_f32_16x16x32_bf16 v[104:107], a[144:147], a[72:75], v[104:107]
    ds_read_b64_tr_b16 a[136:137], v5 offset:49664
    v_add_f32_e64 v226, v226, v23
    v_mfma_f32_16x16x32_bf16 v[104:107], a[148:151], a[88:91], v[104:107]
    ds_read_b64_tr_b16 a[138:139], v5 offset:53760
    v_add_f32_e64 v227, v227, v161
    v_mfma_f32_16x16x32_bf16 v[108:111], a[148:151], a[92:95], v[108:111]
    v_lshlrev_b32_e64 v9, 16, v162
    v_and_b32 v162, 0xffff0000, v162
    v_mfma_f32_16x16x32_bf16 v[108:111], a[144:147], a[76:79], v[108:111]
    v_add_f32 v228, v228, v9
    s_waitcnt lgkmcnt(6)
    v_mfma_f32_16x16x32_bf16 v[112:115], a[152:155], a[64:67], v[112:115]
    ds_read_b64_tr_b16 a[140:141], v5 offset:57856
    v_add_f32 v229, v229, v162
    v_lshlrev_b32 v23, 16, v163
    v_mfma_f32_16x16x32_bf16 v[112:115], a[156:159], a[80:83], v[112:115]
    ds_read_b64_tr_b16 a[142:143], v5 offset:61952
    v_and_b32 v163, 0xffff0000, v163
    v_mfma_f32_16x16x32_bf16 v[116:119], a[156:159], a[84:87], v[116:119]
    v_add_f32 v230, v230, v23
    v_add_f32 v231, v231, v163
    v_mfma_f32_16x16x32_bf16 v[116:119], a[152:155], a[68:71], v[116:119]
    buffer_load_dwordx2 v[184:185], v21, s[24:27], s46 offen offset:32
    v_lshlrev_b32_e64 v9, 16, v164
    v_mfma_f32_16x16x32_bf16 v[120:123], a[152:155], a[72:75], v[120:123]
    ds_read_b64_tr_b16 a[144:145], v1 offset:17152
    v_and_b32 v164, 0xffff0000, v164
    v_mfma_f32_16x16x32_bf16 v[120:123], a[156:159], a[88:91], v[120:123]
    ds_read_b64_tr_b16 a[146:147], v1 offset:21248
    v_add_f32_e64 v232, v232, v9
    v_mfma_f32_16x16x32_bf16 v[124:127], a[156:159], a[92:95], v[124:127]
    v_add_f32 v233, v233, v164
    v_lshlrev_b32 v23, 16, v165
    v_and_b32 v165, 0xffff0000, v165
    v_mfma_f32_16x16x32_bf16 v[124:127], a[152:155], a[76:79], v[124:127]
    v_add_f32 v234, v234, v23
    s_waitcnt lgkmcnt(6)
    v_mfma_f32_16x16x32_bf16 v[96:99], a[128:131], a[96:99], v[96:99]
    ds_read_b64_tr_b16 a[148:149], v1 offset:25344
    v_add_f32_e64 v235, v235, v165
    v_mfma_f32_16x16x32_bf16 v[96:99], a[132:135], a[112:115], v[96:99]
    ds_read_b64_tr_b16 a[150:151], v1 offset:29440
    v_lshlrev_b32_e64 v9, 16, v166
    v_mfma_f32_16x16x32_bf16 v[100:103], a[132:135], a[116:119], v[100:103]
    v_and_b32 v166, 0xffff0000, v166
    v_add_f32_e64 v236, v236, v9
    v_mfma_f32_16x16x32_bf16 v[100:103], a[128:131], a[100:103], v[100:103]
    buffer_load_dwordx2 v[186:187], v21, s[24:27], s47 offen offset:32
    v_add_f32 v237, v237, v166
    v_lshlrev_b32 v23, 16, v167
    v_mfma_f32_16x16x32_bf16 v[104:107], a[128:131], a[104:107], v[104:107]
    ds_read_b64_tr_b16 a[152:153], v2 offset:17152
    v_and_b32 v167, 0xffff0000, v167
    v_mfma_f32_16x16x32_bf16 v[104:107], a[132:135], a[120:123], v[104:107]
    ds_read_b64_tr_b16 a[154:155], v2 offset:21248
    v_add_f32_e64 v238, v238, v23
    v_mfma_f32_16x16x32_bf16 v[108:111], a[132:135], a[124:127], v[108:111]
    v_add_f32 v239, v239, v167
    v_lshlrev_b32 v9, 16, v168
    v_mfma_f32_16x16x32_bf16 v[108:111], a[128:131], a[108:111], v[108:111]
    v_and_b32 v168, 0xffff0000, v168
    s_waitcnt lgkmcnt(6)
    v_mfma_f32_16x16x32_bf16 v[112:115], a[136:139], a[96:99], v[112:115]
    ds_read_b64_tr_b16 a[156:157], v2 offset:25344
    v_add_f32 v240, v240, v9
    v_mfma_f32_16x16x32_bf16 v[112:115], a[140:143], a[112:115], v[112:115]
    ds_read_b64_tr_b16 a[158:159], v2 offset:29440
    v_add_f32 v241, v241, v168
    v_lshlrev_b32 v23, 16, v169
    v_mfma_f32_16x16x32_bf16 v[116:119], a[140:143], a[116:119], v[116:119]
    v_and_b32 v169, 0xffff0000, v169
    v_add_f32_e64 v242, v242, v23
    v_mfma_f32_16x16x32_bf16 v[116:119], a[136:139], a[100:103], v[116:119]
    buffer_load_dwordx2 v[188:189], v21, s[24:27], s48 offen offset:32
    v_add_f32_e64 v243, v243, v169
    v_mfma_f32_16x16x32_bf16 v[120:123], a[136:139], a[104:107], v[120:123]
    ds_read_b64_tr_b16 a[128:129], v1 offset:512
    v_lshlrev_b32_e64 v9, 16, v170
    v_mfma_f32_16x16x32_bf16 v[120:123], a[140:143], a[120:123], v[120:123]
    ds_read_b64_tr_b16 a[130:131], v1 offset:4608
    v_and_b32 v170, 0xffff0000, v170
    v_mfma_f32_16x16x32_bf16 v[124:127], a[140:143], a[124:127], v[124:127]
    v_add_f32 v244, v244, v9
    v_add_f32 v245, v245, v170
    v_lshlrev_b32_e64 v23, 16, v171
    v_mfma_f32_16x16x32_bf16 v[124:127], a[136:139], a[108:111], v[124:127]
    v_and_b32 v171, 0xffff0000, v171
    s_waitcnt vmcnt(7) lgkmcnt(6)
    v_mfma_f32_16x16x32_bf16 v[128:131], a[144:147], a[32:35], v[128:131]
    ds_read_b64_tr_b16 a[132:133], v1 offset:8704
    v_add_f32 v246, v246, v23
    v_mfma_f32_16x16x32_bf16 v[128:131], a[148:151], a[48:51], v[128:131]
    ds_read_b64_tr_b16 a[134:135], v1 offset:12800
    v_add_f32_e64 v247, v247, v171
    v_mfma_f32_16x16x32_bf16 v[132:135], a[148:151], a[52:55], v[132:135]
    v_lshlrev_b32_e64 v9, 16, v172
    v_and_b32 v172, 0xffff0000, v172
    v_mfma_f32_16x16x32_bf16 v[132:135], a[144:147], a[36:39], v[132:135]
    buffer_load_dwordx2 v[190:191], v21, s[24:27], s49 offen offset:32
    v_add_f32 v248, v248, v9
    v_add_f32 v249, v249, v172
    v_mfma_f32_16x16x32_bf16 v[136:139], a[144:147], a[40:43], v[136:139]
    ds_read_b64_tr_b16 a[136:137], v2 offset:512
    v_lshlrev_b32_e64 v23, 16, v173
    v_mfma_f32_16x16x32_bf16 v[136:139], a[148:151], a[56:59], v[136:139]
    ds_read_b64_tr_b16 a[138:139], v2 offset:4608
    v_and_b32 v173, 0xffff0000, v173
    v_mfma_f32_16x16x32_bf16 v[140:143], a[148:151], a[60:63], v[140:143]
    v_add_f32 v250, v250, v23
    v_add_f32 v251, v251, v173
    v_mfma_f32_16x16x32_bf16 v[140:143], a[144:147], a[44:47], v[140:143]
    v_lshlrev_b32 v9, 16, v174
    s_waitcnt lgkmcnt(6)
    v_mfma_f32_16x16x32_bf16 v[144:147], a[152:155], a[32:35], v[144:147]
    ds_read_b64_tr_b16 a[140:141], v2 offset:8704
    v_and_b32 v174, 0xffff0000, v174
    v_mfma_f32_16x16x32_bf16 v[144:147], a[156:159], a[48:51], v[144:147]
    ds_read_b64_tr_b16 a[142:143], v2 offset:12800
    v_add_f32 v252, v252, v9
    v_add_f32 v253, v253, v174
    v_mfma_f32_16x16x32_bf16 v[148:151], a[156:159], a[52:55], v[148:151]
    v_lshlrev_b32_e64 v23, 16, v175
    v_and_b32 v175, 0xffff0000, v175
    v_mfma_f32_16x16x32_bf16 v[148:151], a[152:155], a[36:39], v[148:151]
    v_add_f32 v254, v254, v23
    v_add_f32 v255, v255, v175
    v_mfma_f32_16x16x32_bf16 v[152:155], a[152:155], a[40:43], v[152:155]
    ds_read_b64_tr_b16 a[144:145], v1 offset:16896
    v_mul_f32 v9, 0xbfb8aa3b, v224
    v_mfma_f32_16x16x32_bf16 v[152:155], a[156:159], a[56:59], v[152:155]
    ds_read_b64_tr_b16 a[146:147], v1 offset:20992
    v_mul_f32 v23, 0xbfb8aa3b, v225
    v_mfma_f32_16x16x32_bf16 v[156:159], a[156:159], a[60:63], v[156:159]
    v_mul_f32 v28, 0xbfb8aa3b, v226
    v_mul_f32 v29, 0xbfb8aa3b, v227
    v_mfma_f32_16x16x32_bf16 v[156:159], a[152:155], a[44:47], v[156:159]
    v_exp_f32 v9, v9
    s_waitcnt lgkmcnt(6)
    v_mfma_f32_16x16x32_bf16 v[96:99], a[128:131], a[0:3], v[96:99]
    ds_read_b64_tr_b16 a[148:149], v1 offset:25088
    v_exp_f32_e64 v23, v23
    v_mfma_f32_16x16x32_bf16 v[96:99], a[132:135], a[16:19], v[96:99]
    ds_read_b64_tr_b16 a[150:151], v1 offset:29184
    v_mfma_f32_16x16x32_bf16 v[100:103], a[132:135], a[20:23], v[100:103]
    v_exp_f32_e64 v28, v28
    v_mfma_f32_16x16x32_bf16 v[100:103], a[128:131], a[4:7], v[100:103]
    v_exp_f32 v29, v29
    v_add_f32 v9, 1.0, v9
    v_mfma_f32_16x16x32_bf16 v[104:107], a[128:131], a[8:11], v[104:107]
    ds_read_b64_tr_b16 a[152:153], v2 offset:16896
    v_cvt_pk_bf16_f32 v128, v128, v129
    v_mfma_f32_16x16x32_bf16 v[104:107], a[132:135], a[24:27], v[104:107]
    ds_read_b64_tr_b16 a[154:155], v2 offset:20992
    v_add_f32_e64 v23, 1.0, v23
    v_mfma_f32_16x16x32_bf16 v[108:111], a[132:135], a[28:31], v[108:111]
    v_cvt_pk_bf16_f32 v129, v130, v131
    v_add_f32_e64 v28, 1.0, v28
    v_mfma_f32_16x16x32_bf16 v[108:111], a[128:131], a[12:15], v[108:111]
    v_add_f32 v29, 1.0, v29
    s_waitcnt lgkmcnt(6)
    v_mfma_f32_16x16x32_bf16 v[112:115], a[136:139], a[0:3], v[112:115]
    ds_read_b64_tr_b16 a[156:157], v2 offset:25088
    v_cvt_pk_bf16_f32 v130, v132, v133
    v_rcp_f32_e64 v9, v9
    v_mfma_f32_16x16x32_bf16 v[112:115], a[140:143], a[16:19], v[112:115]
    ds_read_b64_tr_b16 a[158:159], v2 offset:29184
    v_rcp_f32_e64 v23, v23
    v_mfma_f32_16x16x32_bf16 v[116:119], a[140:143], a[20:23], v[116:119]
    v_cvt_pk_bf16_f32 v131, v134, v135
    v_rcp_f32_e64 v28, v28
    v_mfma_f32_16x16x32_bf16 v[116:119], a[136:139], a[4:7], v[116:119]
    v_rcp_f32 v29, v29
    v_mul_f32 v224, v224, v9
    v_mfma_f32_16x16x32_bf16 v[120:123], a[136:139], a[8:11], v[120:123]
    ds_read_b64_tr_b16 a[128:129], v4 offset:33024
    v_mul_f32 v225, v225, v23
    v_mul_f32 v226, v226, v28
    v_mfma_f32_16x16x32_bf16 v[120:123], a[140:143], a[24:27], v[120:123]
    ds_read_b64_tr_b16 a[130:131], v4 offset:37120
    v_mul_f32_e64 v227, v227, v29
    v_mfma_f32_16x16x32_bf16 v[124:127], a[140:143], a[28:31], v[124:127]
    v_mul_f32 v9, 0xbfb8aa3b, v228
    v_mul_f32 v23, 0xbfb8aa3b, v229
    v_mfma_f32_16x16x32_bf16 v[124:127], a[136:139], a[12:15], v[124:127]
    buffer_store_dwordx4 v[128:131], v20, s[8:11], s32 offen offset:0 sc1
    s_waitcnt lgkmcnt(6)
    v_mfma_f32_16x16x32_bf16 v[96:99], a[144:147], a[32:35], v[96:99]
    ds_read_b64_tr_b16 a[132:133], v4 offset:41216
    v_cvt_pk_bf16_f32 v132, v136, v137
    v_mul_f32 v28, 0xbfb8aa3b, v230
    v_mfma_f32_16x16x32_bf16 v[96:99], a[148:151], a[48:51], v[96:99]
    ds_read_b64_tr_b16 a[134:135], v4 offset:45312
    v_mul_f32 v29, 0xbfb8aa3b, v231
    v_mfma_f32_16x16x32_bf16 v[100:103], a[148:151], a[52:55], v[100:103]
    v_cvt_pk_bf16_f32 v133, v138, v139
    v_mfma_f32_16x16x32_bf16 v[100:103], a[144:147], a[36:39], v[100:103]
    v_exp_f32 v9, v9
    v_exp_f32_e64 v23, v23
    v_mfma_f32_16x16x32_bf16 v[104:107], a[144:147], a[40:43], v[104:107]
    ds_read_b64_tr_b16 a[136:137], v5 offset:33024
    v_cvt_pk_bf16_f32 v134, v140, v141
    v_mfma_f32_16x16x32_bf16 v[104:107], a[148:151], a[56:59], v[104:107]
    ds_read_b64_tr_b16 a[138:139], v5 offset:37120
    v_mfma_f32_16x16x32_bf16 v[108:111], a[148:151], a[60:63], v[108:111]
    v_cvt_pk_bf16_f32 v135, v142, v143
    v_exp_f32_e64 v28, v28
    v_mfma_f32_16x16x32_bf16 v[108:111], a[144:147], a[44:47], v[108:111]
    s_waitcnt lgkmcnt(6)
    v_mfma_f32_16x16x32_bf16 v[112:115], a[152:155], a[32:35], v[112:115]
    ds_read_b64_tr_b16 a[140:141], v5 offset:41216
    v_exp_f32 v29, v29
    v_mfma_f32_16x16x32_bf16 v[112:115], a[156:159], a[48:51], v[112:115]
    ds_read_b64_tr_b16 a[142:143], v5 offset:45312
    v_add_f32_e64 v9, 1.0, v9
    v_mfma_f32_16x16x32_bf16 v[116:119], a[156:159], a[52:55], v[116:119]
    v_add_f32 v23, 1.0, v23
    v_add_f32 v28, 1.0, v28
    v_mfma_f32_16x16x32_bf16 v[116:119], a[152:155], a[36:39], v[116:119]
    buffer_store_dwordx4 v[132:135], v30, s[8:11], s32 offen offset:0 sc1
    v_add_f32 v29, 1.0, v29
    v_rcp_f32 v9, v9
    v_mfma_f32_16x16x32_bf16 v[120:123], a[152:155], a[40:43], v[120:123]
    ds_read_b64_tr_b16 a[144:145], v4 offset:49408
    v_cvt_pk_bf16_f32 v136, v144, v145
    v_mfma_f32_16x16x32_bf16 v[120:123], a[156:159], a[56:59], v[120:123]
    ds_read_b64_tr_b16 a[146:147], v4 offset:53504
    v_rcp_f32_e64 v23, v23
    v_mfma_f32_16x16x32_bf16 v[124:127], a[156:159], a[60:63], v[124:127]
    v_cvt_pk_bf16_f32 v137, v146, v147
    v_rcp_f32_e64 v28, v28
    v_mfma_f32_16x16x32_bf16 v[124:127], a[152:155], a[44:47], v[124:127]
    v_rcp_f32 v29, v29
    s_waitcnt lgkmcnt(6)
    v_mfma_f32_16x16x32_bf16 v[64:67], a[128:131], a[64:67], v[64:67]
    ds_read_b64_tr_b16 a[148:149], v4 offset:57600
    v_cvt_pk_bf16_f32 v138, v148, v149
    v_mul_f32_e64 v228, v228, v9
    v_mfma_f32_16x16x32_bf16 v[64:67], a[132:135], a[80:83], v[64:67]
    ds_read_b64_tr_b16 a[150:151], v4 offset:61696
    v_mul_f32_e64 v229, v229, v23
    v_mfma_f32_16x16x32_bf16 v[68:71], a[132:135], a[84:87], v[68:71]
    v_cvt_pk_bf16_f32 v139, v150, v151
    v_mul_f32_e64 v230, v230, v28
    v_mfma_f32_16x16x32_bf16 v[68:71], a[128:131], a[68:71], v[68:71]
    v_mul_f32_e64 v231, v231, v29
    v_mul_f32 v9, 0xbfb8aa3b, v232
    v_mfma_f32_16x16x32_bf16 v[72:75], a[128:131], a[72:75], v[72:75]
    ds_read_b64_tr_b16 a[152:153], v5 offset:49408
    v_mul_f32 v23, 0xbfb8aa3b, v233
    v_mfma_f32_16x16x32_bf16 v[72:75], a[132:135], a[88:91], v[72:75]
    ds_read_b64_tr_b16 a[154:155], v5 offset:53504
    v_mul_f32 v28, 0xbfb8aa3b, v234
    v_mfma_f32_16x16x32_bf16 v[76:79], a[132:135], a[92:95], v[76:79]
    v_mul_f32 v29, 0xbfb8aa3b, v235
    v_exp_f32_e64 v9, v9
    v_mfma_f32_16x16x32_bf16 v[76:79], a[128:131], a[76:79], v[76:79]
    buffer_store_dwordx4 v[136:139], v20, s[8:11], s33 offen offset:0 sc1
    s_waitcnt lgkmcnt(6)
    v_mfma_f32_16x16x32_bf16 v[80:83], a[136:139], a[64:67], v[80:83]
    ds_read_b64_tr_b16 a[156:157], v5 offset:57600
    v_cvt_pk_bf16_f32 v140, v152, v153
    v_mfma_f32_16x16x32_bf16 v[80:83], a[140:143], a[80:83], v[80:83]
    ds_read_b64_tr_b16 a[158:159], v5 offset:61696
    v_exp_f32 v23, v23
    v_mfma_f32_16x16x32_bf16 v[84:87], a[140:143], a[84:87], v[84:87]
    v_cvt_pk_bf16_f32 v141, v154, v155
    v_mfma_f32_16x16x32_bf16 v[84:87], a[136:139], a[68:71], v[84:87]
    v_exp_f32_e64 v28, v28
    v_mfma_f32_16x16x32_bf16 v[88:91], a[136:139], a[72:75], v[88:91]
    ds_read_b64_tr_b16 a[128:129], v1 offset:256
    v_cvt_pk_bf16_f32 v142, v156, v157
    v_exp_f32_e64 v29, v29
    v_mfma_f32_16x16x32_bf16 v[88:91], a[140:143], a[88:91], v[88:91]
    ds_read_b64_tr_b16 a[130:131], v1 offset:4352
    v_mfma_f32_16x16x32_bf16 v[92:95], a[140:143], a[92:95], v[92:95]
    v_cvt_pk_bf16_f32 v143, v158, v159
    v_add_f32 v9, 1.0, v9
    v_add_f32 v23, 1.0, v23
    v_mfma_f32_16x16x32_bf16 v[92:95], a[136:139], a[76:79], v[92:95]
    v_add_f32 v28, 1.0, v28
    s_waitcnt lgkmcnt(6)
    v_mfma_f32_16x16x32_bf16 v[64:67], a[144:147], a[96:99], v[64:67]
    ds_read_b64_tr_b16 a[132:133], v1 offset:8448
    v_add_f32_e64 v29, 1.0, v29
    v_mfma_f32_16x16x32_bf16 v[64:67], a[148:151], a[112:115], v[64:67]
    ds_read_b64_tr_b16 a[134:135], v1 offset:12544
    v_rcp_f32_e64 v9, v9
    v_mfma_f32_16x16x32_bf16 v[68:71], a[148:151], a[116:119], v[68:71]
    v_rcp_f32 v23, v23
    v_rcp_f32 v28, v28
    v_mfma_f32_16x16x32_bf16 v[68:71], a[144:147], a[100:103], v[68:71]
    buffer_store_dwordx4 v[140:143], v30, s[8:11], s33 offen offset:0 sc1
    v_rcp_f32_e64 v29, v29
    v_mfma_f32_16x16x32_bf16 v[72:75], a[144:147], a[104:107], v[72:75]
    ds_read_b64_tr_b16 a[136:137], v2 offset:256
    v_cvt_pk_bf16_f32 v96, v96, v97
    v_mul_f32_e64 v232, v232, v9
    v_mfma_f32_16x16x32_bf16 v[72:75], a[148:151], a[120:123], v[72:75]
    ds_read_b64_tr_b16 a[138:139], v2 offset:4352
    v_mul_f32_e64 v233, v233, v23
    v_mfma_f32_16x16x32_bf16 v[76:79], a[148:151], a[124:127], v[76:79]
    v_cvt_pk_bf16_f32 v97, v98, v99
    v_mul_f32_e64 v234, v234, v28
    v_mfma_f32_16x16x32_bf16 v[76:79], a[144:147], a[108:111], v[76:79]
    v_mul_f32 v235, v235, v29
    s_waitcnt lgkmcnt(6)
    v_mfma_f32_16x16x32_bf16 v[80:83], a[152:155], a[96:99], v[80:83]
    ds_read_b64_tr_b16 a[140:141], v2 offset:8448
    v_cvt_pk_bf16_f32 v98, v100, v101
    v_mfma_f32_16x16x32_bf16 v[80:83], a[156:159], a[112:115], v[80:83]
    ds_read_b64_tr_b16 a[142:143], v2 offset:12544
    v_mul_f32 v9, 0xbfb8aa3b, v236
    v_mul_f32 v23, 0xbfb8aa3b, v237
    v_mfma_f32_16x16x32_bf16 v[84:87], a[156:159], a[116:119], v[84:87]
    v_cvt_pk_bf16_f32 v99, v102, v103
    v_mul_f32 v28, 0xbfb8aa3b, v238
    v_mfma_f32_16x16x32_bf16 v[84:87], a[152:155], a[100:103], v[84:87]
    v_mul_f32 v29, 0xbfb8aa3b, v239
    v_exp_f32_e64 v9, v9
    v_mfma_f32_16x16x32_bf16 v[88:91], a[152:155], a[104:107], v[88:91]
    ds_read_b64_tr_b16 a[144:145], v1 offset:16640
    v_mfma_f32_16x16x32_bf16 v[88:91], a[156:159], a[120:123], v[88:91]
    ds_read_b64_tr_b16 a[146:147], v1 offset:20736
    v_exp_f32_e64 v23, v23
    v_mfma_f32_16x16x32_bf16 v[92:95], a[156:159], a[124:127], v[92:95]
    v_exp_f32_e64 v28, v28
    v_mfma_f32_16x16x32_bf16 v[92:95], a[152:155], a[108:111], v[92:95]
    buffer_store_dwordx4 v[96:99], v20, s[8:11], s32 offen offset:3072 sc1
    s_waitcnt lgkmcnt(6)
    v_mfma_f32_16x16x32_bf16 v[64:67], a[128:131], a[0:3], v[64:67]
    ds_read_b64_tr_b16 a[148:149], v1 offset:24832
    v_cvt_pk_bf16_f32 v100, v104, v105
    v_mfma_f32_16x16x32_bf16 v[64:67], a[132:135], a[16:19], v[64:67]
    ds_read_b64_tr_b16 a[150:151], v1 offset:28928
    v_exp_f32 v29, v29
    v_mfma_f32_16x16x32_bf16 v[68:71], a[132:135], a[20:23], v[68:71]
    v_cvt_pk_bf16_f32 v101, v106, v107
    v_mfma_f32_16x16x32_bf16 v[68:71], a[128:131], a[4:7], v[68:71]
    v_add_f32 v9, 1.0, v9
    v_add_f32 v23, 1.0, v23
    v_add_f32_e64 v28, 1.0, v28
    v_mfma_f32_16x16x32_bf16 v[72:75], a[128:131], a[8:11], v[72:75]
    ds_read_b64_tr_b16 a[152:153], v2 offset:16640
    v_cvt_pk_bf16_f32 v102, v108, v109
    v_mfma_f32_16x16x32_bf16 v[72:75], a[132:135], a[24:27], v[72:75]
    ds_read_b64_tr_b16 a[154:155], v2 offset:20736
    v_add_f32_e64 v29, 1.0, v29
    v_mfma_f32_16x16x32_bf16 v[76:79], a[132:135], a[28:31], v[76:79]
    v_cvt_pk_bf16_f32 v103, v110, v111
    v_rcp_f32_e64 v9, v9
    v_mfma_f32_16x16x32_bf16 v[76:79], a[128:131], a[12:15], v[76:79]
    v_rcp_f32 v23, v23
    s_waitcnt lgkmcnt(6)
    v_mfma_f32_16x16x32_bf16 v[80:83], a[136:139], a[0:3], v[80:83]
    ds_read_b64_tr_b16 a[156:157], v2 offset:24832
    v_rcp_f32 v28, v28
    v_rcp_f32 v29, v29
    v_mfma_f32_16x16x32_bf16 v[80:83], a[140:143], a[16:19], v[80:83]
    ds_read_b64_tr_b16 a[158:159], v2 offset:28928
    v_mul_f32_e64 v236, v236, v9
    v_mfma_f32_16x16x32_bf16 v[84:87], a[140:143], a[20:23], v[84:87]
    v_mul_f32 v237, v237, v23
    v_mul_f32 v238, v238, v28
    v_mfma_f32_16x16x32_bf16 v[84:87], a[136:139], a[4:7], v[84:87]
    buffer_store_dwordx4 v[100:103], v30, s[8:11], s32 offen offset:3072 sc1
    v_mul_f32_e64 v239, v239, v29
    v_mfma_f32_16x16x32_bf16 v[88:91], a[136:139], a[8:11], v[88:91]
    ds_read_b64_tr_b16 a[128:129], v4 offset:32768
    v_cvt_pk_bf16_f32 v104, v112, v113
    v_mul_f32 v9, 0xbfb8aa3b, v240
    v_mfma_f32_16x16x32_bf16 v[88:91], a[140:143], a[24:27], v[88:91]
    ds_read_b64_tr_b16 a[130:131], v4 offset:36864
    v_mul_f32 v23, 0xbfb8aa3b, v241
    v_mfma_f32_16x16x32_bf16 v[92:95], a[140:143], a[28:31], v[92:95]
    v_cvt_pk_bf16_f32 v105, v114, v115
    v_mul_f32 v28, 0xbfb8aa3b, v242
    v_mfma_f32_16x16x32_bf16 v[92:95], a[136:139], a[12:15], v[92:95]
    v_mul_f32 v29, 0xbfb8aa3b, v243
    s_waitcnt lgkmcnt(6)
    v_mfma_f32_16x16x32_bf16 v[64:67], a[144:147], a[32:35], v[64:67]
    ds_read_b64_tr_b16 a[132:133], v4 offset:40960
    v_cvt_pk_bf16_f32 v106, v116, v117
    v_mfma_f32_16x16x32_bf16 v[64:67], a[148:151], a[48:51], v[64:67]
    ds_read_b64_tr_b16 a[134:135], v4 offset:45056
    v_exp_f32 v9, v9
    v_mfma_f32_16x16x32_bf16 v[68:71], a[148:151], a[52:55], v[68:71]
    v_cvt_pk_bf16_f32 v107, v118, v119
    v_mfma_f32_16x16x32_bf16 v[68:71], a[144:147], a[36:39], v[68:71]
    v_exp_f32_e64 v23, v23
    v_mfma_f32_16x16x32_bf16 v[72:75], a[144:147], a[40:43], v[72:75]
    ds_read_b64_tr_b16 a[136:137], v5 offset:32768
    v_exp_f32_e64 v28, v28
    v_mfma_f32_16x16x32_bf16 v[72:75], a[148:151], a[56:59], v[72:75]
    ds_read_b64_tr_b16 a[138:139], v5 offset:36864
    v_exp_f32_e64 v29, v29
    v_mfma_f32_16x16x32_bf16 v[76:79], a[148:151], a[60:63], v[76:79]
    v_add_f32_e64 v9, 1.0, v9
    v_mfma_f32_16x16x32_bf16 v[76:79], a[144:147], a[44:47], v[76:79]
    buffer_store_dwordx4 v[104:107], v20, s[8:11], s33 offen offset:3072 sc1
    v_add_f32 v23, 1.0, v23
    s_waitcnt lgkmcnt(6)
    v_mfma_f32_16x16x32_bf16 v[80:83], a[152:155], a[32:35], v[80:83]
    ds_read_b64_tr_b16 a[140:141], v5 offset:40960
    v_cvt_pk_bf16_f32 v108, v120, v121
    v_mfma_f32_16x16x32_bf16 v[80:83], a[156:159], a[48:51], v[80:83]
    ds_read_b64_tr_b16 a[142:143], v5 offset:45056
    v_add_f32_e64 v28, 1.0, v28
    v_mfma_f32_16x16x32_bf16 v[84:87], a[156:159], a[52:55], v[84:87]
    v_cvt_pk_bf16_f32 v109, v122, v123
    v_add_f32_e64 v29, 1.0, v29
    v_mfma_f32_16x16x32_bf16 v[84:87], a[152:155], a[36:39], v[84:87]
    v_rcp_f32 v9, v9
    v_rcp_f32 v23, v23
    v_rcp_f32_e64 v28, v28
    v_mfma_f32_16x16x32_bf16 v[88:91], a[152:155], a[40:43], v[88:91]
    ds_read_b64_tr_b16 a[144:145], v4 offset:49152
    v_cvt_pk_bf16_f32 v110, v124, v125
    v_mfma_f32_16x16x32_bf16 v[88:91], a[156:159], a[56:59], v[88:91]
    ds_read_b64_tr_b16 a[146:147], v4 offset:53248
    v_rcp_f32_e64 v29, v29
    v_mfma_f32_16x16x32_bf16 v[92:95], a[156:159], a[60:63], v[92:95]
    v_cvt_pk_bf16_f32 v111, v126, v127
    v_mul_f32_e64 v240, v240, v9
    v_mfma_f32_16x16x32_bf16 v[92:95], a[152:155], a[44:47], v[92:95]
    v_mul_f32 v241, v241, v23
    s_waitcnt lgkmcnt(6)
    v_mfma_f32_16x16x32_bf16 v[32:35], a[128:131], a[64:67], v[32:35]
    ds_read_b64_tr_b16 a[148:149], v4 offset:57344
    v_mul_f32_e64 v242, v242, v28
    v_mfma_f32_16x16x32_bf16 v[32:35], a[132:135], a[80:83], v[32:35]
    ds_read_b64_tr_b16 a[150:151], v4 offset:61440
    v_mul_f32_e64 v243, v243, v29
    v_mul_f32 v9, 0xbfb8aa3b, v244
    v_mfma_f32_16x16x32_bf16 v[36:39], a[132:135], a[84:87], v[36:39]
    v_mul_f32 v23, 0xbfb8aa3b, v245
    v_mul_f32 v28, 0xbfb8aa3b, v246
    v_mfma_f32_16x16x32_bf16 v[36:39], a[128:131], a[68:71], v[36:39]
    buffer_store_dwordx4 v[108:111], v30, s[8:11], s33 offen offset:3072 sc1
    v_mul_f32 v29, 0xbfb8aa3b, v247
    v_mfma_f32_16x16x32_bf16 v[40:43], a[128:131], a[72:75], v[40:43]
    ds_read_b64_tr_b16 a[152:153], v5 offset:49152
    v_cvt_pk_bf16_f32 v64, v64, v65
    v_mfma_f32_16x16x32_bf16 v[40:43], a[132:135], a[88:91], v[40:43]
    ds_read_b64_tr_b16 a[154:155], v5 offset:53248
    v_exp_f32_e64 v9, v9
    v_mfma_f32_16x16x32_bf16 v[44:47], a[132:135], a[92:95], v[44:47]
    v_cvt_pk_bf16_f32 v65, v66, v67
    v_mfma_f32_16x16x32_bf16 v[44:47], a[128:131], a[76:79], v[44:47]
    v_exp_f32 v23, v23
    s_waitcnt lgkmcnt(6)
    v_mfma_f32_16x16x32_bf16 v[48:51], a[136:139], a[64:67], v[48:51]
    ds_read_b64_tr_b16 a[156:157], v5 offset:57344
    v_cvt_pk_bf16_f32 v66, v68, v69
    v_mfma_f32_16x16x32_bf16 v[48:51], a[140:143], a[80:83], v[48:51]
    ds_read_b64_tr_b16 a[158:159], v5 offset:61440
    v_exp_f32_e64 v28, v28
    v_mfma_f32_16x16x32_bf16 v[52:55], a[140:143], a[84:87], v[52:55]
    v_cvt_pk_bf16_f32 v67, v70, v71
    v_mfma_f32_16x16x32_bf16 v[52:55], a[136:139], a[68:71], v[52:55]
    v_exp_f32 v29, v29
    v_add_f32 v9, 1.0, v9
    v_mfma_f32_16x16x32_bf16 v[56:59], a[136:139], a[72:75], v[56:59]
    ds_read_b64_tr_b16 a[128:129], v1 offset:0
    v_add_f32_e64 v23, 1.0, v23
    v_mfma_f32_16x16x32_bf16 v[56:59], a[140:143], a[88:91], v[56:59]
    ds_read_b64_tr_b16 a[130:131], v1 offset:4096
    v_add_f32_e64 v28, 1.0, v28
    v_mfma_f32_16x16x32_bf16 v[60:63], a[140:143], a[92:95], v[60:63]
    v_add_f32 v29, 1.0, v29
    v_rcp_f32 v9, v9
    v_mfma_f32_16x16x32_bf16 v[60:63], a[136:139], a[76:79], v[60:63]
    buffer_store_dwordx4 v[64:67], v20, s[8:11], s32 offen offset:2048 sc1
    v_rcp_f32 v23, v23
    s_waitcnt lgkmcnt(6)
    v_mfma_f32_16x16x32_bf16 v[32:35], a[144:147], a[96:99], v[32:35]
    ds_read_b64_tr_b16 a[132:133], v1 offset:8192
    v_cvt_pk_bf16_f32 v68, v72, v73
    v_mfma_f32_16x16x32_bf16 v[32:35], a[148:151], a[112:115], v[32:35]
    ds_read_b64_tr_b16 a[134:135], v1 offset:12288
    v_rcp_f32_e64 v28, v28
    v_mfma_f32_16x16x32_bf16 v[36:39], a[148:151], a[116:119], v[36:39]
    v_cvt_pk_bf16_f32 v69, v74, v75
    v_rcp_f32_e64 v29, v29
    v_mfma_f32_16x16x32_bf16 v[36:39], a[144:147], a[100:103], v[36:39]
    v_mul_f32 v244, v244, v9
    v_mul_f32 v245, v245, v23
    v_mfma_f32_16x16x32_bf16 v[40:43], a[144:147], a[104:107], v[40:43]
    ds_read_b64_tr_b16 a[136:137], v2 offset:0
    v_cvt_pk_bf16_f32 v70, v76, v77
    v_mul_f32_e64 v246, v246, v28
    v_mfma_f32_16x16x32_bf16 v[40:43], a[148:151], a[120:123], v[40:43]
    ds_read_b64_tr_b16 a[138:139], v2 offset:4096
    v_mul_f32_e64 v247, v247, v29
    v_mfma_f32_16x16x32_bf16 v[44:47], a[148:151], a[124:127], v[44:47]
    v_cvt_pk_bf16_f32 v71, v78, v79
    v_mul_f32 v9, 0xbfb8aa3b, v248
    v_mfma_f32_16x16x32_bf16 v[44:47], a[144:147], a[108:111], v[44:47]
    v_mul_f32 v23, 0xbfb8aa3b, v249
    s_waitcnt lgkmcnt(6)
    v_mfma_f32_16x16x32_bf16 v[48:51], a[152:155], a[96:99], v[48:51]
    ds_read_b64_tr_b16 a[140:141], v2 offset:8192
    v_mul_f32 v28, 0xbfb8aa3b, v250
    v_mfma_f32_16x16x32_bf16 v[48:51], a[156:159], a[112:115], v[48:51]
    ds_read_b64_tr_b16 a[142:143], v2 offset:12288
    v_mul_f32 v29, 0xbfb8aa3b, v251
    v_mfma_f32_16x16x32_bf16 v[52:55], a[156:159], a[116:119], v[52:55]
    v_exp_f32 v9, v9
    v_mfma_f32_16x16x32_bf16 v[52:55], a[152:155], a[100:103], v[52:55]
    buffer_store_dwordx4 v[68:71], v30, s[8:11], s32 offen offset:2048 sc1
    v_exp_f32_e64 v23, v23
    v_mfma_f32_16x16x32_bf16 v[56:59], a[152:155], a[104:107], v[56:59]
    ds_read_b64_tr_b16 a[144:145], v1 offset:16384
    v_cvt_pk_bf16_f32 v72, v80, v81
    v_mfma_f32_16x16x32_bf16 v[56:59], a[156:159], a[120:123], v[56:59]
    ds_read_b64_tr_b16 a[146:147], v1 offset:20480
    v_exp_f32_e64 v28, v28
    v_mfma_f32_16x16x32_bf16 v[60:63], a[156:159], a[124:127], v[60:63]
    v_cvt_pk_bf16_f32 v73, v82, v83
    v_mfma_f32_16x16x32_bf16 v[60:63], a[152:155], a[108:111], v[60:63]
    v_exp_f32 v29, v29
    s_waitcnt lgkmcnt(6)
    v_mfma_f32_16x16x32_bf16 v[32:35], a[128:131], a[0:3], v[32:35]
    ds_read_b64_tr_b16 a[148:149], v1 offset:24576
    v_cvt_pk_bf16_f32 v74, v84, v85
    v_mfma_f32_16x16x32_bf16 v[32:35], a[132:135], a[16:19], v[32:35]
    ds_read_b64_tr_b16 a[150:151], v1 offset:28672
    v_add_f32_e64 v9, 1.0, v9
    v_mfma_f32_16x16x32_bf16 v[36:39], a[132:135], a[20:23], v[36:39]
    v_cvt_pk_bf16_f32 v75, v86, v87
    v_add_f32_e64 v23, 1.0, v23
    v_mfma_f32_16x16x32_bf16 v[36:39], a[128:131], a[4:7], v[36:39]
    v_add_f32 v28, 1.0, v28
    v_add_f32 v29, 1.0, v29
    v_mfma_f32_16x16x32_bf16 v[40:43], a[128:131], a[8:11], v[40:43]
    ds_read_b64_tr_b16 a[152:153], v2 offset:16384
    v_rcp_f32 v9, v9
    v_rcp_f32 v23, v23
    v_mfma_f32_16x16x32_bf16 v[40:43], a[132:135], a[24:27], v[40:43]
    ds_read_b64_tr_b16 a[154:155], v2 offset:20480
    v_rcp_f32_e64 v28, v28
    v_mfma_f32_16x16x32_bf16 v[44:47], a[132:135], a[28:31], v[44:47]
    v_rcp_f32 v29, v29
    v_mul_f32 v248, v248, v9
    v_mfma_f32_16x16x32_bf16 v[44:47], a[128:131], a[12:15], v[44:47]
    buffer_store_dwordx4 v[72:75], v20, s[8:11], s33 offen offset:2048 sc1
    s_waitcnt lgkmcnt(6)
    v_mfma_f32_16x16x32_bf16 v[48:51], a[136:139], a[0:3], v[48:51]
    ds_read_b64_tr_b16 a[156:157], v2 offset:24576
    v_cvt_pk_bf16_f32 v76, v88, v89
    v_mul_f32 v249, v249, v23
    v_mfma_f32_16x16x32_bf16 v[48:51], a[140:143], a[16:19], v[48:51]
    ds_read_b64_tr_b16 a[158:159], v2 offset:28672
    v_mul_f32_e64 v250, v250, v28
    v_mfma_f32_16x16x32_bf16 v[52:55], a[140:143], a[20:23], v[52:55]
    v_cvt_pk_bf16_f32 v77, v90, v91
    v_mul_f32_e64 v251, v251, v29
    v_mfma_f32_16x16x32_bf16 v[52:55], a[136:139], a[4:7], v[52:55]
    v_mul_f32 v9, 0xbfb8aa3b, v252
    v_mul_f32 v23, 0xbfb8aa3b, v253
    v_mfma_f32_16x16x32_bf16 v[56:59], a[136:139], a[8:11], v[56:59]
    v_cvt_pk_bf16_f32 v78, v92, v93
    v_mul_f32 v28, 0xbfb8aa3b, v254
    v_mfma_f32_16x16x32_bf16 v[56:59], a[140:143], a[24:27], v[56:59]
    v_mul_f32 v29, 0xbfb8aa3b, v255
    v_exp_f32_e64 v9, v9
    v_mfma_f32_16x16x32_bf16 v[60:63], a[140:143], a[28:31], v[60:63]
    v_cvt_pk_bf16_f32 v79, v94, v95
    v_mfma_f32_16x16x32_bf16 v[60:63], a[136:139], a[12:15], v[60:63]
    v_exp_f32 v23, v23
    s_waitcnt lgkmcnt(4)
    v_mfma_f32_16x16x32_bf16 v[32:35], a[144:147], a[32:35], v[32:35]
    v_exp_f32_e64 v28, v28
    v_mfma_f32_16x16x32_bf16 v[32:35], a[148:151], a[48:51], v[32:35]
    v_exp_f32 v29, v29
    v_add_f32 v9, 1.0, v9
    v_mfma_f32_16x16x32_bf16 v[36:39], a[148:151], a[52:55], v[36:39]
    v_add_f32 v23, 1.0, v23
    v_add_f32 v28, 1.0, v28
    v_mfma_f32_16x16x32_bf16 v[36:39], a[144:147], a[36:39], v[36:39]
    buffer_store_dwordx4 v[76:79], v30, s[8:11], s33 offen offset:2048 sc1
    v_add_f32_e64 v29, 1.0, v29
    v_mfma_f32_16x16x32_bf16 v[40:43], a[144:147], a[40:43], v[40:43]
    v_rcp_f32 v9, v9
    v_rcp_f32 v23, v23
    v_mfma_f32_16x16x32_bf16 v[40:43], a[148:151], a[56:59], v[40:43]
    v_rcp_f32 v28, v28
    v_rcp_f32 v29, v29
    v_mul_f32_e64 v252, v252, v9
    v_mfma_f32_16x16x32_bf16 v[44:47], a[148:151], a[60:63], v[44:47]
    v_mul_f32 v253, v253, v23
    v_mul_f32 v254, v254, v28
    v_mfma_f32_16x16x32_bf16 v[44:47], a[144:147], a[44:47], v[44:47]
    v_mul_f32 v255, v255, v29
    s_waitcnt lgkmcnt(0)
    v_mfma_f32_16x16x32_bf16 v[48:51], a[152:155], a[32:35], v[48:51]
    v_mfma_f32_16x16x32_bf16 v[48:51], a[156:159], a[48:51], v[48:51]
    v_mfma_f32_16x16x32_bf16 v[52:55], a[156:159], a[52:55], v[52:55]
    v_mfma_f32_16x16x32_bf16 v[52:55], a[152:155], a[36:39], v[52:55]
    v_mfma_f32_16x16x32_bf16 v[56:59], a[152:155], a[40:43], v[56:59]
    v_mfma_f32_16x16x32_bf16 v[56:59], a[156:159], a[56:59], v[56:59]
    v_mfma_f32_16x16x32_bf16 v[60:63], a[156:159], a[60:63], v[60:63]
    v_mfma_f32_16x16x32_bf16 v[60:63], a[152:155], a[44:47], v[60:63]
    s_add_u32 s43, s45, 128
    s_waitcnt vmcnt(12)
    v_lshlrev_b32 v192, 16, v176
    v_and_b32 v193, 0xffff0000, v176
    v_lshlrev_b32_e64 v194, 16, v177
    v_and_b32 v195, 0xffff0000, v177
    v_pk_fma_f32 v[32:33], v[32:33], v[224:225], v[192:193]
    v_pk_fma_f32 v[34:35], v[34:35], v[226:227], v[194:195]
    v_lshlrev_b32_e64 v196, 16, v178
    v_and_b32 v197, 0xffff0000, v178
    v_lshlrev_b32_e64 v198, 16, v179
    v_and_b32 v199, 0xffff0000, v179
    v_pk_fma_f32 v[36:37], v[36:37], v[228:229], v[196:197]
    v_pk_fma_f32 v[38:39], v[38:39], v[230:231], v[198:199]
    v_lshlrev_b32_e64 v200, 16, v180
    v_and_b32 v201, 0xffff0000, v180
    v_lshlrev_b32_e64 v202, 16, v181
    v_and_b32 v203, 0xffff0000, v181
    v_pk_fma_f32 v[40:41], v[40:41], v[232:233], v[200:201]
    v_pk_fma_f32 v[42:43], v[42:43], v[234:235], v[202:203]
    v_lshlrev_b32_e64 v204, 16, v182
    v_and_b32 v205, 0xffff0000, v182
    v_lshlrev_b32_e64 v206, 16, v183
    v_and_b32 v207, 0xffff0000, v183
    v_pk_fma_f32 v[44:45], v[44:45], v[236:237], v[204:205]
    v_pk_fma_f32 v[46:47], v[46:47], v[238:239], v[206:207]
    v_lshlrev_b32_e64 v208, 16, v184
    v_and_b32 v209, 0xffff0000, v184
    v_lshlrev_b32_e64 v210, 16, v185
    v_and_b32 v211, 0xffff0000, v185
    v_pk_fma_f32 v[48:49], v[48:49], v[240:241], v[208:209]
    v_pk_fma_f32 v[50:51], v[50:51], v[242:243], v[210:211]
    v_lshlrev_b32_e64 v212, 16, v186
    v_and_b32 v213, 0xffff0000, v186
    v_lshlrev_b32_e64 v214, 16, v187
    v_and_b32 v215, 0xffff0000, v187
    v_pk_fma_f32 v[52:53], v[52:53], v[244:245], v[212:213]
    v_pk_fma_f32 v[54:55], v[54:55], v[246:247], v[214:215]
    v_lshlrev_b32_e64 v216, 16, v188
    v_and_b32 v217, 0xffff0000, v188
    v_lshlrev_b32_e64 v218, 16, v189
    v_and_b32 v219, 0xffff0000, v189
    v_pk_fma_f32 v[56:57], v[56:57], v[248:249], v[216:217]
    v_pk_fma_f32 v[58:59], v[58:59], v[250:251], v[218:219]
    v_lshlrev_b32_e64 v220, 16, v190
    v_and_b32 v221, 0xffff0000, v190
    v_lshlrev_b32_e64 v222, 16, v191
    v_and_b32 v223, 0xffff0000, v191
    v_pk_fma_f32 v[60:61], v[60:61], v[252:253], v[220:221]
    v_pk_fma_f32 v[62:63], v[62:63], v[254:255], v[222:223]
    s_waitcnt vmcnt(0)
    s_mov_b64 exec, 1
    buffer_store_dword v17, v24, s[8:11], s45 offen offset:128 sc1
    s_mov_b64 exec, -1
    v_mov_b32 v19, 0
    v_cmp_ne_u32 vcc, 1, v19
    s_cbranch_vccz L_pollf_ok
    s_mov_b32 s60, 1048576
L_pollf:
    buffer_load_dword v19, v18, s[8:11], s43 offen sc1
    s_sub_u32 s60, s60, 1
    s_cbranch_scc1 L_pollf_ok
    s_waitcnt vmcnt(0)
    v_cmp_ne_u32 vcc, 1, v19
    s_cbranch_vccnz L_pollf
L_pollf_ok:
    s_xor_b32 s32, s34, 1
    s_lshl_b32 s32, s32, 14
    s_add_u32 s32, s32, s44
    s_add_u32 s32, s32, 8192
    s_add_u32 s33, s32, 4096
    buffer_load_dwordx4 v[192:195], v20, s[8:11], s32 offen offset:2048 sc1
    buffer_load_dwordx4 v[196:199], v30, s[8:11], s32 offen offset:2048 sc1
    buffer_load_dwordx4 v[200:203], v20, s[8:11], s33 offen offset:2048 sc1
    buffer_load_dwordx4 v[204:207], v30, s[8:11], s33 offen offset:2048 sc1
    s_xor_b32 s32, s34, 2
    s_lshl_b32 s32, s32, 14
    s_add_u32 s32, s32, s44
    s_nop 0
    s_add_u32 s32, s32, 8192
    s_add_u32 s33, s32, 4096
    buffer_load_dwordx4 v[208:211], v20, s[8:11], s32 offen offset:3072 sc1
    buffer_load_dwordx4 v[212:215], v30, s[8:11], s32 offen offset:3072 sc1
    buffer_load_dwordx4 v[216:219], v20, s[8:11], s33 offen offset:3072 sc1
    buffer_load_dwordx4 v[220:223], v30, s[8:11], s33 offen offset:3072 sc1
    s_xor_b32 s32, s34, 3
    s_lshl_b32 s32, s32, 14
    s_add_u32 s32, s32, s44
    s_nop 0
    s_add_u32 s32, s32, 8192
    s_add_u32 s33, s32, 4096
    buffer_load_dwordx4 v[160:163], v20, s[8:11], s32 offen offset:0 sc1
    buffer_load_dwordx4 v[164:167], v30, s[8:11], s32 offen offset:0 sc1
    buffer_load_dwordx4 v[168:171], v20, s[8:11], s33 offen offset:0 sc1
    buffer_load_dwordx4 v[172:175], v30, s[8:11], s33 offen offset:0 sc1
    s_waitcnt vmcnt(8)
    v_lshlrev_b32 v64, 16, v192
    v_and_b32 v65, 0xffff0000, v192
    v_pk_fma_f32 v[32:33], v[64:65], v[224:225], v[32:33]
    v_lshlrev_b32_e64 v66, 16, v193
    v_and_b32 v67, 0xffff0000, v193
    v_pk_fma_f32 v[34:35], v[66:67], v[226:227], v[34:35]
    v_lshlrev_b32_e64 v68, 16, v194
    v_and_b32 v69, 0xffff0000, v194
    v_pk_fma_f32 v[36:37], v[68:69], v[228:229], v[36:37]
    v_lshlrev_b32_e64 v70, 16, v195
    v_and_b32 v71, 0xffff0000, v195
    v_pk_fma_f32 v[38:39], v[70:71], v[230:231], v[38:39]
    v_lshlrev_b32_e64 v72, 16, v196
    v_and_b32 v73, 0xffff0000, v196
    v_pk_fma_f32 v[40:41], v[72:73], v[232:233], v[40:41]
    v_lshlrev_b32_e64 v74, 16, v197
    v_and_b32 v75, 0xffff0000, v197
    v_pk_fma_f32 v[42:43], v[74:75], v[234:235], v[42:43]
    v_lshlrev_b32_e64 v76, 16, v198
    v_and_b32 v77, 0xffff0000, v198
    v_pk_fma_f32 v[44:45], v[76:77], v[236:237], v[44:45]
    v_lshlrev_b32_e64 v78, 16, v199
    v_and_b32 v79, 0xffff0000, v199
    v_pk_fma_f32 v[46:47], v[78:79], v[238:239], v[46:47]
    v_lshlrev_b32_e64 v64, 16, v200
    v_and_b32 v65, 0xffff0000, v200
    v_pk_fma_f32 v[48:49], v[64:65], v[240:241], v[48:49]
    v_lshlrev_b32_e64 v66, 16, v201
    v_and_b32 v67, 0xffff0000, v201
    v_pk_fma_f32 v[50:51], v[66:67], v[242:243], v[50:51]
    v_lshlrev_b32_e64 v68, 16, v202
    v_and_b32 v69, 0xffff0000, v202
    v_pk_fma_f32 v[52:53], v[68:69], v[244:245], v[52:53]
    v_lshlrev_b32_e64 v70, 16, v203
    v_and_b32 v71, 0xffff0000, v203
    v_pk_fma_f32 v[54:55], v[70:71], v[246:247], v[54:55]
    v_lshlrev_b32_e64 v72, 16, v204
    v_and_b32 v73, 0xffff0000, v204
    v_pk_fma_f32 v[56:57], v[72:73], v[248:249], v[56:57]
    v_lshlrev_b32_e64 v74, 16, v205
    v_and_b32 v75, 0xffff0000, v205
    v_pk_fma_f32 v[58:59], v[74:75], v[250:251], v[58:59]
    v_lshlrev_b32_e64 v76, 16, v206
    v_and_b32 v77, 0xffff0000, v206
    v_pk_fma_f32 v[60:61], v[76:77], v[252:253], v[60:61]
    v_lshlrev_b32_e64 v78, 16, v207
    v_and_b32 v79, 0xffff0000, v207
    v_pk_fma_f32 v[62:63], v[78:79], v[254:255], v[62:63]
    s_waitcnt vmcnt(4)
    v_lshlrev_b32 v64, 16, v208
    v_and_b32 v65, 0xffff0000, v208
    v_pk_fma_f32 v[32:33], v[64:65], v[224:225], v[32:33]
    v_lshlrev_b32_e64 v66, 16, v209
    v_and_b32 v67, 0xffff0000, v209
    v_pk_fma_f32 v[34:35], v[66:67], v[226:227], v[34:35]
    v_lshlrev_b32_e64 v68, 16, v210
    v_and_b32 v69, 0xffff0000, v210
    v_pk_fma_f32 v[36:37], v[68:69], v[228:229], v[36:37]
    v_lshlrev_b32_e64 v70, 16, v211
    v_and_b32 v71, 0xffff0000, v211
    v_pk_fma_f32 v[38:39], v[70:71], v[230:231], v[38:39]
    v_lshlrev_b32_e64 v72, 16, v212
    v_and_b32 v73, 0xffff0000, v212
    v_pk_fma_f32 v[40:41], v[72:73], v[232:233], v[40:41]
    v_lshlrev_b32_e64 v74, 16, v213
    v_and_b32 v75, 0xffff0000, v213
    v_pk_fma_f32 v[42:43], v[74:75], v[234:235], v[42:43]
    v_lshlrev_b32_e64 v76, 16, v214
    v_and_b32 v77, 0xffff0000, v214
    v_pk_fma_f32 v[44:45], v[76:77], v[236:237], v[44:45]
    v_lshlrev_b32_e64 v78, 16, v215
    v_and_b32 v79, 0xffff0000, v215
    v_pk_fma_f32 v[46:47], v[78:79], v[238:239], v[46:47]
    v_lshlrev_b32_e64 v64, 16, v216
    v_and_b32 v65, 0xffff0000, v216
    v_pk_fma_f32 v[48:49], v[64:65], v[240:241], v[48:49]
    v_lshlrev_b32_e64 v66, 16, v217
    v_and_b32 v67, 0xffff0000, v217
    v_pk_fma_f32 v[50:51], v[66:67], v[242:243], v[50:51]
    v_lshlrev_b32_e64 v68, 16, v218
    v_and_b32 v69, 0xffff0000, v218
    v_pk_fma_f32 v[52:53], v[68:69], v[244:245], v[52:53]
    v_lshlrev_b32_e64 v70, 16, v219
    v_and_b32 v71, 0xffff0000, v219
    v_pk_fma_f32 v[54:55], v[70:71], v[246:247], v[54:55]
    v_lshlrev_b32_e64 v72, 16, v220
    v_and_b32 v73, 0xffff0000, v220
    v_pk_fma_f32 v[56:57], v[72:73], v[248:249], v[56:57]
    v_lshlrev_b32_e64 v74, 16, v221
    v_and_b32 v75, 0xffff0000, v221
    v_pk_fma_f32 v[58:59], v[74:75], v[250:251], v[58:59]
    v_lshlrev_b32_e64 v76, 16, v222
    v_and_b32 v77, 0xffff0000, v222
    v_pk_fma_f32 v[60:61], v[76:77], v[252:253], v[60:61]
    v_lshlrev_b32_e64 v78, 16, v223
    v_and_b32 v79, 0xffff0000, v223
    v_pk_fma_f32 v[62:63], v[78:79], v[254:255], v[62:63]
    s_waitcnt vmcnt(0)
    v_lshlrev_b32 v64, 16, v160
    v_and_b32 v65, 0xffff0000, v160
    v_pk_fma_f32 v[32:33], v[64:65], v[224:225], v[32:33]
    v_lshlrev_b32_e64 v66, 16, v161
    v_and_b32 v67, 0xffff0000, v161
    v_pk_fma_f32 v[34:35], v[66:67], v[226:227], v[34:35]
    v_lshlrev_b32_e64 v68, 16, v162
    v_and_b32 v69, 0xffff0000, v162
    v_pk_fma_f32 v[36:37], v[68:69], v[228:229], v[36:37]
    v_lshlrev_b32_e64 v70, 16, v163
    v_and_b32 v71, 0xffff0000, v163
    v_pk_fma_f32 v[38:39], v[70:71], v[230:231], v[38:39]
    v_lshlrev_b32_e64 v72, 16, v164
    v_and_b32 v73, 0xffff0000, v164
    v_pk_fma_f32 v[40:41], v[72:73], v[232:233], v[40:41]
    v_lshlrev_b32_e64 v74, 16, v165
    v_and_b32 v75, 0xffff0000, v165
    v_pk_fma_f32 v[42:43], v[74:75], v[234:235], v[42:43]
    v_lshlrev_b32_e64 v76, 16, v166
    v_and_b32 v77, 0xffff0000, v166
    v_pk_fma_f32 v[44:45], v[76:77], v[236:237], v[44:45]
    v_lshlrev_b32_e64 v78, 16, v167
    v_and_b32 v79, 0xffff0000, v167
    v_pk_fma_f32 v[46:47], v[78:79], v[238:239], v[46:47]
    v_lshlrev_b32_e64 v64, 16, v168
    v_and_b32 v65, 0xffff0000, v168
    v_pk_fma_f32 v[48:49], v[64:65], v[240:241], v[48:49]
    v_lshlrev_b32_e64 v66, 16, v169
    v_and_b32 v67, 0xffff0000, v169
    v_pk_fma_f32 v[50:51], v[66:67], v[242:243], v[50:51]
    v_lshlrev_b32_e64 v68, 16, v170
    v_and_b32 v69, 0xffff0000, v170
    v_pk_fma_f32 v[52:53], v[68:69], v[244:245], v[52:53]
    v_lshlrev_b32_e64 v70, 16, v171
    v_and_b32 v71, 0xffff0000, v171
    v_pk_fma_f32 v[54:55], v[70:71], v[246:247], v[54:55]
    v_lshlrev_b32_e64 v72, 16, v172
    v_and_b32 v73, 0xffff0000, v172
    v_pk_fma_f32 v[56:57], v[72:73], v[248:249], v[56:57]
    v_lshlrev_b32_e64 v74, 16, v173
    v_and_b32 v75, 0xffff0000, v173
    v_pk_fma_f32 v[58:59], v[74:75], v[250:251], v[58:59]
    v_lshlrev_b32_e64 v76, 16, v174
    v_and_b32 v77, 0xffff0000, v174
    v_pk_fma_f32 v[60:61], v[76:77], v[252:253], v[60:61]
    v_lshlrev_b32_e64 v78, 16, v175
    v_and_b32 v79, 0xffff0000, v175
    v_pk_fma_f32 v[62:63], v[78:79], v[254:255], v[62:63]
    v_cvt_pk_bf16_f32 v32, v32, v33
    v_cvt_pk_bf16_f32 v33, v34, v35
    v_cvt_pk_bf16_f32 v34, v48, v49
    v_cvt_pk_bf16_f32 v35, v50, v51
    s_nop 0
    v_permlane32_swap_b32 v32, v34
    v_permlane32_swap_b32 v33, v35
    s_nop 0
    v_permlane16_swap_b32 v32, v34
    v_permlane16_swap_b32 v33, v35
    buffer_store_dwordx4 v[32:35], v22, s[12:15], s46 offen
    v_cvt_pk_bf16_f32 v36, v36, v37
    v_cvt_pk_bf16_f32 v37, v38, v39
    v_cvt_pk_bf16_f32 v38, v52, v53
    v_cvt_pk_bf16_f32 v39, v54, v55
    s_nop 0
    v_permlane32_swap_b32 v36, v38
    v_permlane32_swap_b32 v37, v39
    s_nop 0
    v_permlane16_swap_b32 v36, v38
    v_permlane16_swap_b32 v37, v39
    buffer_store_dwordx4 v[36:39], v22, s[12:15], s47 offen
    v_cvt_pk_bf16_f32 v40, v40, v41
    v_cvt_pk_bf16_f32 v41, v42, v43
    v_cvt_pk_bf16_f32 v42, v56, v57
    v_cvt_pk_bf16_f32 v43, v58, v59
    s_nop 0
    v_permlane32_swap_b32 v40, v42
    v_permlane32_swap_b32 v41, v43
    s_nop 0
    v_permlane16_swap_b32 v40, v42
    v_permlane16_swap_b32 v41, v43
    buffer_store_dwordx4 v[40:43], v22, s[12:15], s48 offen
    v_cvt_pk_bf16_f32 v44, v44, v45
    v_cvt_pk_bf16_f32 v45, v46, v47
    v_cvt_pk_bf16_f32 v46, v60, v61
    v_cvt_pk_bf16_f32 v47, v62, v63
    s_nop 0
    v_permlane32_swap_b32 v44, v46
    v_permlane32_swap_b32 v45, v47
    s_nop 0
    v_permlane16_swap_b32 v44, v46
    v_permlane16_swap_b32 v45, v47
    buffer_store_dwordx4 v[44:47], v22, s[12:15], s49 offen
L_fin:
L_end:
    s_endpgm
L_sigh:
    s_waitcnt vmcnt(10)
    s_mov_b64 exec, 1
    buffer_store_dword v17, v16, s[8:11], s55 offen sc1
    s_mov_b64 exec, -1
    s_branch L_sigh_ret
L_st00:
    buffer_store_dwordx4 v[160:163], v20, s[8:11], s32 offen offset:0 sc1
    s_branch L_st00_ret
L_st01:
    buffer_store_dwordx4 v[164:167], v30, s[8:11], s32 offen offset:0 sc1
    s_branch L_st01_ret
L_st02:
    buffer_store_dwordx4 v[168:171], v20, s[8:11], s33 offen offset:0 sc1
    s_branch L_st02_ret
L_st03:
    buffer_store_dwordx4 v[172:175], v30, s[8:11], s33 offen offset:0 sc1
    s_branch L_st03_ret
L_st10:
    buffer_store_dwordx4 v[176:179], v20, s[8:11], s32 offen offset:1024 sc1
    s_branch L_st10_ret
L_st11:
    buffer_store_dwordx4 v[180:183], v30, s[8:11], s32 offen offset:1024 sc1
    s_branch L_st11_ret
L_st12:
    buffer_store_dwordx4 v[184:187], v20, s[8:11], s33 offen offset:1024 sc1
    s_branch L_st12_ret
L_st13:
    buffer_store_dwordx4 v[188:191], v30, s[8:11], s33 offen offset:1024 sc1
    s_branch L_st13_ret
L_st20:
    buffer_store_dwordx4 v[192:195], v20, s[8:11], s32 offen offset:2048 sc1
    s_branch L_st20_ret
L_st21:
    buffer_store_dwordx4 v[196:199], v30, s[8:11], s32 offen offset:2048 sc1
    s_branch L_st21_ret
L_st22:
    buffer_store_dwordx4 v[200:203], v20, s[8:11], s33 offen offset:2048 sc1
    s_branch L_st22_ret
L_st23:
    buffer_store_dwordx4 v[204:207], v30, s[8:11], s33 offen offset:2048 sc1
    s_branch L_st23_ret
L_st30:
    buffer_store_dwordx4 v[208:211], v20, s[8:11], s32 offen offset:3072 sc1
    s_branch L_st30_ret
L_st31:
    buffer_store_dwordx4 v[212:215], v30, s[8:11], s32 offen offset:3072 sc1
    s_branch L_st31_ret
L_st32:
    buffer_store_dwordx4 v[216:219], v20, s[8:11], s33 offen offset:3072 sc1
    s_branch L_st32_ret
L_st33:
    buffer_store_dwordx4 v[220:223], v30, s[8:11], s33 offen offset:3072 sc1
    s_branch L_st33_ret
L_special:
    s_cmp_lg_u32 s41, 1
    s_cbranch_scc1 L_spn1
    s_waitcnt vmcnt(12)
    s_mov_b64 exec, 1
    v_mov_b32 v23, 4096
    buffer_store_dword v17, v23, s[8:11], s55 offen sc1
    s_mov_b64 exec, -1
L_spn1:
    s_cmp_eq_u32 s41, 2
    s_cbranch_scc1 L_sp2
    s_cmp_eq_u32 s41, 4
    s_cbranch_scc0 L_special_ret
    s_waitcnt vmcnt(24)
    s_mov_b64 exec, 1
    buffer_store_dword v17, v24, s[8:11], s45 offen offset:0 sc1
    s_mov_b64 exec, -1
    s_branch L_special_ret
L_sp1:
    s_waitcnt vmcnt(12)
    s_mov_b64 exec, 1
    v_mov_b32 v23, 4096
    buffer_store_dword v17, v23, s[8:11], s55 offen sc1
    s_mov_b64 exec, -1
    s_branch L_sp1_ret
L_spw:
    s_mov_b32 s20, s70
    s_and_b32 s21, s71, 0xffff
    s_mov_b32 s22, 8388608
    s_lshl_b32 s30, s34, 21
    s_branch L_spw_ret
L_sp2:
    v_cmp_ne_u32 vcc, 1, v19
    s_cbranch_vccz L_pollo_ok
    s_mov_b32 s60, 1048576
L_pollo:
    buffer_load_dword v19, v18, s[8:11], s43 offen sc1
    s_sub_u32 s60, s60, 1
    s_cbranch_scc1 L_pollo_ok
    s_waitcnt vmcnt(0)
    v_cmp_ne_u32 vcc, 1, v19
    s_cbranch_vccnz L_pollo
L_pollo_ok:
    s_lshl_b32 s28, s34, 15
    s_add_u32 s28, s28, 4194304
    s_add_u32 s52, s28, 0x40000
    v_and_b32 v18, 3, v0
    v_lshlrev_b32 v18, 2, v18
    s_mov_b32 s43, s45
    s_branch L_special_ret
L_switch:
    v_mov_b64 v[224:225], v[32:33]
    v_mov_b64 v[32:33], 0
    v_mov_b64 v[226:227], v[34:35]
    v_mov_b64 v[34:35], 0
    v_mov_b64 v[228:229], v[36:37]
    v_mov_b64 v[36:37], 0
    v_mov_b64 v[230:231], v[38:39]
    v_mov_b64 v[38:39], 0
    v_mov_b64 v[232:233], v[40:41]
    v_mov_b64 v[40:41], 0
    v_mov_b64 v[234:235], v[42:43]
    v_mov_b64 v[42:43], 0
    v_mov_b64 v[236:237], v[44:45]
    v_mov_b64 v[44:45], 0
    v_mov_b64 v[238:239], v[46:47]
    v_mov_b64 v[46:47], 0
    v_mov_b64 v[240:241], v[48:49]
    v_mov_b64 v[48:49], 0
    v_mov_b64 v[242:243], v[50:51]
    v_mov_b64 v[50:51], 0
    v_mov_b64 v[244:245], v[52:53]
    v_mov_b64 v[52:53], 0
    v_mov_b64 v[246:247], v[54:55]
    v_mov_b64 v[54:55], 0
    v_mov_b64 v[248:249], v[56:57]
    v_mov_b64 v[56:57], 0
    v_mov_b64 v[250:251], v[58:59]
    v_mov_b64 v[58:59], 0
    v_mov_b64 v[252:253], v[60:61]
    v_mov_b64 v[60:61], 0
    v_mov_b64 v[254:255], v[62:63]
    v_mov_b64_e64 v[62:63], 0
    v_cvt_pk_bf16_f32 v192, v64, v65
    v_mov_b64_e64 v[64:65], 0
    v_cvt_pk_bf16_f32 v193, v66, v67
    v_mov_b64_e64 v[66:67], 0
    v_cvt_pk_bf16_f32 v194, v68, v69
    v_mov_b64_e64 v[68:69], 0
    v_cvt_pk_bf16_f32 v195, v70, v71
    v_mov_b64_e64 v[70:71], 0
    v_cvt_pk_bf16_f32 v196, v72, v73
    v_mov_b64_e64 v[72:73], 0
    v_cvt_pk_bf16_f32 v197, v74, v75
    v_mov_b64_e64 v[74:75], 0
    v_cvt_pk_bf16_f32 v198, v76, v77
    v_mov_b64_e64 v[76:77], 0
    v_cvt_pk_bf16_f32 v199, v78, v79
    v_mov_b64_e64 v[78:79], 0
    v_cvt_pk_bf16_f32 v200, v80, v81
    v_mov_b64_e64 v[80:81], 0
    v_cvt_pk_bf16_f32 v201, v82, v83
    v_mov_b64_e64 v[82:83], 0
    v_cvt_pk_bf16_f32 v202, v84, v85
    v_mov_b64_e64 v[84:85], 0
    v_cvt_pk_bf16_f32 v203, v86, v87
    v_mov_b64_e64 v[86:87], 0
    v_cvt_pk_bf16_f32 v204, v88, v89
    v_mov_b64_e64 v[88:89], 0
    v_cvt_pk_bf16_f32 v205, v90, v91
    v_mov_b64_e64 v[90:91], 0
    v_cvt_pk_bf16_f32 v206, v92, v93
    v_mov_b64_e64 v[92:93], 0
    v_cvt_pk_bf16_f32 v207, v94, v95
    v_mov_b64_e64 v[94:95], 0
    v_cvt_pk_bf16_f32 v208, v96, v97
    v_mov_b64_e64 v[96:97], 0
    v_cvt_pk_bf16_f32 v209, v98, v99
    v_mov_b64_e64 v[98:99], 0
    v_cvt_pk_bf16_f32 v210, v100, v101
    v_mov_b64_e64 v[100:101], 0
    v_cvt_pk_bf16_f32 v211, v102, v103
    v_mov_b64_e64 v[102:103], 0
    v_cvt_pk_bf16_f32 v212, v104, v105
    v_mov_b64_e64 v[104:105], 0
    v_cvt_pk_bf16_f32 v213, v106, v107
    v_mov_b64_e64 v[106:107], 0
    v_cvt_pk_bf16_f32 v214, v108, v109
    v_mov_b64_e64 v[108:109], 0
    v_cvt_pk_bf16_f32 v215, v110, v111
    v_mov_b64_e64 v[110:111], 0
    v_cvt_pk_bf16_f32 v216, v112, v113
    v_mov_b64_e64 v[112:113], 0
    v_cvt_pk_bf16_f32 v217, v114, v115
    v_mov_b64_e64 v[114:115], 0
    v_cvt_pk_bf16_f32 v218, v116, v117
    v_mov_b64_e64 v[116:117], 0
    v_cvt_pk_bf16_f32 v219, v118, v119
    v_mov_b64_e64 v[118:119], 0
    v_cvt_pk_bf16_f32 v220, v120, v121
    v_mov_b64_e64 v[120:121], 0
    v_cvt_pk_bf16_f32 v221, v122, v123
    v_mov_b64_e64 v[122:123], 0
    v_cvt_pk_bf16_f32 v222, v124, v125
    v_mov_b64_e64 v[124:125], 0
    v_cvt_pk_bf16_f32 v223, v126, v127
    v_mov_b64_e64 v[126:127], 0
    v_cvt_pk_bf16_f32 v160, v128, v129
    v_mov_b64_e64 v[128:129], 0
    v_cvt_pk_bf16_f32 v161, v130, v131
    v_mov_b64_e64 v[130:131], 0
    v_cvt_pk_bf16_f32 v162, v132, v133
    v_mov_b64_e64 v[132:133], 0
    v_cvt_pk_bf16_f32 v163, v134, v135
    v_mov_b64_e64 v[134:135], 0
    v_cvt_pk_bf16_f32 v164, v136, v137
    v_mov_b64_e64 v[136:137], 0
    v_cvt_pk_bf16_f32 v165, v138, v139
    v_mov_b64_e64 v[138:139], 0
    v_cvt_pk_bf16_f32 v166, v140, v141
    v_mov_b64_e64 v[140:141], 0
    v_cvt_pk_bf16_f32 v167, v142, v143
    v_mov_b64_e64 v[142:143], 0
    v_cvt_pk_bf16_f32 v168, v144, v145
    v_mov_b64_e64 v[144:145], 0
    v_cvt_pk_bf16_f32 v169, v146, v147
    v_mov_b64_e64 v[146:147], 0
    v_cvt_pk_bf16_f32 v170, v148, v149
    v_mov_b64_e64 v[148:149], 0
    v_cvt_pk_bf16_f32 v171, v150, v151
    v_mov_b64_e64 v[150:151], 0
    v_cvt_pk_bf16_f32 v172, v152, v153
    v_mov_b64_e64 v[152:153], 0
    v_cvt_pk_bf16_f32 v173, v154, v155
    v_mov_b64_e64 v[154:155], 0
    v_cvt_pk_bf16_f32 v174, v156, v157
    v_mov_b64_e64 v[156:157], 0
    v_cvt_pk_bf16_f32 v175, v158, v159
    v_mov_b64 v[158:159], 0
    s_xor_b32 s32, s34, 0
    s_lshl_b32 s32, s32, 14
    s_add_u32 s32, s32, s44
    s_add_u32 s33, s32, 4096
    s_mov_b64 vcc, -1
    s_mov_b32 s53, 0xff00
    s_branch L_switch_ret
L_slow1_6:
    v_max3_f32 v250, v176, v177, v178
    v_max3_f32 v251, v179, v180, v181
    v_max3_f32 v250, v250, v182, v183
    v_max_f32 v250, v250, v251
    v_mov_b32 v251, v250
    s_nop 1
    v_permlane16_swap_b32 v250, v251
    v_max_f32 v250, v250, v251
    v_mov_b32 v251, v250
    s_nop 1
    v_permlane32_swap_b32 v250, v251
    v_max_f32_e64 v250, v250, v251
    v_add_f32 v250, 0x41800000, v250
    v_max_f32 v250, 0, v250
    v_sub_f32 v250, 0, v250
    v_mov_b32 v251, v250
    v_exp_f32 v240, v250
    v_pk_add_f32 v[176:177], v[176:177], v[250:251]
    v_pk_add_f32 v[178:179], v[178:179], v[250:251]
    v_pk_add_f32 v[180:181], v[180:181], v[250:251]
    v_pk_add_f32 v[182:183], v[182:183], v[250:251]
    v_pk_add_f32 v[200:201], v[200:201], v[250:251]
    v_pk_add_f32 v[202:203], v[202:203], v[250:251]
    v_mov_b32 v250, v240
    v_mov_b32 v251, v240
    v_pk_mul_f32 v[216:217], v[216:217], v[250:251]
    v_pk_mul_f32 v[218:219], v[218:219], v[250:251]
    v_pk_mul_f32 v[40:41], v[40:41], v[250:251]
    v_pk_mul_f32 v[42:43], v[42:43], v[250:251]
    v_pk_mul_f32 v[56:57], v[56:57], v[250:251]
    v_pk_mul_f32 v[58:59], v[58:59], v[250:251]
    v_pk_mul_f32 v[72:73], v[72:73], v[250:251]
    v_pk_mul_f32 v[74:75], v[74:75], v[250:251]
    v_pk_mul_f32 v[88:89], v[88:89], v[250:251]
    v_pk_mul_f32 v[90:91], v[90:91], v[250:251]
    v_pk_mul_f32 v[104:105], v[104:105], v[250:251]
    v_pk_mul_f32 v[106:107], v[106:107], v[250:251]
    v_pk_mul_f32 v[120:121], v[120:121], v[250:251]
    v_pk_mul_f32 v[122:123], v[122:123], v[250:251]
    v_pk_mul_f32 v[136:137], v[136:137], v[250:251]
    v_pk_mul_f32 v[138:139], v[138:139], v[250:251]
    v_pk_mul_f32 v[152:153], v[152:153], v[250:251]
    v_pk_mul_f32 v[154:155], v[154:155], v[250:251]
    v_max3_f32 v252, v184, v185, v186
    v_max3_f32 v253, v187, v188, v189
    v_max3_f32 v252, v252, v190, v191
    v_max_f32 v252, v252, v253
    v_mov_b32 v253, v252
    s_nop 1
    v_permlane16_swap_b32 v252, v253
    v_max_f32 v252, v252, v253
    v_mov_b32 v253, v252
    s_nop 1
    v_permlane32_swap_b32 v252, v253
    v_max_f32_e64 v252, v252, v253
    v_add_f32 v252, 0x41800000, v252
    v_max_f32 v252, 0, v252
    v_sub_f32 v252, 0, v252
    v_mov_b32 v253, v252
    v_exp_f32 v240, v252
    v_pk_add_f32 v[184:185], v[184:185], v[252:253]
    v_pk_add_f32 v[186:187], v[186:187], v[252:253]
    v_pk_add_f32 v[188:189], v[188:189], v[252:253]
    v_pk_add_f32 v[190:191], v[190:191], v[252:253]
    v_pk_add_f32 v[204:205], v[204:205], v[252:253]
    v_pk_add_f32 v[206:207], v[206:207], v[252:253]
    v_mov_b32 v252, v240
    v_mov_b32 v253, v240
    v_pk_mul_f32 v[220:221], v[220:221], v[252:253]
    v_pk_mul_f32 v[222:223], v[222:223], v[252:253]
    v_pk_mul_f32 v[44:45], v[44:45], v[252:253]
    v_pk_mul_f32 v[46:47], v[46:47], v[252:253]
    v_pk_mul_f32 v[60:61], v[60:61], v[252:253]
    v_pk_mul_f32 v[62:63], v[62:63], v[252:253]
    v_pk_mul_f32 v[76:77], v[76:77], v[252:253]
    v_pk_mul_f32 v[78:79], v[78:79], v[252:253]
    v_pk_mul_f32 v[92:93], v[92:93], v[252:253]
    v_pk_mul_f32 v[94:95], v[94:95], v[252:253]
    v_pk_mul_f32 v[108:109], v[108:109], v[252:253]
    v_pk_mul_f32 v[110:111], v[110:111], v[252:253]
    v_pk_mul_f32 v[124:125], v[124:125], v[252:253]
    v_pk_mul_f32 v[126:127], v[126:127], v[252:253]
    v_pk_mul_f32 v[140:141], v[140:141], v[252:253]
    v_pk_mul_f32 v[142:143], v[142:143], v[252:253]
    v_pk_mul_f32 v[156:157], v[156:157], v[252:253]
    v_pk_mul_f32 v[158:159], v[158:159], v[252:253]
    v_exp_f32 v240, v176
    v_exp_f32 v241, v177
    v_exp_f32 v242, v178
    v_exp_f32 v243, v179
    v_cvt_pk_bf16_f32 v232, v240, v241
    v_exp_f32 v244, v180
    v_exp_f32 v245, v181
    v_cvt_pk_bf16_f32 v233, v242, v243
    v_exp_f32 v240, v182
    v_exp_f32 v241, v183
    v_cvt_pk_bf16_f32 v234, v244, v245
    v_exp_f32 v242, v184
    v_exp_f32 v243, v185
    v_cvt_pk_bf16_f32 v235, v240, v241
    v_exp_f32 v244, v186
    v_exp_f32 v245, v187
    v_cvt_pk_bf16_f32 v236, v242, v243
    v_exp_f32 v240, v188
    v_exp_f32 v241, v189
    v_cvt_pk_bf16_f32 v237, v244, v245
    v_exp_f32 v242, v190
    v_exp_f32 v243, v191
    v_cvt_pk_bf16_f32 v238, v240, v241
    s_nop 0
    v_cvt_pk_bf16_f32 v239, v242, v243
    s_branch L_slow1_6_ret
L_slow0_6:
    v_max3_f32 v250, v160, v161, v162
    v_max3_f32 v251, v163, v164, v165
    v_max3_f32 v250, v250, v166, v167
    v_max_f32 v250, v250, v251
    v_mov_b32 v251, v250
    s_nop 1
    v_permlane16_swap_b32 v250, v251
    v_max_f32 v250, v250, v251
    v_mov_b32 v251, v250
    s_nop 1
    v_permlane32_swap_b32 v250, v251
    v_max_f32_e64 v250, v250, v251
    v_add_f32 v250, 0x41800000, v250
    v_max_f32 v250, 0, v250
    v_sub_f32 v250, 0, v250
    v_mov_b32 v251, v250
    v_exp_f32 v240, v250
    v_pk_add_f32 v[160:161], v[160:161], v[250:251]
    v_pk_add_f32 v[162:163], v[162:163], v[250:251]
    v_pk_add_f32 v[164:165], v[164:165], v[250:251]
    v_pk_add_f32 v[166:167], v[166:167], v[250:251]
    v_pk_add_f32 v[192:193], v[192:193], v[250:251]
    v_pk_add_f32 v[194:195], v[194:195], v[250:251]
    v_mov_b32 v250, v240
    v_mov_b32 v251, v240
    v_pk_mul_f32 v[208:209], v[208:209], v[250:251]
    v_pk_mul_f32 v[210:211], v[210:211], v[250:251]
    v_pk_mul_f32 v[32:33], v[32:33], v[250:251]
    v_pk_mul_f32 v[34:35], v[34:35], v[250:251]
    v_pk_mul_f32 v[48:49], v[48:49], v[250:251]
    v_pk_mul_f32 v[50:51], v[50:51], v[250:251]
    v_pk_mul_f32 v[64:65], v[64:65], v[250:251]
    v_pk_mul_f32 v[66:67], v[66:67], v[250:251]
    v_pk_mul_f32 v[80:81], v[80:81], v[250:251]
    v_pk_mul_f32 v[82:83], v[82:83], v[250:251]
    v_pk_mul_f32 v[96:97], v[96:97], v[250:251]
    v_pk_mul_f32 v[98:99], v[98:99], v[250:251]
    v_pk_mul_f32 v[112:113], v[112:113], v[250:251]
    v_pk_mul_f32 v[114:115], v[114:115], v[250:251]
    v_pk_mul_f32 v[128:129], v[128:129], v[250:251]
    v_pk_mul_f32 v[130:131], v[130:131], v[250:251]
    v_pk_mul_f32 v[144:145], v[144:145], v[250:251]
    v_pk_mul_f32 v[146:147], v[146:147], v[250:251]
    v_max3_f32 v252, v168, v169, v170
    v_max3_f32 v253, v171, v172, v173
    v_max3_f32 v252, v252, v174, v175
    v_max_f32 v252, v252, v253
    v_mov_b32 v253, v252
    s_nop 1
    v_permlane16_swap_b32 v252, v253
    v_max_f32 v252, v252, v253
    v_mov_b32 v253, v252
    s_nop 1
    v_permlane32_swap_b32 v252, v253
    v_max_f32_e64 v252, v252, v253
    v_add_f32 v252, 0x41800000, v252
    v_max_f32 v252, 0, v252
    v_sub_f32 v252, 0, v252
    v_mov_b32 v253, v252
    v_exp_f32 v240, v252
    v_pk_add_f32 v[168:169], v[168:169], v[252:253]
    v_pk_add_f32 v[170:171], v[170:171], v[252:253]
    v_pk_add_f32 v[172:173], v[172:173], v[252:253]
    v_pk_add_f32 v[174:175], v[174:175], v[252:253]
    v_pk_add_f32 v[196:197], v[196:197], v[252:253]
    v_pk_add_f32 v[198:199], v[198:199], v[252:253]
    v_mov_b32 v252, v240
    v_mov_b32 v253, v240
    v_pk_mul_f32 v[212:213], v[212:213], v[252:253]
    v_pk_mul_f32 v[214:215], v[214:215], v[252:253]
    v_pk_mul_f32 v[36:37], v[36:37], v[252:253]
    v_pk_mul_f32 v[38:39], v[38:39], v[252:253]
    v_pk_mul_f32 v[52:53], v[52:53], v[252:253]
    v_pk_mul_f32 v[54:55], v[54:55], v[252:253]
    v_pk_mul_f32 v[68:69], v[68:69], v[252:253]
    v_pk_mul_f32 v[70:71], v[70:71], v[252:253]
    v_pk_mul_f32 v[84:85], v[84:85], v[252:253]
    v_pk_mul_f32 v[86:87], v[86:87], v[252:253]
    v_pk_mul_f32 v[100:101], v[100:101], v[252:253]
    v_pk_mul_f32 v[102:103], v[102:103], v[252:253]
    v_pk_mul_f32 v[116:117], v[116:117], v[252:253]
    v_pk_mul_f32 v[118:119], v[118:119], v[252:253]
    v_pk_mul_f32 v[132:133], v[132:133], v[252:253]
    v_pk_mul_f32 v[134:135], v[134:135], v[252:253]
    v_pk_mul_f32 v[148:149], v[148:149], v[252:253]
    v_pk_mul_f32 v[150:151], v[150:151], v[252:253]
    v_exp_f32 v240, v160
    v_exp_f32 v241, v161
    v_exp_f32 v242, v162
    v_exp_f32 v243, v163
    v_cvt_pk_bf16_f32 v224, v240, v241
    v_exp_f32 v244, v164
    v_exp_f32 v245, v165
    v_cvt_pk_bf16_f32 v225, v242, v243
    v_exp_f32 v240, v166
    v_exp_f32 v241, v167
    v_cvt_pk_bf16_f32 v226, v244, v245
    v_exp_f32 v242, v168
    v_exp_f32 v243, v169
    v_cvt_pk_bf16_f32 v227, v240, v241
    v_exp_f32 v244, v170
    v_exp_f32 v245, v171
    v_cvt_pk_bf16_f32 v228, v242, v243
    v_exp_f32 v240, v172
    v_exp_f32 v241, v173
    v_cvt_pk_bf16_f32 v229, v244, v245
    v_exp_f32 v242, v174
    v_exp_f32 v243, v175
    v_cvt_pk_bf16_f32 v230, v240, v241
    s_nop 0
    v_cvt_pk_bf16_f32 v231, v242, v243
    s_branch L_slow0_6_ret
L_slow1_7:
    v_max3_f32 v250, v176, v177, v178
    v_max3_f32 v251, v179, v180, v181
    v_max3_f32 v250, v250, v182, v183
    v_max_f32 v250, v250, v251
    v_mov_b32 v251, v250
    s_nop 1
    v_permlane16_swap_b32 v250, v251
    v_max_f32 v250, v250, v251
    v_mov_b32 v251, v250
    s_nop 1
    v_permlane32_swap_b32 v250, v251
    v_max_f32_e64 v250, v250, v251
    v_add_f32 v250, 0x41800000, v250
    v_max_f32 v250, 0, v250
    v_sub_f32 v250, 0, v250
    v_mov_b32 v251, v250
    v_exp_f32 v240, v250
    v_pk_add_f32 v[176:177], v[176:177], v[250:251]
    v_pk_add_f32 v[178:179], v[178:179], v[250:251]
    v_pk_add_f32 v[180:181], v[180:181], v[250:251]
    v_pk_add_f32 v[182:183], v[182:183], v[250:251]
    v_pk_add_f32 v[200:201], v[200:201], v[250:251]
    v_pk_add_f32 v[202:203], v[202:203], v[250:251]
    v_mov_b32 v250, v240
    v_mov_b32 v251, v240
    v_pk_mul_f32 v[216:217], v[216:217], v[250:251]
    v_pk_mul_f32 v[218:219], v[218:219], v[250:251]
    v_pk_mul_f32 v[40:41], v[40:41], v[250:251]
    v_pk_mul_f32 v[42:43], v[42:43], v[250:251]
    v_pk_mul_f32 v[56:57], v[56:57], v[250:251]
    v_pk_mul_f32 v[58:59], v[58:59], v[250:251]
    v_pk_mul_f32 v[72:73], v[72:73], v[250:251]
    v_pk_mul_f32 v[74:75], v[74:75], v[250:251]
    v_pk_mul_f32 v[88:89], v[88:89], v[250:251]
    v_pk_mul_f32 v[90:91], v[90:91], v[250:251]
    v_pk_mul_f32 v[104:105], v[104:105], v[250:251]
    v_pk_mul_f32 v[106:107], v[106:107], v[250:251]
    v_pk_mul_f32 v[120:121], v[120:121], v[250:251]
    v_pk_mul_f32 v[122:123], v[122:123], v[250:251]
    v_pk_mul_f32 v[136:137], v[136:137], v[250:251]
    v_pk_mul_f32 v[138:139], v[138:139], v[250:251]
    v_pk_mul_f32 v[152:153], v[152:153], v[250:251]
    v_pk_mul_f32 v[154:155], v[154:155], v[250:251]
    v_max3_f32 v252, v184, v185, v186
    v_max3_f32 v253, v187, v188, v189
    v_max3_f32 v252, v252, v190, v191
    v_max_f32 v252, v252, v253
    v_mov_b32 v253, v252
    s_nop 1
    v_permlane16_swap_b32 v252, v253
    v_max_f32 v252, v252, v253
    v_mov_b32 v253, v252
    s_nop 1
    v_permlane32_swap_b32 v252, v253
    v_max_f32_e64 v252, v252, v253
    v_add_f32 v252, 0x41800000, v252
    v_max_f32 v252, 0, v252
    v_sub_f32 v252, 0, v252
    v_mov_b32 v253, v252
    v_exp_f32 v240, v252
    v_pk_add_f32 v[184:185], v[184:185], v[252:253]
    v_pk_add_f32 v[186:187], v[186:187], v[252:253]
    v_pk_add_f32 v[188:189], v[188:189], v[252:253]
    v_pk_add_f32 v[190:191], v[190:191], v[252:253]
    v_pk_add_f32 v[204:205], v[204:205], v[252:253]
    v_pk_add_f32 v[206:207], v[206:207], v[252:253]
    v_mov_b32 v252, v240
    v_mov_b32 v253, v240
    v_pk_mul_f32 v[220:221], v[220:221], v[252:253]
    v_pk_mul_f32 v[222:223], v[222:223], v[252:253]
    v_pk_mul_f32 v[44:45], v[44:45], v[252:253]
    v_pk_mul_f32 v[46:47], v[46:47], v[252:253]
    v_pk_mul_f32 v[60:61], v[60:61], v[252:253]
    v_pk_mul_f32 v[62:63], v[62:63], v[252:253]
    v_pk_mul_f32 v[76:77], v[76:77], v[252:253]
    v_pk_mul_f32 v[78:79], v[78:79], v[252:253]
    v_pk_mul_f32 v[92:93], v[92:93], v[252:253]
    v_pk_mul_f32 v[94:95], v[94:95], v[252:253]
    v_pk_mul_f32 v[108:109], v[108:109], v[252:253]
    v_pk_mul_f32 v[110:111], v[110:111], v[252:253]
    v_pk_mul_f32 v[124:125], v[124:125], v[252:253]
    v_pk_mul_f32 v[126:127], v[126:127], v[252:253]
    v_pk_mul_f32 v[140:141], v[140:141], v[252:253]
    v_pk_mul_f32 v[142:143], v[142:143], v[252:253]
    v_pk_mul_f32 v[156:157], v[156:157], v[252:253]
    v_pk_mul_f32 v[158:159], v[158:159], v[252:253]
    v_exp_f32 v240, v176
    v_exp_f32 v241, v177
    v_exp_f32 v242, v178
    v_exp_f32 v243, v179
    v_cvt_pk_bf16_f32 v232, v240, v241
    v_exp_f32 v244, v180
    v_exp_f32 v245, v181
    v_cvt_pk_bf16_f32 v233, v242, v243
    v_exp_f32 v240, v182
    v_exp_f32 v241, v183
    v_cvt_pk_bf16_f32 v234, v244, v245
    v_exp_f32 v242, v184
    v_exp_f32 v243, v185
    v_cvt_pk_bf16_f32 v235, v240, v241
    v_exp_f32 v244, v186
    v_exp_f32 v245, v187
    v_cvt_pk_bf16_f32 v236, v242, v243
    v_exp_f32 v240, v188
    v_exp_f32 v241, v189
    v_cvt_pk_bf16_f32 v237, v244, v245
    v_exp_f32 v242, v190
    v_exp_f32 v243, v191
    v_cvt_pk_bf16_f32 v238, v240, v241
    s_nop 0
    v_cvt_pk_bf16_f32 v239, v242, v243
    s_branch L_slow1_7_ret
L_slow0_7:
    v_max3_f32 v250, v160, v161, v162
    v_max3_f32 v251, v163, v164, v165
    v_max3_f32 v250, v250, v166, v167
    v_max_f32 v250, v250, v251
    v_mov_b32 v251, v250
    s_nop 1
    v_permlane16_swap_b32 v250, v251
    v_max_f32 v250, v250, v251
    v_mov_b32 v251, v250
    s_nop 1
    v_permlane32_swap_b32 v250, v251
    v_max_f32_e64 v250, v250, v251
    v_add_f32 v250, 0x41800000, v250
    v_max_f32 v250, 0, v250
    v_sub_f32 v250, 0, v250
    v_mov_b32 v251, v250
    v_exp_f32 v240, v250
    v_pk_add_f32 v[160:161], v[160:161], v[250:251]
    v_pk_add_f32 v[162:163], v[162:163], v[250:251]
    v_pk_add_f32 v[164:165], v[164:165], v[250:251]
    v_pk_add_f32 v[166:167], v[166:167], v[250:251]
    v_pk_add_f32 v[192:193], v[192:193], v[250:251]
    v_pk_add_f32 v[194:195], v[194:195], v[250:251]
    v_mov_b32 v250, v240
    v_mov_b32 v251, v240
    v_pk_mul_f32 v[208:209], v[208:209], v[250:251]
    v_pk_mul_f32 v[210:211], v[210:211], v[250:251]
    v_pk_mul_f32 v[32:33], v[32:33], v[250:251]
    v_pk_mul_f32 v[34:35], v[34:35], v[250:251]
    v_pk_mul_f32 v[48:49], v[48:49], v[250:251]
    v_pk_mul_f32 v[50:51], v[50:51], v[250:251]
    v_pk_mul_f32 v[64:65], v[64:65], v[250:251]
    v_pk_mul_f32 v[66:67], v[66:67], v[250:251]
    v_pk_mul_f32 v[80:81], v[80:81], v[250:251]
    v_pk_mul_f32 v[82:83], v[82:83], v[250:251]
    v_pk_mul_f32 v[96:97], v[96:97], v[250:251]
    v_pk_mul_f32 v[98:99], v[98:99], v[250:251]
    v_pk_mul_f32 v[112:113], v[112:113], v[250:251]
    v_pk_mul_f32 v[114:115], v[114:115], v[250:251]
    v_pk_mul_f32 v[128:129], v[128:129], v[250:251]
    v_pk_mul_f32 v[130:131], v[130:131], v[250:251]
    v_pk_mul_f32 v[144:145], v[144:145], v[250:251]
    v_pk_mul_f32 v[146:147], v[146:147], v[250:251]
    v_max3_f32 v252, v168, v169, v170
    v_max3_f32 v253, v171, v172, v173
    v_max3_f32 v252, v252, v174, v175
    v_max_f32 v252, v252, v253
    v_mov_b32 v253, v252
    s_nop 1
    v_permlane16_swap_b32 v252, v253
    v_max_f32 v252, v252, v253
    v_mov_b32 v253, v252
    s_nop 1
    v_permlane32_swap_b32 v252, v253
    v_max_f32_e64 v252, v252, v253
    v_add_f32 v252, 0x41800000, v252
    v_max_f32 v252, 0, v252
    v_sub_f32 v252, 0, v252
    v_mov_b32 v253, v252
    v_exp_f32 v240, v252
    v_pk_add_f32 v[168:169], v[168:169], v[252:253]
    v_pk_add_f32 v[170:171], v[170:171], v[252:253]
    v_pk_add_f32 v[172:173], v[172:173], v[252:253]
    v_pk_add_f32 v[174:175], v[174:175], v[252:253]
    v_pk_add_f32 v[196:197], v[196:197], v[252:253]
    v_pk_add_f32 v[198:199], v[198:199], v[252:253]
    v_mov_b32 v252, v240
    v_mov_b32 v253, v240
    v_pk_mul_f32 v[212:213], v[212:213], v[252:253]
    v_pk_mul_f32 v[214:215], v[214:215], v[252:253]
    v_pk_mul_f32 v[36:37], v[36:37], v[252:253]
    v_pk_mul_f32 v[38:39], v[38:39], v[252:253]
    v_pk_mul_f32 v[52:53], v[52:53], v[252:253]
    v_pk_mul_f32 v[54:55], v[54:55], v[252:253]
    v_pk_mul_f32 v[68:69], v[68:69], v[252:253]
    v_pk_mul_f32 v[70:71], v[70:71], v[252:253]
    v_pk_mul_f32 v[84:85], v[84:85], v[252:253]
    v_pk_mul_f32 v[86:87], v[86:87], v[252:253]
    v_pk_mul_f32 v[100:101], v[100:101], v[252:253]
    v_pk_mul_f32 v[102:103], v[102:103], v[252:253]
    v_pk_mul_f32 v[116:117], v[116:117], v[252:253]
    v_pk_mul_f32 v[118:119], v[118:119], v[252:253]
    v_pk_mul_f32 v[132:133], v[132:133], v[252:253]
    v_pk_mul_f32 v[134:135], v[134:135], v[252:253]
    v_pk_mul_f32 v[148:149], v[148:149], v[252:253]
    v_pk_mul_f32 v[150:151], v[150:151], v[252:253]
    v_exp_f32 v240, v160
    v_exp_f32 v241, v161
    v_exp_f32 v242, v162
    v_exp_f32 v243, v163
    v_cvt_pk_bf16_f32 v224, v240, v241
    v_exp_f32 v244, v164
    v_exp_f32 v245, v165
    v_cvt_pk_bf16_f32 v225, v242, v243
    v_exp_f32 v240, v166
    v_exp_f32 v241, v167
    v_cvt_pk_bf16_f32 v226, v244, v245
    v_exp_f32 v242, v168
    v_exp_f32 v243, v169
    v_cvt_pk_bf16_f32 v227, v240, v241
    v_exp_f32 v244, v170
    v_exp_f32 v245, v171
    v_cvt_pk_bf16_f32 v228, v242, v243
    v_exp_f32 v240, v172
    v_exp_f32 v241, v173
    v_cvt_pk_bf16_f32 v229, v244, v245
    v_exp_f32 v242, v174
    v_exp_f32 v243, v175
    v_cvt_pk_bf16_f32 v230, v240, v241
    s_nop 0
    v_cvt_pk_bf16_f32 v231, v242, v243
    s_branch L_slow0_7_ret
L_slow1_1:
    v_max3_f32 v250, v176, v177, v178
    v_max3_f32 v251, v179, v180, v181
    v_max3_f32 v250, v250, v182, v183
    v_max_f32 v250, v250, v251
    v_mov_b32 v251, v250
    s_nop 1
    v_permlane16_swap_b32 v250, v251
    v_max_f32 v250, v250, v251
    v_mov_b32 v251, v250
    s_nop 1
    v_permlane32_swap_b32 v250, v251
    v_max_f32_e64 v250, v250, v251
    v_add_f32 v250, 0x41800000, v250
    v_max_f32 v250, 0, v250
    v_sub_f32 v250, 0, v250
    v_mov_b32 v251, v250
    v_exp_f32 v240, v250
    v_pk_add_f32 v[176:177], v[176:177], v[250:251]
    v_pk_add_f32 v[178:179], v[178:179], v[250:251]
    v_pk_add_f32 v[180:181], v[180:181], v[250:251]
    v_pk_add_f32 v[182:183], v[182:183], v[250:251]
    v_pk_add_f32 v[200:201], v[200:201], v[250:251]
    v_pk_add_f32 v[202:203], v[202:203], v[250:251]
    v_mov_b32 v250, v240
    v_mov_b32 v251, v240
    v_pk_mul_f32 v[216:217], v[216:217], v[250:251]
    v_pk_mul_f32 v[218:219], v[218:219], v[250:251]
    v_pk_mul_f32 v[40:41], v[40:41], v[250:251]
    v_pk_mul_f32 v[42:43], v[42:43], v[250:251]
    v_pk_mul_f32 v[56:57], v[56:57], v[250:251]
    v_pk_mul_f32 v[58:59], v[58:59], v[250:251]
    v_pk_mul_f32 v[72:73], v[72:73], v[250:251]
    v_pk_mul_f32 v[74:75], v[74:75], v[250:251]
    v_pk_mul_f32 v[88:89], v[88:89], v[250:251]
    v_pk_mul_f32 v[90:91], v[90:91], v[250:251]
    v_pk_mul_f32 v[104:105], v[104:105], v[250:251]
    v_pk_mul_f32 v[106:107], v[106:107], v[250:251]
    v_pk_mul_f32 v[120:121], v[120:121], v[250:251]
    v_pk_mul_f32 v[122:123], v[122:123], v[250:251]
    v_pk_mul_f32 v[136:137], v[136:137], v[250:251]
    v_pk_mul_f32 v[138:139], v[138:139], v[250:251]
    v_pk_mul_f32 v[152:153], v[152:153], v[250:251]
    v_pk_mul_f32 v[154:155], v[154:155], v[250:251]
    v_max3_f32 v252, v184, v185, v186
    v_max3_f32 v253, v187, v188, v189
    v_max3_f32 v252, v252, v190, v191
    v_max_f32 v252, v252, v253
    v_mov_b32 v253, v252
    s_nop 1
    v_permlane16_swap_b32 v252, v253
    v_max_f32 v252, v252, v253
    v_mov_b32 v253, v252
    s_nop 1
    v_permlane32_swap_b32 v252, v253
    v_max_f32_e64 v252, v252, v253
    v_add_f32 v252, 0x41800000, v252
    v_max_f32 v252, 0, v252
    v_sub_f32 v252, 0, v252
    v_mov_b32 v253, v252
    v_exp_f32 v240, v252
    v_pk_add_f32 v[184:185], v[184:185], v[252:253]
    v_pk_add_f32 v[186:187], v[186:187], v[252:253]
    v_pk_add_f32 v[188:189], v[188:189], v[252:253]
    v_pk_add_f32 v[190:191], v[190:191], v[252:253]
    v_pk_add_f32 v[204:205], v[204:205], v[252:253]
    v_pk_add_f32 v[206:207], v[206:207], v[252:253]
    v_mov_b32 v252, v240
    v_mov_b32 v253, v240
    v_pk_mul_f32 v[220:221], v[220:221], v[252:253]
    v_pk_mul_f32 v[222:223], v[222:223], v[252:253]
    v_pk_mul_f32 v[44:45], v[44:45], v[252:253]
    v_pk_mul_f32 v[46:47], v[46:47], v[252:253]
    v_pk_mul_f32 v[60:61], v[60:61], v[252:253]
    v_pk_mul_f32 v[62:63], v[62:63], v[252:253]
    v_pk_mul_f32 v[76:77], v[76:77], v[252:253]
    v_pk_mul_f32 v[78:79], v[78:79], v[252:253]
    v_pk_mul_f32 v[92:93], v[92:93], v[252:253]
    v_pk_mul_f32 v[94:95], v[94:95], v[252:253]
    v_pk_mul_f32 v[108:109], v[108:109], v[252:253]
    v_pk_mul_f32 v[110:111], v[110:111], v[252:253]
    v_pk_mul_f32 v[124:125], v[124:125], v[252:253]
    v_pk_mul_f32 v[126:127], v[126:127], v[252:253]
    v_pk_mul_f32 v[140:141], v[140:141], v[252:253]
    v_pk_mul_f32 v[142:143], v[142:143], v[252:253]
    v_pk_mul_f32 v[156:157], v[156:157], v[252:253]
    v_pk_mul_f32 v[158:159], v[158:159], v[252:253]
    v_exp_f32 v240, v176
    v_exp_f32 v241, v177
    v_exp_f32 v242, v178
    v_exp_f32 v243, v179
    v_cvt_pk_bf16_f32 v232, v240, v241
    v_exp_f32 v244, v180
    v_exp_f32 v245, v181
    v_cvt_pk_bf16_f32 v233, v242, v243
    v_exp_f32 v240, v182
    v_exp_f32 v241, v183
    v_cvt_pk_bf16_f32 v234, v244, v245
    v_exp_f32 v242, v184
    v_exp_f32 v243, v185
    v_cvt_pk_bf16_f32 v235, v240, v241
    v_exp_f32 v244, v186
    v_exp_f32 v245, v187
    v_cvt_pk_bf16_f32 v236, v242, v243
    v_exp_f32 v240, v188
    v_exp_f32 v241, v189
    v_cvt_pk_bf16_f32 v237, v244, v245
    v_exp_f32 v242, v190
    v_exp_f32 v243, v191
    v_cvt_pk_bf16_f32 v238, v240, v241
    s_nop 0
    v_cvt_pk_bf16_f32 v239, v242, v243
    s_branch L_slow1_1_ret
L_slow0_1:
    v_max3_f32 v250, v160, v161, v162
    v_max3_f32 v251, v163, v164, v165
    v_max3_f32 v250, v250, v166, v167
    v_max_f32 v250, v250, v251
    v_mov_b32 v251, v250
    s_nop 1
    v_permlane16_swap_b32 v250, v251
    v_max_f32 v250, v250, v251
    v_mov_b32 v251, v250
    s_nop 1
    v_permlane32_swap_b32 v250, v251
    v_max_f32_e64 v250, v250, v251
    v_add_f32 v250, 0x41800000, v250
    v_max_f32 v250, 0, v250
    v_sub_f32 v250, 0, v250
    v_mov_b32 v251, v250
    v_exp_f32 v240, v250
    v_pk_add_f32 v[160:161], v[160:161], v[250:251]
    v_pk_add_f32 v[162:163], v[162:163], v[250:251]
    v_pk_add_f32 v[164:165], v[164:165], v[250:251]
    v_pk_add_f32 v[166:167], v[166:167], v[250:251]
    v_pk_add_f32 v[192:193], v[192:193], v[250:251]
    v_pk_add_f32 v[194:195], v[194:195], v[250:251]
    v_mov_b32 v250, v240
    v_mov_b32 v251, v240
    v_pk_mul_f32 v[208:209], v[208:209], v[250:251]
    v_pk_mul_f32 v[210:211], v[210:211], v[250:251]
    v_pk_mul_f32 v[32:33], v[32:33], v[250:251]
    v_pk_mul_f32 v[34:35], v[34:35], v[250:251]
    v_pk_mul_f32 v[48:49], v[48:49], v[250:251]
    v_pk_mul_f32 v[50:51], v[50:51], v[250:251]
    v_pk_mul_f32 v[64:65], v[64:65], v[250:251]
    v_pk_mul_f32 v[66:67], v[66:67], v[250:251]
    v_pk_mul_f32 v[80:81], v[80:81], v[250:251]
    v_pk_mul_f32 v[82:83], v[82:83], v[250:251]
    v_pk_mul_f32 v[96:97], v[96:97], v[250:251]
    v_pk_mul_f32 v[98:99], v[98:99], v[250:251]
    v_pk_mul_f32 v[112:113], v[112:113], v[250:251]
    v_pk_mul_f32 v[114:115], v[114:115], v[250:251]
    v_pk_mul_f32 v[128:129], v[128:129], v[250:251]
    v_pk_mul_f32 v[130:131], v[130:131], v[250:251]
    v_pk_mul_f32 v[144:145], v[144:145], v[250:251]
    v_pk_mul_f32 v[146:147], v[146:147], v[250:251]
    v_max3_f32 v252, v168, v169, v170
    v_max3_f32 v253, v171, v172, v173
    v_max3_f32 v252, v252, v174, v175
    v_max_f32 v252, v252, v253
    v_mov_b32 v253, v252
    s_nop 1
    v_permlane16_swap_b32 v252, v253
    v_max_f32 v252, v252, v253
    v_mov_b32 v253, v252
    s_nop 1
    v_permlane32_swap_b32 v252, v253
    v_max_f32_e64 v252, v252, v253
    v_add_f32 v252, 0x41800000, v252
    v_max_f32 v252, 0, v252
    v_sub_f32 v252, 0, v252
    v_mov_b32 v253, v252
    v_exp_f32 v240, v252
    v_pk_add_f32 v[168:169], v[168:169], v[252:253]
    v_pk_add_f32 v[170:171], v[170:171], v[252:253]
    v_pk_add_f32 v[172:173], v[172:173], v[252:253]
    v_pk_add_f32 v[174:175], v[174:175], v[252:253]
    v_pk_add_f32 v[196:197], v[196:197], v[252:253]
    v_pk_add_f32 v[198:199], v[198:199], v[252:253]
    v_mov_b32 v252, v240
    v_mov_b32 v253, v240
    v_pk_mul_f32 v[212:213], v[212:213], v[252:253]
    v_pk_mul_f32 v[214:215], v[214:215], v[252:253]
    v_pk_mul_f32 v[36:37], v[36:37], v[252:253]
    v_pk_mul_f32 v[38:39], v[38:39], v[252:253]
    v_pk_mul_f32 v[52:53], v[52:53], v[252:253]
    v_pk_mul_f32 v[54:55], v[54:55], v[252:253]
    v_pk_mul_f32 v[68:69], v[68:69], v[252:253]
    v_pk_mul_f32 v[70:71], v[70:71], v[252:253]
    v_pk_mul_f32 v[84:85], v[84:85], v[252:253]
    v_pk_mul_f32 v[86:87], v[86:87], v[252:253]
    v_pk_mul_f32 v[100:101], v[100:101], v[252:253]
    v_pk_mul_f32 v[102:103], v[102:103], v[252:253]
    v_pk_mul_f32 v[116:117], v[116:117], v[252:253]
    v_pk_mul_f32 v[118:119], v[118:119], v[252:253]
    v_pk_mul_f32 v[132:133], v[132:133], v[252:253]
    v_pk_mul_f32 v[134:135], v[134:135], v[252:253]
    v_pk_mul_f32 v[148:149], v[148:149], v[252:253]
    v_pk_mul_f32 v[150:151], v[150:151], v[252:253]
    v_exp_f32 v240, v160
    v_exp_f32 v241, v161
    v_exp_f32 v242, v162
    v_exp_f32 v243, v163
    v_cvt_pk_bf16_f32 v224, v240, v241
    v_exp_f32 v244, v164
    v_exp_f32 v245, v165
    v_cvt_pk_bf16_f32 v225, v242, v243
    v_exp_f32 v240, v166
    v_exp_f32 v241, v167
    v_cvt_pk_bf16_f32 v226, v244, v245
    v_exp_f32 v242, v168
    v_exp_f32 v243, v169
    v_cvt_pk_bf16_f32 v227, v240, v241
    v_exp_f32 v244, v170
    v_exp_f32 v245, v171
    v_cvt_pk_bf16_f32 v228, v242, v243
    v_exp_f32 v240, v172
    v_exp_f32 v241, v173
    v_cvt_pk_bf16_f32 v229, v244, v245
    v_exp_f32 v242, v174
    v_exp_f32 v243, v175
    v_cvt_pk_bf16_f32 v230, v240, v241
    s_nop 0
    v_cvt_pk_bf16_f32 v231, v242, v243
    s_branch L_slow0_1_ret
L_slow1_2:
    v_max3_f32 v250, v176, v177, v178
    v_max3_f32 v251, v179, v180, v181
    v_max3_f32 v250, v250, v182, v183
    v_max_f32 v250, v250, v251
    v_mov_b32 v251, v250
    s_nop 1
    v_permlane16_swap_b32 v250, v251
    v_max_f32 v250, v250, v251
    v_mov_b32 v251, v250
    s_nop 1
    v_permlane32_swap_b32 v250, v251
    v_max_f32_e64 v250, v250, v251
    v_add_f32 v250, 0x41800000, v250
    v_max_f32 v250, 0, v250
    v_sub_f32 v250, 0, v250
    v_mov_b32 v251, v250
    v_exp_f32 v240, v250
    v_pk_add_f32 v[176:177], v[176:177], v[250:251]
    v_pk_add_f32 v[178:179], v[178:179], v[250:251]
    v_pk_add_f32 v[180:181], v[180:181], v[250:251]
    v_pk_add_f32 v[182:183], v[182:183], v[250:251]
    v_pk_add_f32 v[200:201], v[200:201], v[250:251]
    v_pk_add_f32 v[202:203], v[202:203], v[250:251]
    v_mov_b32 v250, v240
    v_mov_b32 v251, v240
    v_pk_mul_f32 v[216:217], v[216:217], v[250:251]
    v_pk_mul_f32 v[218:219], v[218:219], v[250:251]
    v_pk_mul_f32 v[40:41], v[40:41], v[250:251]
    v_pk_mul_f32 v[42:43], v[42:43], v[250:251]
    v_pk_mul_f32 v[56:57], v[56:57], v[250:251]
    v_pk_mul_f32 v[58:59], v[58:59], v[250:251]
    v_pk_mul_f32 v[72:73], v[72:73], v[250:251]
    v_pk_mul_f32 v[74:75], v[74:75], v[250:251]
    v_pk_mul_f32 v[88:89], v[88:89], v[250:251]
    v_pk_mul_f32 v[90:91], v[90:91], v[250:251]
    v_pk_mul_f32 v[104:105], v[104:105], v[250:251]
    v_pk_mul_f32 v[106:107], v[106:107], v[250:251]
    v_pk_mul_f32 v[120:121], v[120:121], v[250:251]
    v_pk_mul_f32 v[122:123], v[122:123], v[250:251]
    v_pk_mul_f32 v[136:137], v[136:137], v[250:251]
    v_pk_mul_f32 v[138:139], v[138:139], v[250:251]
    v_pk_mul_f32 v[152:153], v[152:153], v[250:251]
    v_pk_mul_f32 v[154:155], v[154:155], v[250:251]
    v_max3_f32 v252, v184, v185, v186
    v_max3_f32 v253, v187, v188, v189
    v_max3_f32 v252, v252, v190, v191
    v_max_f32 v252, v252, v253
    v_mov_b32 v253, v252
    s_nop 1
    v_permlane16_swap_b32 v252, v253
    v_max_f32 v252, v252, v253
    v_mov_b32 v253, v252
    s_nop 1
    v_permlane32_swap_b32 v252, v253
    v_max_f32_e64 v252, v252, v253
    v_add_f32 v252, 0x41800000, v252
    v_max_f32 v252, 0, v252
    v_sub_f32 v252, 0, v252
    v_mov_b32 v253, v252
    v_exp_f32 v240, v252
    v_pk_add_f32 v[184:185], v[184:185], v[252:253]
    v_pk_add_f32 v[186:187], v[186:187], v[252:253]
    v_pk_add_f32 v[188:189], v[188:189], v[252:253]
    v_pk_add_f32 v[190:191], v[190:191], v[252:253]
    v_pk_add_f32 v[204:205], v[204:205], v[252:253]
    v_pk_add_f32 v[206:207], v[206:207], v[252:253]
    v_mov_b32 v252, v240
    v_mov_b32 v253, v240
    v_pk_mul_f32 v[220:221], v[220:221], v[252:253]
    v_pk_mul_f32 v[222:223], v[222:223], v[252:253]
    v_pk_mul_f32 v[44:45], v[44:45], v[252:253]
    v_pk_mul_f32 v[46:47], v[46:47], v[252:253]
    v_pk_mul_f32 v[60:61], v[60:61], v[252:253]
    v_pk_mul_f32 v[62:63], v[62:63], v[252:253]
    v_pk_mul_f32 v[76:77], v[76:77], v[252:253]
    v_pk_mul_f32 v[78:79], v[78:79], v[252:253]
    v_pk_mul_f32 v[92:93], v[92:93], v[252:253]
    v_pk_mul_f32 v[94:95], v[94:95], v[252:253]
    v_pk_mul_f32 v[108:109], v[108:109], v[252:253]
    v_pk_mul_f32 v[110:111], v[110:111], v[252:253]
    v_pk_mul_f32 v[124:125], v[124:125], v[252:253]
    v_pk_mul_f32 v[126:127], v[126:127], v[252:253]
    v_pk_mul_f32 v[140:141], v[140:141], v[252:253]
    v_pk_mul_f32 v[142:143], v[142:143], v[252:253]
    v_pk_mul_f32 v[156:157], v[156:157], v[252:253]
    v_pk_mul_f32 v[158:159], v[158:159], v[252:253]
    v_exp_f32 v240, v176
    v_exp_f32 v241, v177
    v_exp_f32 v242, v178
    v_exp_f32 v243, v179
    v_cvt_pk_bf16_f32 v232, v240, v241
    v_exp_f32 v244, v180
    v_exp_f32 v245, v181
    v_cvt_pk_bf16_f32 v233, v242, v243
    v_exp_f32 v240, v182
    v_exp_f32 v241, v183
    v_cvt_pk_bf16_f32 v234, v244, v245
    v_exp_f32 v242, v184
    v_exp_f32 v243, v185
    v_cvt_pk_bf16_f32 v235, v240, v241
    v_exp_f32 v244, v186
    v_exp_f32 v245, v187
    v_cvt_pk_bf16_f32 v236, v242, v243
    v_exp_f32 v240, v188
    v_exp_f32 v241, v189
    v_cvt_pk_bf16_f32 v237, v244, v245
    v_exp_f32 v242, v190
    v_exp_f32 v243, v191
    v_cvt_pk_bf16_f32 v238, v240, v241
    s_nop 0
    v_cvt_pk_bf16_f32 v239, v242, v243
    s_branch L_slow1_2_ret
L_slow0_2:
    v_max3_f32 v250, v160, v161, v162
    v_max3_f32 v251, v163, v164, v165
    v_max3_f32 v250, v250, v166, v167
    v_max_f32 v250, v250, v251
    v_mov_b32 v251, v250
    s_nop 1
    v_permlane16_swap_b32 v250, v251
    v_max_f32 v250, v250, v251
    v_mov_b32 v251, v250
    s_nop 1
    v_permlane32_swap_b32 v250, v251
    v_max_f32_e64 v250, v250, v251
    v_add_f32 v250, 0x41800000, v250
    v_max_f32 v250, 0, v250
    v_sub_f32 v250, 0, v250
    v_mov_b32 v251, v250
    v_exp_f32 v240, v250
    v_pk_add_f32 v[160:161], v[160:161], v[250:251]
    v_pk_add_f32 v[162:163], v[162:163], v[250:251]
    v_pk_add_f32 v[164:165], v[164:165], v[250:251]
    v_pk_add_f32 v[166:167], v[166:167], v[250:251]
    v_pk_add_f32 v[192:193], v[192:193], v[250:251]
    v_pk_add_f32 v[194:195], v[194:195], v[250:251]
    v_mov_b32 v250, v240
    v_mov_b32 v251, v240
    v_pk_mul_f32 v[208:209], v[208:209], v[250:251]
    v_pk_mul_f32 v[210:211], v[210:211], v[250:251]
    v_pk_mul_f32 v[32:33], v[32:33], v[250:251]
    v_pk_mul_f32 v[34:35], v[34:35], v[250:251]
    v_pk_mul_f32 v[48:49], v[48:49], v[250:251]
    v_pk_mul_f32 v[50:51], v[50:51], v[250:251]
    v_pk_mul_f32 v[64:65], v[64:65], v[250:251]
    v_pk_mul_f32 v[66:67], v[66:67], v[250:251]
    v_pk_mul_f32 v[80:81], v[80:81], v[250:251]
    v_pk_mul_f32 v[82:83], v[82:83], v[250:251]
    v_pk_mul_f32 v[96:97], v[96:97], v[250:251]
    v_pk_mul_f32 v[98:99], v[98:99], v[250:251]
    v_pk_mul_f32 v[112:113], v[112:113], v[250:251]
    v_pk_mul_f32 v[114:115], v[114:115], v[250:251]
    v_pk_mul_f32 v[128:129], v[128:129], v[250:251]
    v_pk_mul_f32 v[130:131], v[130:131], v[250:251]
    v_pk_mul_f32 v[144:145], v[144:145], v[250:251]
    v_pk_mul_f32 v[146:147], v[146:147], v[250:251]
    v_max3_f32 v252, v168, v169, v170
    v_max3_f32 v253, v171, v172, v173
    v_max3_f32 v252, v252, v174, v175
    v_max_f32 v252, v252, v253
    v_mov_b32 v253, v252
    s_nop 1
    v_permlane16_swap_b32 v252, v253
    v_max_f32 v252, v252, v253
    v_mov_b32 v253, v252
    s_nop 1
    v_permlane32_swap_b32 v252, v253
    v_max_f32_e64 v252, v252, v253
    v_add_f32 v252, 0x41800000, v252
    v_max_f32 v252, 0, v252
    v_sub_f32 v252, 0, v252
    v_mov_b32 v253, v252
    v_exp_f32 v240, v252
    v_pk_add_f32 v[168:169], v[168:169], v[252:253]
    v_pk_add_f32 v[170:171], v[170:171], v[252:253]
    v_pk_add_f32 v[172:173], v[172:173], v[252:253]
    v_pk_add_f32 v[174:175], v[174:175], v[252:253]
    v_pk_add_f32 v[196:197], v[196:197], v[252:253]
    v_pk_add_f32 v[198:199], v[198:199], v[252:253]
    v_mov_b32 v252, v240
    v_mov_b32 v253, v240
    v_pk_mul_f32 v[212:213], v[212:213], v[252:253]
    v_pk_mul_f32 v[214:215], v[214:215], v[252:253]
    v_pk_mul_f32 v[36:37], v[36:37], v[252:253]
    v_pk_mul_f32 v[38:39], v[38:39], v[252:253]
    v_pk_mul_f32 v[52:53], v[52:53], v[252:253]
    v_pk_mul_f32 v[54:55], v[54:55], v[252:253]
    v_pk_mul_f32 v[68:69], v[68:69], v[252:253]
    v_pk_mul_f32 v[70:71], v[70:71], v[252:253]
    v_pk_mul_f32 v[84:85], v[84:85], v[252:253]
    v_pk_mul_f32 v[86:87], v[86:87], v[252:253]
    v_pk_mul_f32 v[100:101], v[100:101], v[252:253]
    v_pk_mul_f32 v[102:103], v[102:103], v[252:253]
    v_pk_mul_f32 v[116:117], v[116:117], v[252:253]
    v_pk_mul_f32 v[118:119], v[118:119], v[252:253]
    v_pk_mul_f32 v[132:133], v[132:133], v[252:253]
    v_pk_mul_f32 v[134:135], v[134:135], v[252:253]
    v_pk_mul_f32 v[148:149], v[148:149], v[252:253]
    v_pk_mul_f32 v[150:151], v[150:151], v[252:253]
    v_exp_f32 v240, v160
    v_exp_f32 v241, v161
    v_exp_f32 v242, v162
    v_exp_f32 v243, v163
    v_cvt_pk_bf16_f32 v224, v240, v241
    v_exp_f32 v244, v164
    v_exp_f32 v245, v165
    v_cvt_pk_bf16_f32 v225, v242, v243
    v_exp_f32 v240, v166
    v_exp_f32 v241, v167
    v_cvt_pk_bf16_f32 v226, v244, v245
    v_exp_f32 v242, v168
    v_exp_f32 v243, v169
    v_cvt_pk_bf16_f32 v227, v240, v241
    v_exp_f32 v244, v170
    v_exp_f32 v245, v171
    v_cvt_pk_bf16_f32 v228, v242, v243
    v_exp_f32 v240, v172
    v_exp_f32 v241, v173
    v_cvt_pk_bf16_f32 v229, v244, v245
    v_exp_f32 v242, v174
    v_exp_f32 v243, v175
    v_cvt_pk_bf16_f32 v230, v240, v241
    s_nop 0
    v_cvt_pk_bf16_f32 v231, v242, v243
    s_branch L_slow0_2_ret
L_slow1_3:
    v_max3_f32 v250, v176, v177, v178
    v_max3_f32 v251, v179, v180, v181
    v_max3_f32 v250, v250, v182, v183
    v_max_f32 v250, v250, v251
    v_mov_b32 v251, v250
    s_nop 1
    v_permlane16_swap_b32 v250, v251
    v_max_f32 v250, v250, v251
    v_mov_b32 v251, v250
    s_nop 1
    v_permlane32_swap_b32 v250, v251
    v_max_f32_e64 v250, v250, v251
    v_add_f32 v250, 0x41800000, v250
    v_max_f32 v250, 0, v250
    v_sub_f32 v250, 0, v250
    v_mov_b32 v251, v250
    v_exp_f32 v240, v250
    v_pk_add_f32 v[176:177], v[176:177], v[250:251]
    v_pk_add_f32 v[178:179], v[178:179], v[250:251]
    v_pk_add_f32 v[180:181], v[180:181], v[250:251]
    v_pk_add_f32 v[182:183], v[182:183], v[250:251]
    v_pk_add_f32 v[200:201], v[200:201], v[250:251]
    v_pk_add_f32 v[202:203], v[202:203], v[250:251]
    v_mov_b32 v250, v240
    v_mov_b32 v251, v240
    v_pk_mul_f32 v[216:217], v[216:217], v[250:251]
    v_pk_mul_f32 v[218:219], v[218:219], v[250:251]
    v_pk_mul_f32 v[40:41], v[40:41], v[250:251]
    v_pk_mul_f32 v[42:43], v[42:43], v[250:251]
    v_pk_mul_f32 v[56:57], v[56:57], v[250:251]
    v_pk_mul_f32 v[58:59], v[58:59], v[250:251]
    v_pk_mul_f32 v[72:73], v[72:73], v[250:251]
    v_pk_mul_f32 v[74:75], v[74:75], v[250:251]
    v_pk_mul_f32 v[88:89], v[88:89], v[250:251]
    v_pk_mul_f32 v[90:91], v[90:91], v[250:251]
    v_pk_mul_f32 v[104:105], v[104:105], v[250:251]
    v_pk_mul_f32 v[106:107], v[106:107], v[250:251]
    v_pk_mul_f32 v[120:121], v[120:121], v[250:251]
    v_pk_mul_f32 v[122:123], v[122:123], v[250:251]
    v_pk_mul_f32 v[136:137], v[136:137], v[250:251]
    v_pk_mul_f32 v[138:139], v[138:139], v[250:251]
    v_pk_mul_f32 v[152:153], v[152:153], v[250:251]
    v_pk_mul_f32 v[154:155], v[154:155], v[250:251]
    v_max3_f32 v252, v184, v185, v186
    v_max3_f32 v253, v187, v188, v189
    v_max3_f32 v252, v252, v190, v191
    v_max_f32 v252, v252, v253
    v_mov_b32 v253, v252
    s_nop 1
    v_permlane16_swap_b32 v252, v253
    v_max_f32 v252, v252, v253
    v_mov_b32 v253, v252
    s_nop 1
    v_permlane32_swap_b32 v252, v253
    v_max_f32_e64 v252, v252, v253
    v_add_f32 v252, 0x41800000, v252
    v_max_f32 v252, 0, v252
    v_sub_f32 v252, 0, v252
    v_mov_b32 v253, v252
    v_exp_f32 v240, v252
    v_pk_add_f32 v[184:185], v[184:185], v[252:253]
    v_pk_add_f32 v[186:187], v[186:187], v[252:253]
    v_pk_add_f32 v[188:189], v[188:189], v[252:253]
    v_pk_add_f32 v[190:191], v[190:191], v[252:253]
    v_pk_add_f32 v[204:205], v[204:205], v[252:253]
    v_pk_add_f32 v[206:207], v[206:207], v[252:253]
    v_mov_b32 v252, v240
    v_mov_b32 v253, v240
    v_pk_mul_f32 v[220:221], v[220:221], v[252:253]
    v_pk_mul_f32 v[222:223], v[222:223], v[252:253]
    v_pk_mul_f32 v[44:45], v[44:45], v[252:253]
    v_pk_mul_f32 v[46:47], v[46:47], v[252:253]
    v_pk_mul_f32 v[60:61], v[60:61], v[252:253]
    v_pk_mul_f32 v[62:63], v[62:63], v[252:253]
    v_pk_mul_f32 v[76:77], v[76:77], v[252:253]
    v_pk_mul_f32 v[78:79], v[78:79], v[252:253]
    v_pk_mul_f32 v[92:93], v[92:93], v[252:253]
    v_pk_mul_f32 v[94:95], v[94:95], v[252:253]
    v_pk_mul_f32 v[108:109], v[108:109], v[252:253]
    v_pk_mul_f32 v[110:111], v[110:111], v[252:253]
    v_pk_mul_f32 v[124:125], v[124:125], v[252:253]
    v_pk_mul_f32 v[126:127], v[126:127], v[252:253]
    v_pk_mul_f32 v[140:141], v[140:141], v[252:253]
    v_pk_mul_f32 v[142:143], v[142:143], v[252:253]
    v_pk_mul_f32 v[156:157], v[156:157], v[252:253]
    v_pk_mul_f32 v[158:159], v[158:159], v[252:253]
    v_exp_f32 v240, v176
    v_exp_f32 v241, v177
    v_exp_f32 v242, v178
    v_exp_f32 v243, v179
    v_cvt_pk_bf16_f32 v232, v240, v241
    v_exp_f32 v244, v180
    v_exp_f32 v245, v181
    v_cvt_pk_bf16_f32 v233, v242, v243
    v_exp_f32 v240, v182
    v_exp_f32 v241, v183
    v_cvt_pk_bf16_f32 v234, v244, v245
    v_exp_f32 v242, v184
    v_exp_f32 v243, v185
    v_cvt_pk_bf16_f32 v235, v240, v241
    v_exp_f32 v244, v186
    v_exp_f32 v245, v187
    v_cvt_pk_bf16_f32 v236, v242, v243
    v_exp_f32 v240, v188
    v_exp_f32 v241, v189
    v_cvt_pk_bf16_f32 v237, v244, v245
    v_exp_f32 v242, v190
    v_exp_f32 v243, v191
    v_cvt_pk_bf16_f32 v238, v240, v241
    s_nop 0
    v_cvt_pk_bf16_f32 v239, v242, v243
    s_branch L_slow1_3_ret
L_slow0_3:
    v_max3_f32 v250, v160, v161, v162
    v_max3_f32 v251, v163, v164, v165
    v_max3_f32 v250, v250, v166, v167
    v_max_f32 v250, v250, v251
    v_mov_b32 v251, v250
    s_nop 1
    v_permlane16_swap_b32 v250, v251
    v_max_f32 v250, v250, v251
    v_mov_b32 v251, v250
    s_nop 1
    v_permlane32_swap_b32 v250, v251
    v_max_f32_e64 v250, v250, v251
    v_add_f32 v250, 0x41800000, v250
    v_max_f32 v250, 0, v250
    v_sub_f32 v250, 0, v250
    v_mov_b32 v251, v250
    v_exp_f32 v240, v250
    v_pk_add_f32 v[160:161], v[160:161], v[250:251]
    v_pk_add_f32 v[162:163], v[162:163], v[250:251]
    v_pk_add_f32 v[164:165], v[164:165], v[250:251]
    v_pk_add_f32 v[166:167], v[166:167], v[250:251]
    v_pk_add_f32 v[192:193], v[192:193], v[250:251]
    v_pk_add_f32 v[194:195], v[194:195], v[250:251]
    v_mov_b32 v250, v240
    v_mov_b32 v251, v240
    v_pk_mul_f32 v[208:209], v[208:209], v[250:251]
    v_pk_mul_f32 v[210:211], v[210:211], v[250:251]
    v_pk_mul_f32 v[32:33], v[32:33], v[250:251]
    v_pk_mul_f32 v[34:35], v[34:35], v[250:251]
    v_pk_mul_f32 v[48:49], v[48:49], v[250:251]
    v_pk_mul_f32 v[50:51], v[50:51], v[250:251]
    v_pk_mul_f32 v[64:65], v[64:65], v[250:251]
    v_pk_mul_f32 v[66:67], v[66:67], v[250:251]
    v_pk_mul_f32 v[80:81], v[80:81], v[250:251]
    v_pk_mul_f32 v[82:83], v[82:83], v[250:251]
    v_pk_mul_f32 v[96:97], v[96:97], v[250:251]
    v_pk_mul_f32 v[98:99], v[98:99], v[250:251]
    v_pk_mul_f32 v[112:113], v[112:113], v[250:251]
    v_pk_mul_f32 v[114:115], v[114:115], v[250:251]
    v_pk_mul_f32 v[128:129], v[128:129], v[250:251]
    v_pk_mul_f32 v[130:131], v[130:131], v[250:251]
    v_pk_mul_f32 v[144:145], v[144:145], v[250:251]
    v_pk_mul_f32 v[146:147], v[146:147], v[250:251]
    v_max3_f32 v252, v168, v169, v170
    v_max3_f32 v253, v171, v172, v173
    v_max3_f32 v252, v252, v174, v175
    v_max_f32 v252, v252, v253
    v_mov_b32 v253, v252
    s_nop 1
    v_permlane16_swap_b32 v252, v253
    v_max_f32 v252, v252, v253
    v_mov_b32 v253, v252
    s_nop 1
    v_permlane32_swap_b32 v252, v253
    v_max_f32_e64 v252, v252, v253
    v_add_f32 v252, 0x41800000, v252
    v_max_f32 v252, 0, v252
    v_sub_f32 v252, 0, v252
    v_mov_b32 v253, v252
    v_exp_f32 v240, v252
    v_pk_add_f32 v[168:169], v[168:169], v[252:253]
    v_pk_add_f32 v[170:171], v[170:171], v[252:253]
    v_pk_add_f32 v[172:173], v[172:173], v[252:253]
    v_pk_add_f32 v[174:175], v[174:175], v[252:253]
    v_pk_add_f32 v[196:197], v[196:197], v[252:253]
    v_pk_add_f32 v[198:199], v[198:199], v[252:253]
    v_mov_b32 v252, v240
    v_mov_b32 v253, v240
    v_pk_mul_f32 v[212:213], v[212:213], v[252:253]
    v_pk_mul_f32 v[214:215], v[214:215], v[252:253]
    v_pk_mul_f32 v[36:37], v[36:37], v[252:253]
    v_pk_mul_f32 v[38:39], v[38:39], v[252:253]
    v_pk_mul_f32 v[52:53], v[52:53], v[252:253]
    v_pk_mul_f32 v[54:55], v[54:55], v[252:253]
    v_pk_mul_f32 v[68:69], v[68:69], v[252:253]
    v_pk_mul_f32 v[70:71], v[70:71], v[252:253]
    v_pk_mul_f32 v[84:85], v[84:85], v[252:253]
    v_pk_mul_f32 v[86:87], v[86:87], v[252:253]
    v_pk_mul_f32 v[100:101], v[100:101], v[252:253]
    v_pk_mul_f32 v[102:103], v[102:103], v[252:253]
    v_pk_mul_f32 v[116:117], v[116:117], v[252:253]
    v_pk_mul_f32 v[118:119], v[118:119], v[252:253]
    v_pk_mul_f32 v[132:133], v[132:133], v[252:253]
    v_pk_mul_f32 v[134:135], v[134:135], v[252:253]
    v_pk_mul_f32 v[148:149], v[148:149], v[252:253]
    v_pk_mul_f32 v[150:151], v[150:151], v[252:253]
    v_exp_f32 v240, v160
    v_exp_f32 v241, v161
    v_exp_f32 v242, v162
    v_exp_f32 v243, v163
    v_cvt_pk_bf16_f32 v224, v240, v241
    v_exp_f32 v244, v164
    v_exp_f32 v245, v165
    v_cvt_pk_bf16_f32 v225, v242, v243
    v_exp_f32 v240, v166
    v_exp_f32 v241, v167
    v_cvt_pk_bf16_f32 v226, v244, v245
    v_exp_f32 v242, v168
    v_exp_f32 v243, v169
    v_cvt_pk_bf16_f32 v227, v240, v241
    v_exp_f32 v244, v170
    v_exp_f32 v245, v171
    v_cvt_pk_bf16_f32 v228, v242, v243
    v_exp_f32 v240, v172
    v_exp_f32 v241, v173
    v_cvt_pk_bf16_f32 v229, v244, v245
    v_exp_f32 v242, v174
    v_exp_f32 v243, v175
    v_cvt_pk_bf16_f32 v230, v240, v241
    s_nop 0
    v_cvt_pk_bf16_f32 v231, v242, v243
    s_branch L_slow0_3_ret
L_slow1_4:
    v_max3_f32 v250, v176, v177, v178
    v_max3_f32 v251, v179, v180, v181
    v_max3_f32 v250, v250, v182, v183
    v_max_f32 v250, v250, v251
    v_mov_b32 v251, v250
    s_nop 1
    v_permlane16_swap_b32 v250, v251
    v_max_f32 v250, v250, v251
    v_mov_b32 v251, v250
    s_nop 1
    v_permlane32_swap_b32 v250, v251
    v_max_f32_e64 v250, v250, v251
    v_add_f32 v250, 0x41800000, v250
    v_max_f32 v250, 0, v250
    v_sub_f32 v250, 0, v250
    v_mov_b32 v251, v250
    v_exp_f32 v240, v250
    v_pk_add_f32 v[176:177], v[176:177], v[250:251]
    v_pk_add_f32 v[178:179], v[178:179], v[250:251]
    v_pk_add_f32 v[180:181], v[180:181], v[250:251]
    v_pk_add_f32 v[182:183], v[182:183], v[250:251]
    v_pk_add_f32 v[200:201], v[200:201], v[250:251]
    v_pk_add_f32 v[202:203], v[202:203], v[250:251]
    v_mov_b32 v250, v240
    v_mov_b32 v251, v240
    v_pk_mul_f32 v[216:217], v[216:217], v[250:251]
    v_pk_mul_f32 v[218:219], v[218:219], v[250:251]
    v_pk_mul_f32 v[40:41], v[40:41], v[250:251]
    v_pk_mul_f32 v[42:43], v[42:43], v[250:251]
    v_pk_mul_f32 v[56:57], v[56:57], v[250:251]
    v_pk_mul_f32 v[58:59], v[58:59], v[250:251]
    v_pk_mul_f32 v[72:73], v[72:73], v[250:251]
    v_pk_mul_f32 v[74:75], v[74:75], v[250:251]
    v_pk_mul_f32 v[88:89], v[88:89], v[250:251]
    v_pk_mul_f32 v[90:91], v[90:91], v[250:251]
    v_pk_mul_f32 v[104:105], v[104:105], v[250:251]
    v_pk_mul_f32 v[106:107], v[106:107], v[250:251]
    v_pk_mul_f32 v[120:121], v[120:121], v[250:251]
    v_pk_mul_f32 v[122:123], v[122:123], v[250:251]
    v_pk_mul_f32 v[136:137], v[136:137], v[250:251]
    v_pk_mul_f32 v[138:139], v[138:139], v[250:251]
    v_pk_mul_f32 v[152:153], v[152:153], v[250:251]
    v_pk_mul_f32 v[154:155], v[154:155], v[250:251]
    v_max3_f32 v252, v184, v185, v186
    v_max3_f32 v253, v187, v188, v189
    v_max3_f32 v252, v252, v190, v191
    v_max_f32 v252, v252, v253
    v_mov_b32 v253, v252
    s_nop 1
    v_permlane16_swap_b32 v252, v253
    v_max_f32 v252, v252, v253
    v_mov_b32 v253, v252
    s_nop 1
    v_permlane32_swap_b32 v252, v253
    v_max_f32_e64 v252, v252, v253
    v_add_f32 v252, 0x41800000, v252
    v_max_f32 v252, 0, v252
    v_sub_f32 v252, 0, v252
    v_mov_b32 v253, v252
    v_exp_f32 v240, v252
    v_pk_add_f32 v[184:185], v[184:185], v[252:253]
    v_pk_add_f32 v[186:187], v[186:187], v[252:253]
    v_pk_add_f32 v[188:189], v[188:189], v[252:253]
    v_pk_add_f32 v[190:191], v[190:191], v[252:253]
    v_pk_add_f32 v[204:205], v[204:205], v[252:253]
    v_pk_add_f32 v[206:207], v[206:207], v[252:253]
    v_mov_b32 v252, v240
    v_mov_b32 v253, v240
    v_pk_mul_f32 v[220:221], v[220:221], v[252:253]
    v_pk_mul_f32 v[222:223], v[222:223], v[252:253]
    v_pk_mul_f32 v[44:45], v[44:45], v[252:253]
    v_pk_mul_f32 v[46:47], v[46:47], v[252:253]
    v_pk_mul_f32 v[60:61], v[60:61], v[252:253]
    v_pk_mul_f32 v[62:63], v[62:63], v[252:253]
    v_pk_mul_f32 v[76:77], v[76:77], v[252:253]
    v_pk_mul_f32 v[78:79], v[78:79], v[252:253]
    v_pk_mul_f32 v[92:93], v[92:93], v[252:253]
    v_pk_mul_f32 v[94:95], v[94:95], v[252:253]
    v_pk_mul_f32 v[108:109], v[108:109], v[252:253]
    v_pk_mul_f32 v[110:111], v[110:111], v[252:253]
    v_pk_mul_f32 v[124:125], v[124:125], v[252:253]
    v_pk_mul_f32 v[126:127], v[126:127], v[252:253]
    v_pk_mul_f32 v[140:141], v[140:141], v[252:253]
    v_pk_mul_f32 v[142:143], v[142:143], v[252:253]
    v_pk_mul_f32 v[156:157], v[156:157], v[252:253]
    v_pk_mul_f32 v[158:159], v[158:159], v[252:253]
    v_exp_f32 v240, v176
    v_exp_f32 v241, v177
    v_exp_f32 v242, v178
    v_exp_f32 v243, v179
    v_cvt_pk_bf16_f32 v232, v240, v241
    v_exp_f32 v244, v180
    v_exp_f32 v245, v181
    v_cvt_pk_bf16_f32 v233, v242, v243
    v_exp_f32 v240, v182
    v_exp_f32 v241, v183
    v_cvt_pk_bf16_f32 v234, v244, v245
    v_exp_f32 v242, v184
    v_exp_f32 v243, v185
    v_cvt_pk_bf16_f32 v235, v240, v241
    v_exp_f32 v244, v186
    v_exp_f32 v245, v187
    v_cvt_pk_bf16_f32 v236, v242, v243
    v_exp_f32 v240, v188
    v_exp_f32 v241, v189
    v_cvt_pk_bf16_f32 v237, v244, v245
    v_exp_f32 v242, v190
    v_exp_f32 v243, v191
    v_cvt_pk_bf16_f32 v238, v240, v241
    s_nop 0
    v_cvt_pk_bf16_f32 v239, v242, v243
    s_branch L_slow1_4_ret
L_slow0_4:
    v_max3_f32 v250, v160, v161, v162
    v_max3_f32 v251, v163, v164, v165
    v_max3_f32 v250, v250, v166, v167
    v_max_f32 v250, v250, v251
    v_mov_b32 v251, v250
    s_nop 1
    v_permlane16_swap_b32 v250, v251
    v_max_f32 v250, v250, v251
    v_mov_b32 v251, v250
    s_nop 1
    v_permlane32_swap_b32 v250, v251
    v_max_f32_e64 v250, v250, v251
    v_add_f32 v250, 0x41800000, v250
    v_max_f32 v250, 0, v250
    v_sub_f32 v250, 0, v250
    v_mov_b32 v251, v250
    v_exp_f32 v240, v250
    v_pk_add_f32 v[160:161], v[160:161], v[250:251]
    v_pk_add_f32 v[162:163], v[162:163], v[250:251]
    v_pk_add_f32 v[164:165], v[164:165], v[250:251]
    v_pk_add_f32 v[166:167], v[166:167], v[250:251]
    v_pk_add_f32 v[192:193], v[192:193], v[250:251]
    v_pk_add_f32 v[194:195], v[194:195], v[250:251]
    v_mov_b32 v250, v240
    v_mov_b32 v251, v240
    v_pk_mul_f32 v[208:209], v[208:209], v[250:251]
    v_pk_mul_f32 v[210:211], v[210:211], v[250:251]
    v_pk_mul_f32 v[32:33], v[32:33], v[250:251]
    v_pk_mul_f32 v[34:35], v[34:35], v[250:251]
    v_pk_mul_f32 v[48:49], v[48:49], v[250:251]
    v_pk_mul_f32 v[50:51], v[50:51], v[250:251]
    v_pk_mul_f32 v[64:65], v[64:65], v[250:251]
    v_pk_mul_f32 v[66:67], v[66:67], v[250:251]
    v_pk_mul_f32 v[80:81], v[80:81], v[250:251]
    v_pk_mul_f32 v[82:83], v[82:83], v[250:251]
    v_pk_mul_f32 v[96:97], v[96:97], v[250:251]
    v_pk_mul_f32 v[98:99], v[98:99], v[250:251]
    v_pk_mul_f32 v[112:113], v[112:113], v[250:251]
    v_pk_mul_f32 v[114:115], v[114:115], v[250:251]
    v_pk_mul_f32 v[128:129], v[128:129], v[250:251]
    v_pk_mul_f32 v[130:131], v[130:131], v[250:251]
    v_pk_mul_f32 v[144:145], v[144:145], v[250:251]
    v_pk_mul_f32 v[146:147], v[146:147], v[250:251]
    v_max3_f32 v252, v168, v169, v170
    v_max3_f32 v253, v171, v172, v173
    v_max3_f32 v252, v252, v174, v175
    v_max_f32 v252, v252, v253
    v_mov_b32 v253, v252
    s_nop 1
    v_permlane16_swap_b32 v252, v253
    v_max_f32 v252, v252, v253
    v_mov_b32 v253, v252
    s_nop 1
    v_permlane32_swap_b32 v252, v253
    v_max_f32_e64 v252, v252, v253
    v_add_f32 v252, 0x41800000, v252
    v_max_f32 v252, 0, v252
    v_sub_f32 v252, 0, v252
    v_mov_b32 v253, v252
    v_exp_f32 v240, v252
    v_pk_add_f32 v[168:169], v[168:169], v[252:253]
    v_pk_add_f32 v[170:171], v[170:171], v[252:253]
    v_pk_add_f32 v[172:173], v[172:173], v[252:253]
    v_pk_add_f32 v[174:175], v[174:175], v[252:253]
    v_pk_add_f32 v[196:197], v[196:197], v[252:253]
    v_pk_add_f32 v[198:199], v[198:199], v[252:253]
    v_mov_b32 v252, v240
    v_mov_b32 v253, v240
    v_pk_mul_f32 v[212:213], v[212:213], v[252:253]
    v_pk_mul_f32 v[214:215], v[214:215], v[252:253]
    v_pk_mul_f32 v[36:37], v[36:37], v[252:253]
    v_pk_mul_f32 v[38:39], v[38:39], v[252:253]
    v_pk_mul_f32 v[52:53], v[52:53], v[252:253]
    v_pk_mul_f32 v[54:55], v[54:55], v[252:253]
    v_pk_mul_f32 v[68:69], v[68:69], v[252:253]
    v_pk_mul_f32 v[70:71], v[70:71], v[252:253]
    v_pk_mul_f32 v[84:85], v[84:85], v[252:253]
    v_pk_mul_f32 v[86:87], v[86:87], v[252:253]
    v_pk_mul_f32 v[100:101], v[100:101], v[252:253]
    v_pk_mul_f32 v[102:103], v[102:103], v[252:253]
    v_pk_mul_f32 v[116:117], v[116:117], v[252:253]
    v_pk_mul_f32 v[118:119], v[118:119], v[252:253]
    v_pk_mul_f32 v[132:133], v[132:133], v[252:253]
    v_pk_mul_f32 v[134:135], v[134:135], v[252:253]
    v_pk_mul_f32 v[148:149], v[148:149], v[252:253]
    v_pk_mul_f32 v[150:151], v[150:151], v[252:253]
    v_exp_f32 v240, v160
    v_exp_f32 v241, v161
    v_exp_f32 v242, v162
    v_exp_f32 v243, v163
    v_cvt_pk_bf16_f32 v224, v240, v241
    v_exp_f32 v244, v164
    v_exp_f32 v245, v165
    v_cvt_pk_bf16_f32 v225, v242, v243
    v_exp_f32 v240, v166
    v_exp_f32 v241, v167
    v_cvt_pk_bf16_f32 v226, v244, v245
    v_exp_f32 v242, v168
    v_exp_f32 v243, v169
    v_cvt_pk_bf16_f32 v227, v240, v241
    v_exp_f32 v244, v170
    v_exp_f32 v245, v171
    v_cvt_pk_bf16_f32 v228, v242, v243
    v_exp_f32 v240, v172
    v_exp_f32 v241, v173
    v_cvt_pk_bf16_f32 v229, v244, v245
    v_exp_f32 v242, v174
    v_exp_f32 v243, v175
    v_cvt_pk_bf16_f32 v230, v240, v241
    s_nop 0
    v_cvt_pk_bf16_f32 v231, v242, v243
    s_branch L_slow0_4_ret
L_slow1_5:
    v_max3_f32 v250, v176, v177, v178
    v_max3_f32 v251, v179, v180, v181
    v_max3_f32 v250, v250, v182, v183
    v_max_f32 v250, v250, v251
    v_mov_b32 v251, v250
    s_nop 1
    v_permlane16_swap_b32 v250, v251
    v_max_f32 v250, v250, v251
    v_mov_b32 v251, v250
    s_nop 1
    v_permlane32_swap_b32 v250, v251
    v_max_f32_e64 v250, v250, v251
    v_add_f32 v250, 0x41800000, v250
    v_max_f32 v250, 0, v250
    v_sub_f32 v250, 0, v250
    v_mov_b32 v251, v250
    v_exp_f32 v240, v250
    v_pk_add_f32 v[176:177], v[176:177], v[250:251]
    v_pk_add_f32 v[178:179], v[178:179], v[250:251]
    v_pk_add_f32 v[180:181], v[180:181], v[250:251]
    v_pk_add_f32 v[182:183], v[182:183], v[250:251]
    v_pk_add_f32 v[200:201], v[200:201], v[250:251]
    v_pk_add_f32 v[202:203], v[202:203], v[250:251]
    v_mov_b32 v250, v240
    v_mov_b32 v251, v240
    v_pk_mul_f32 v[216:217], v[216:217], v[250:251]
    v_pk_mul_f32 v[218:219], v[218:219], v[250:251]
    v_pk_mul_f32 v[40:41], v[40:41], v[250:251]
    v_pk_mul_f32 v[42:43], v[42:43], v[250:251]
    v_pk_mul_f32 v[56:57], v[56:57], v[250:251]
    v_pk_mul_f32 v[58:59], v[58:59], v[250:251]
    v_pk_mul_f32 v[72:73], v[72:73], v[250:251]
    v_pk_mul_f32 v[74:75], v[74:75], v[250:251]
    v_pk_mul_f32 v[88:89], v[88:89], v[250:251]
    v_pk_mul_f32 v[90:91], v[90:91], v[250:251]
    v_pk_mul_f32 v[104:105], v[104:105], v[250:251]
    v_pk_mul_f32 v[106:107], v[106:107], v[250:251]
    v_pk_mul_f32 v[120:121], v[120:121], v[250:251]
    v_pk_mul_f32 v[122:123], v[122:123], v[250:251]
    v_pk_mul_f32 v[136:137], v[136:137], v[250:251]
    v_pk_mul_f32 v[138:139], v[138:139], v[250:251]
    v_pk_mul_f32 v[152:153], v[152:153], v[250:251]
    v_pk_mul_f32 v[154:155], v[154:155], v[250:251]
    v_max3_f32 v252, v184, v185, v186
    v_max3_f32 v253, v187, v188, v189
    v_max3_f32 v252, v252, v190, v191
    v_max_f32 v252, v252, v253
    v_mov_b32 v253, v252
    s_nop 1
    v_permlane16_swap_b32 v252, v253
    v_max_f32 v252, v252, v253
    v_mov_b32 v253, v252
    s_nop 1
    v_permlane32_swap_b32 v252, v253
    v_max_f32_e64 v252, v252, v253
    v_add_f32 v252, 0x41800000, v252
    v_max_f32 v252, 0, v252
    v_sub_f32 v252, 0, v252
    v_mov_b32 v253, v252
    v_exp_f32 v240, v252
    v_pk_add_f32 v[184:185], v[184:185], v[252:253]
    v_pk_add_f32 v[186:187], v[186:187], v[252:253]
    v_pk_add_f32 v[188:189], v[188:189], v[252:253]
    v_pk_add_f32 v[190:191], v[190:191], v[252:253]
    v_pk_add_f32 v[204:205], v[204:205], v[252:253]
    v_pk_add_f32 v[206:207], v[206:207], v[252:253]
    v_mov_b32 v252, v240
    v_mov_b32 v253, v240
    v_pk_mul_f32 v[220:221], v[220:221], v[252:253]
    v_pk_mul_f32 v[222:223], v[222:223], v[252:253]
    v_pk_mul_f32 v[44:45], v[44:45], v[252:253]
    v_pk_mul_f32 v[46:47], v[46:47], v[252:253]
    v_pk_mul_f32 v[60:61], v[60:61], v[252:253]
    v_pk_mul_f32 v[62:63], v[62:63], v[252:253]
    v_pk_mul_f32 v[76:77], v[76:77], v[252:253]
    v_pk_mul_f32 v[78:79], v[78:79], v[252:253]
    v_pk_mul_f32 v[92:93], v[92:93], v[252:253]
    v_pk_mul_f32 v[94:95], v[94:95], v[252:253]
    v_pk_mul_f32 v[108:109], v[108:109], v[252:253]
    v_pk_mul_f32 v[110:111], v[110:111], v[252:253]
    v_pk_mul_f32 v[124:125], v[124:125], v[252:253]
    v_pk_mul_f32 v[126:127], v[126:127], v[252:253]
    v_pk_mul_f32 v[140:141], v[140:141], v[252:253]
    v_pk_mul_f32 v[142:143], v[142:143], v[252:253]
    v_pk_mul_f32 v[156:157], v[156:157], v[252:253]
    v_pk_mul_f32 v[158:159], v[158:159], v[252:253]
    v_exp_f32 v240, v176
    v_exp_f32 v241, v177
    v_exp_f32 v242, v178
    v_exp_f32 v243, v179
    v_cvt_pk_bf16_f32 v232, v240, v241
    v_exp_f32 v244, v180
    v_exp_f32 v245, v181
    v_cvt_pk_bf16_f32 v233, v242, v243
    v_exp_f32 v240, v182
    v_exp_f32 v241, v183
    v_cvt_pk_bf16_f32 v234, v244, v245
    v_exp_f32 v242, v184
    v_exp_f32 v243, v185
    v_cvt_pk_bf16_f32 v235, v240, v241
    v_exp_f32 v244, v186
    v_exp_f32 v245, v187
    v_cvt_pk_bf16_f32 v236, v242, v243
    v_exp_f32 v240, v188
    v_exp_f32 v241, v189
    v_cvt_pk_bf16_f32 v237, v244, v245
    v_exp_f32 v242, v190
    v_exp_f32 v243, v191
    v_cvt_pk_bf16_f32 v238, v240, v241
    s_nop 0
    v_cvt_pk_bf16_f32 v239, v242, v243
    s_branch L_slow1_5_ret
L_slow0_5:
    v_max3_f32 v250, v160, v161, v162
    v_max3_f32 v251, v163, v164, v165
    v_max3_f32 v250, v250, v166, v167
    v_max_f32 v250, v250, v251
    v_mov_b32 v251, v250
    s_nop 1
    v_permlane16_swap_b32 v250, v251
    v_max_f32 v250, v250, v251
    v_mov_b32 v251, v250
    s_nop 1
    v_permlane32_swap_b32 v250, v251
    v_max_f32_e64 v250, v250, v251
    v_add_f32 v250, 0x41800000, v250
    v_max_f32 v250, 0, v250
    v_sub_f32 v250, 0, v250
    v_mov_b32 v251, v250
    v_exp_f32 v240, v250
    v_pk_add_f32 v[160:161], v[160:161], v[250:251]
    v_pk_add_f32 v[162:163], v[162:163], v[250:251]
    v_pk_add_f32 v[164:165], v[164:165], v[250:251]
    v_pk_add_f32 v[166:167], v[166:167], v[250:251]
    v_pk_add_f32 v[192:193], v[192:193], v[250:251]
    v_pk_add_f32 v[194:195], v[194:195], v[250:251]
    v_mov_b32 v250, v240
    v_mov_b32 v251, v240
    v_pk_mul_f32 v[208:209], v[208:209], v[250:251]
    v_pk_mul_f32 v[210:211], v[210:211], v[250:251]
    v_pk_mul_f32 v[32:33], v[32:33], v[250:251]
    v_pk_mul_f32 v[34:35], v[34:35], v[250:251]
    v_pk_mul_f32 v[48:49], v[48:49], v[250:251]
    v_pk_mul_f32 v[50:51], v[50:51], v[250:251]
    v_pk_mul_f32 v[64:65], v[64:65], v[250:251]
    v_pk_mul_f32 v[66:67], v[66:67], v[250:251]
    v_pk_mul_f32 v[80:81], v[80:81], v[250:251]
    v_pk_mul_f32 v[82:83], v[82:83], v[250:251]
    v_pk_mul_f32 v[96:97], v[96:97], v[250:251]
    v_pk_mul_f32 v[98:99], v[98:99], v[250:251]
    v_pk_mul_f32 v[112:113], v[112:113], v[250:251]
    v_pk_mul_f32 v[114:115], v[114:115], v[250:251]
    v_pk_mul_f32 v[128:129], v[128:129], v[250:251]
    v_pk_mul_f32 v[130:131], v[130:131], v[250:251]
    v_pk_mul_f32 v[144:145], v[144:145], v[250:251]
    v_pk_mul_f32 v[146:147], v[146:147], v[250:251]
    v_max3_f32 v252, v168, v169, v170
    v_max3_f32 v253, v171, v172, v173
    v_max3_f32 v252, v252, v174, v175
    v_max_f32 v252, v252, v253
    v_mov_b32 v253, v252
    s_nop 1
    v_permlane16_swap_b32 v252, v253
    v_max_f32 v252, v252, v253
    v_mov_b32 v253, v252
    s_nop 1
    v_permlane32_swap_b32 v252, v253
    v_max_f32_e64 v252, v252, v253
    v_add_f32 v252, 0x41800000, v252
    v_max_f32 v252, 0, v252
    v_sub_f32 v252, 0, v252
    v_mov_b32 v253, v252
    v_exp_f32 v240, v252
    v_pk_add_f32 v[168:169], v[168:169], v[252:253]
    v_pk_add_f32 v[170:171], v[170:171], v[252:253]
    v_pk_add_f32 v[172:173], v[172:173], v[252:253]
    v_pk_add_f32 v[174:175], v[174:175], v[252:253]
    v_pk_add_f32 v[196:197], v[196:197], v[252:253]
    v_pk_add_f32 v[198:199], v[198:199], v[252:253]
    v_mov_b32 v252, v240
    v_mov_b32 v253, v240
    v_pk_mul_f32 v[212:213], v[212:213], v[252:253]
    v_pk_mul_f32 v[214:215], v[214:215], v[252:253]
    v_pk_mul_f32 v[36:37], v[36:37], v[252:253]
    v_pk_mul_f32 v[38:39], v[38:39], v[252:253]
    v_pk_mul_f32 v[52:53], v[52:53], v[252:253]
    v_pk_mul_f32 v[54:55], v[54:55], v[252:253]
    v_pk_mul_f32 v[68:69], v[68:69], v[252:253]
    v_pk_mul_f32 v[70:71], v[70:71], v[252:253]
    v_pk_mul_f32 v[84:85], v[84:85], v[252:253]
    v_pk_mul_f32 v[86:87], v[86:87], v[252:253]
    v_pk_mul_f32 v[100:101], v[100:101], v[252:253]
    v_pk_mul_f32 v[102:103], v[102:103], v[252:253]
    v_pk_mul_f32 v[116:117], v[116:117], v[252:253]
    v_pk_mul_f32 v[118:119], v[118:119], v[252:253]
    v_pk_mul_f32 v[132:133], v[132:133], v[252:253]
    v_pk_mul_f32 v[134:135], v[134:135], v[252:253]
    v_pk_mul_f32 v[148:149], v[148:149], v[252:253]
    v_pk_mul_f32 v[150:151], v[150:151], v[252:253]
    v_exp_f32 v240, v160
    v_exp_f32 v241, v161
    v_exp_f32 v242, v162
    v_exp_f32 v243, v163
    v_cvt_pk_bf16_f32 v224, v240, v241
    v_exp_f32 v244, v164
    v_exp_f32 v245, v165
    v_cvt_pk_bf16_f32 v225, v242, v243
    v_exp_f32 v240, v166
    v_exp_f32 v241, v167
    v_cvt_pk_bf16_f32 v226, v244, v245
    v_exp_f32 v242, v168
    v_exp_f32 v243, v169
    v_cvt_pk_bf16_f32 v227, v240, v241
    v_exp_f32 v244, v170
    v_exp_f32 v245, v171
    v_cvt_pk_bf16_f32 v228, v242, v243
    v_exp_f32 v240, v172
    v_exp_f32 v241, v173
    v_cvt_pk_bf16_f32 v229, v244, v245
    v_exp_f32 v242, v174
    v_exp_f32 v243, v175
    v_cvt_pk_bf16_f32 v230, v240, v241
    s_nop 0
    v_cvt_pk_bf16_f32 v231, v242, v243
    s_branch L_slow0_5_ret
L_slow1_99:
    v_max3_f32 v250, v176, v177, v178
    v_max3_f32 v251, v179, v180, v181
    v_max3_f32 v250, v250, v182, v183
    v_max_f32 v250, v250, v251
    v_mov_b32 v251, v250
    s_nop 1
    v_permlane16_swap_b32 v250, v251
    v_max_f32 v250, v250, v251
    v_mov_b32 v251, v250
    s_nop 1
    v_permlane32_swap_b32 v250, v251
    v_max_f32_e64 v250, v250, v251
    v_add_f32 v250, 0x41800000, v250
    v_max_f32 v250, 0, v250
    v_sub_f32 v250, 0, v250
    v_mov_b32 v251, v250
    v_exp_f32 v240, v250
    v_pk_add_f32 v[176:177], v[176:177], v[250:251]
    v_pk_add_f32 v[178:179], v[178:179], v[250:251]
    v_pk_add_f32 v[180:181], v[180:181], v[250:251]
    v_pk_add_f32 v[182:183], v[182:183], v[250:251]
    v_pk_add_f32 v[200:201], v[200:201], v[250:251]
    v_pk_add_f32 v[202:203], v[202:203], v[250:251]
    v_mov_b32 v250, v240
    v_mov_b32 v251, v240
    v_pk_mul_f32 v[216:217], v[216:217], v[250:251]
    v_pk_mul_f32 v[218:219], v[218:219], v[250:251]
    v_pk_mul_f32 v[40:41], v[40:41], v[250:251]
    v_pk_mul_f32 v[42:43], v[42:43], v[250:251]
    v_pk_mul_f32 v[56:57], v[56:57], v[250:251]
    v_pk_mul_f32 v[58:59], v[58:59], v[250:251]
    v_pk_mul_f32 v[72:73], v[72:73], v[250:251]
    v_pk_mul_f32 v[74:75], v[74:75], v[250:251]
    v_pk_mul_f32 v[88:89], v[88:89], v[250:251]
    v_pk_mul_f32 v[90:91], v[90:91], v[250:251]
    v_pk_mul_f32 v[104:105], v[104:105], v[250:251]
    v_pk_mul_f32 v[106:107], v[106:107], v[250:251]
    v_pk_mul_f32 v[120:121], v[120:121], v[250:251]
    v_pk_mul_f32 v[122:123], v[122:123], v[250:251]
    v_pk_mul_f32 v[136:137], v[136:137], v[250:251]
    v_pk_mul_f32 v[138:139], v[138:139], v[250:251]
    v_pk_mul_f32 v[152:153], v[152:153], v[250:251]
    v_pk_mul_f32 v[154:155], v[154:155], v[250:251]
    v_max3_f32 v252, v184, v185, v186
    v_max3_f32 v253, v187, v188, v189
    v_max3_f32 v252, v252, v190, v191
    v_max_f32 v252, v252, v253
    v_mov_b32 v253, v252
    s_nop 1
    v_permlane16_swap_b32 v252, v253
    v_max_f32 v252, v252, v253
    v_mov_b32 v253, v252
    s_nop 1
    v_permlane32_swap_b32 v252, v253
    v_max_f32_e64 v252, v252, v253
    v_add_f32 v252, 0x41800000, v252
    v_max_f32 v252, 0, v252
    v_sub_f32 v252, 0, v252
    v_mov_b32 v253, v252
    v_exp_f32 v240, v252
    v_pk_add_f32 v[184:185], v[184:185], v[252:253]
    v_pk_add_f32 v[186:187], v[186:187], v[252:253]
    v_pk_add_f32 v[188:189], v[188:189], v[252:253]
    v_pk_add_f32 v[190:191], v[190:191], v[252:253]
    v_pk_add_f32 v[204:205], v[204:205], v[252:253]
    v_pk_add_f32 v[206:207], v[206:207], v[252:253]
    v_mov_b32 v252, v240
    v_mov_b32 v253, v240
    v_pk_mul_f32 v[220:221], v[220:221], v[252:253]
    v_pk_mul_f32 v[222:223], v[222:223], v[252:253]
    v_pk_mul_f32 v[44:45], v[44:45], v[252:253]
    v_pk_mul_f32 v[46:47], v[46:47], v[252:253]
    v_pk_mul_f32 v[60:61], v[60:61], v[252:253]
    v_pk_mul_f32 v[62:63], v[62:63], v[252:253]
    v_pk_mul_f32 v[76:77], v[76:77], v[252:253]
    v_pk_mul_f32 v[78:79], v[78:79], v[252:253]
    v_pk_mul_f32 v[92:93], v[92:93], v[252:253]
    v_pk_mul_f32 v[94:95], v[94:95], v[252:253]
    v_pk_mul_f32 v[108:109], v[108:109], v[252:253]
    v_pk_mul_f32 v[110:111], v[110:111], v[252:253]
    v_pk_mul_f32 v[124:125], v[124:125], v[252:253]
    v_pk_mul_f32 v[126:127], v[126:127], v[252:253]
    v_pk_mul_f32 v[140:141], v[140:141], v[252:253]
    v_pk_mul_f32 v[142:143], v[142:143], v[252:253]
    v_pk_mul_f32 v[156:157], v[156:157], v[252:253]
    v_pk_mul_f32 v[158:159], v[158:159], v[252:253]
    v_exp_f32 v240, v176
    v_exp_f32 v241, v177
    v_exp_f32 v242, v178
    v_exp_f32 v243, v179
    v_cvt_pk_bf16_f32 v232, v240, v241
    v_exp_f32 v244, v180
    v_exp_f32 v245, v181
    v_cvt_pk_bf16_f32 v233, v242, v243
    v_exp_f32 v240, v182
    v_exp_f32 v241, v183
    v_cvt_pk_bf16_f32 v234, v244, v245
    v_exp_f32 v242, v184
    v_exp_f32 v243, v185
    v_cvt_pk_bf16_f32 v235, v240, v241
    v_exp_f32 v244, v186
    v_exp_f32 v245, v187
    v_cvt_pk_bf16_f32 v236, v242, v243
    v_exp_f32 v240, v188
    v_exp_f32 v241, v189
    v_cvt_pk_bf16_f32 v237, v244, v245
    v_exp_f32 v242, v190
    v_exp_f32 v243, v191
    v_cvt_pk_bf16_f32 v238, v240, v241
    s_nop 0
    v_cvt_pk_bf16_f32 v239, v242, v243
    s_branch L_slow1_99_ret
.section .rodata,"a"
.p2align 6
.amdhsa_kernel recurrent_scan__sliding_block_cached__glu_gated_bilinear__prompt_kernel
  .amdhsa_next_free_vgpr 512
  .amdhsa_next_free_sgpr 102
  .amdhsa_accum_offset 256
  .amdhsa_group_segment_fixed_size 0
  .amdhsa_kernarg_size 96
  .amdhsa_user_sgpr_count 2
  .amdhsa_user_sgpr_kernarg_segment_ptr 1
  .amdhsa_system_sgpr_workgroup_id_x 1
.end_amdhsa_kernel
```
